```python
import torch

def _softmax(x, axis=-1):
    return torch.softmax(x, dim=axis)
def _gelu(x):
    return torch.nn.functional.gelu(x, approximate="tanh")
def _silu(x):
    return torch.nn.functional.silu(x)
def _sigmoid(x):
    return torch.sigmoid(x)
def _layernorm(x, axis=-1, eps=1e-5):
    m = x.mean(dim=axis, keepdim=True)
    v = x.var(dim=axis, keepdim=True, unbiased=False)
    return (x - m) / torch.sqrt(v + eps)
def _scatter_add(tgt, idx, src, axis=0):
    return tgt.clone().index_add_(axis, idx, src)
def _segment_sum(src, seg, n):
    out = torch.zeros((n,) + src.shape[1:], dtype=src.dtype)
    return out.index_add_(0, seg, src)
def _pad(x, pw):
    flat = tuple(v for pair in reversed(pw) for v in pair)
    return torch.nn.functional.pad(x, flat)

kernel_name = 'standalone__gqa_softmax__near_ridge'

def setup_inputs():

    _w = (lambda a: (lambda t: t.to(torch.bfloat16) if t.is_floating_point() else t)(torch.as_tensor(a)))
    B, Hq, Hkv, Sq, Sk, D = 8, 32, 32, 384, 512, 192
    return {
        "q": _w((lambda *s: torch.randn(*s, dtype=torch.bfloat16) * 0.8)(B, Hq, Sq, D)),
        "k": _w((lambda *s: torch.randn(*s, dtype=torch.bfloat16) * 0.8)(B, Hkv, Sk, D)),
        "v": _w((lambda *s: torch.randn(*s, dtype=torch.bfloat16) * 0.05)(B, Hkv, Sk, D)),
    }

def reference(q, k, v):
    B, Hq, Sq, D = q.shape
    Hkv = k.shape[1]
    rep = Hq // Hkv
    k = (lambda x, n, axis: torch.repeat_interleave(x, n, dim=axis))(k, rep, axis=1)
    v = (lambda x, n, axis: torch.repeat_interleave(x, n, dim=axis))(v, rep, axis=1)
    scale = D ** -0.5
    scores = torch.einsum("bhqd,bhkd->bhqk", q, k) * scale
    p = _softmax(scores, axis=-1)
    return torch.einsum("bhqk,bhkd->bhqd", p, v)
```

```asm
; @launch grid=(256,1,1) block=(256,1,1) lds=160768
.amdgcn_target "amdgcn-amd-amdhsa--gfx950"
.text
.globl standalone__gqa_softmax__near_ridge_kernel
.p2align 8
.type standalone__gqa_softmax__near_ridge_kernel,@function
standalone__gqa_softmax__near_ridge_kernel:
    s_cmp_ge_u32 s2, 256
    s_cbranch_scc1 L_end
    s_load_dwordx4 s[36:39], s[0:1], 0
    s_load_dwordx4 s[40:43], s[0:1], 16
    s_getpc_b64 s[60:61]
L_pc:
    s_bfe_u32 s34, s2, 0x50003
    s_lshl_b32 s34, s34, 11
    v_lshrrev_b32 v189, 4, v0
    v_lshlrev_b32 v189, 7, v189
    v_add_u32 v189, s34, v189
    v_min_u32 v189, L_end-L_pc, v189
    global_load_dword a255, v189, s[60:61]
    v_readfirstlane_b32 s3, v0
    v_and_b32 v184, 63, v0
    s_lshr_b32 s3, s3, 6
    s_mul_i32 s30, s3, 3072
    s_and_b32 s34, s2, 7
    s_lshr_b32 s35, s2, 4
    s_lshl_b32 s35, s35, 3
    s_add_u32 s34, s34, s35
    s_bfe_u32 s35, s2, 0x10003
    s_mul_i32 s31, s34, 196608
    s_mul_i32 s44, s34, 147456
    s_mul_i32 s35, s35, 73728
    s_add_u32 s44, s44, s35
    s_mul_i32 s55, s3, 18432
    s_add_u32 s44, s44, s55
    s_add_u32 s45, s44, 18874368
    s_add_u32 s55, s55, 73728
    s_mul_i32 s34, s3, 192
    v_add_u32 v180, s34, v184
    s_lshl_b32 s34, s3, 2
    v_add_u32 v181, 0, v184
    v_mul_u32_u24 v181, 2731, v181
    v_lshrrev_b32 v181, 16, v181
    v_and_b32 v182, 6, v181
    v_xor_b32 v182, v182, v180
    v_lshlrev_b32 v204, 4, v182
    v_lshrrev_b32 v181, 1, v181
    v_add_u32 v181, s34, v181
    v_and_b32 v181, 7, v181
    v_xor_b32 v181, v181, v180
    v_lshlrev_b32 v201, 4, v181
    v_add_u32 v181, 64, v184
    v_mul_u32_u24 v181, 2731, v181
    v_lshrrev_b32 v181, 16, v181
    v_and_b32 v182, 6, v181
    v_xor_b32 v182, v182, v180
    v_lshlrev_b32 v205, 4, v182
    v_lshrrev_b32 v181, 1, v181
    v_add_u32 v181, s34, v181
    v_and_b32 v181, 7, v181
    v_xor_b32 v181, v181, v180
    v_lshlrev_b32 v202, 4, v181
    v_add_u32 v181, 128, v184
    v_mul_u32_u24 v181, 2731, v181
    v_lshrrev_b32 v181, 16, v181
    v_and_b32 v182, 6, v181
    v_xor_b32 v182, v182, v180
    v_lshlrev_b32 v206, 4, v182
    v_lshrrev_b32 v181, 1, v181
    v_add_u32 v181, s34, v181
    v_and_b32 v181, 7, v181
    v_xor_b32 v181, v181, v180
    v_lshlrev_b32 v203, 4, v181
    v_lshrrev_b32 v181, 3, v184
    v_xor_b32 v181, v181, v184
    v_lshlrev_b32 v207, 4, v181
    s_mov_b32 s49, 0x3000000
    s_mov_b32 s54, 0x2400000
    s_mov_b32 s6, s49
    s_mov_b32 s7, 0x20000
    s_mov_b32 s10, s49
    s_mov_b32 s11, 0x20000
    s_mov_b32 s14, s54
    s_mov_b32 s15, 0x20000
    s_mov_b32 s18, 0
    s_mov_b32 s19, 0x20000
    s_add_u32 m0, s30, 36864
    s_waitcnt lgkmcnt(0)
    s_mov_b32 s4, s38
    s_mov_b32 s5, s39
    s_mov_b32 s12, s36
    s_mov_b32 s13, s37
    buffer_load_dwordx4 v201, s[4:7], s31 offen offset:0 nt lds
    buffer_load_dwordx4 v202, s[4:7], s31 offen offset:1024 nt lds
    buffer_load_dwordx4 v203, s[4:7], s31 offen offset:2048 nt lds
    s_mov_b32 s8, s40
    s_mov_b32 s9, s41
    s_mov_b32 s16, s42
    s_mov_b32 s17, s43
    s_add_u32 m0, s55, 0
    s_add_u32 s27, s44, 0
    buffer_load_dwordx4 v207, s[12:15], s27 offen offset:0 nt lds
    buffer_load_dwordx4 v207, s[12:15], s27 offen offset:1024 nt lds
    buffer_load_dwordx4 v207, s[12:15], s27 offen offset:2048 nt lds
    s_add_u32 m0, s55, 3072
    s_add_u32 s27, s44, 3072
    buffer_load_dwordx4 v207, s[12:15], s27 offen offset:0 nt lds
    buffer_load_dwordx4 v207, s[12:15], s27 offen offset:1024 nt lds
    buffer_load_dwordx4 v207, s[12:15], s27 offen offset:2048 nt lds
    s_mov_b32 s36, 0x7f80
    s_mov_b32 s33, 0xfe00
    s_mov_b32 s37, 0x7ffe0000
    s_mov_b32 s20, 2
    s_mov_b32 s25, 0x3dd53b95
    s_mov_b32 s26, 0x40004000
    s_mov_b32 s32, 24981504
    s_mov_b32 s47, 15
    s_mov_b32 s53, s44
    s_mov_b32 s50, 0
    s_add_u32 s51, s45, 0
    s_add_u32 s52, s55, 0
    v_lshlrev_b32 v209, 4, v184
    v_add_u32 v208, s55, v207
    v_and_b32 v180, 15, v184
    v_lshrrev_b32 v181, 4, v184
    v_mul_u32_u24 v182, 384, v180
    v_lshrrev_b32 v183, 1, v180
    v_xor_b32 v183, v183, v181
    v_lshl_add_u32 v183, v183, 4, v182
    v_add_u32 v195, 36864, v183
    v_xor_b32 v196, 64, v195
    v_add_u32 v248, 148480, v183
    v_xor_b32 v249, 64, v248
    v_add_u32 v182, s55, v182
    v_mul_u32_u24 v185, 3, v180
    v_lshrrev_b32 v186, 1, v181
    v_and_b32 v187, 1, v181
    v_lshl_add_u32 v187, v187, 3, v182
    v_add_u32 v183, 0, v185
    v_and_b32 v183, 7, v183
    v_xor_b32 v180, v183, v181
    v_lshl_add_u32 v210, v180, 4, v182
    v_xor_b32 v211, 64, v210
    v_xor_b32 v180, v183, v186
    v_lshl_add_u32 v216, v180, 4, v187
    v_xor_b32 v217, 32, v216
    v_xor_b32 v218, 64, v216
    v_xor_b32 v219, 96, v216
    v_add_u32 v183, 1, v185
    v_and_b32 v183, 7, v183
    v_xor_b32 v180, v183, v181
    v_lshl_add_u32 v212, v180, 4, v182
    v_add_u32 v212, 128, v212
    v_xor_b32 v213, 64, v212
    v_xor_b32 v180, v183, v186
    v_lshl_add_u32 v220, v180, 4, v187
    v_add_u32 v220, 128, v220
    v_xor_b32 v221, 32, v220
    v_xor_b32 v222, 64, v220
    v_xor_b32 v223, 96, v220
    v_add_u32 v183, 2, v185
    v_and_b32 v183, 7, v183
    v_xor_b32 v180, v183, v181
    v_lshl_add_u32 v214, v180, 4, v182
    v_add_u32 v214, 256, v214
    v_xor_b32 v215, 64, v214
    v_xor_b32 v180, v183, v186
    v_lshl_add_u32 v224, v180, 4, v187
    v_add_u32 v224, 256, v224
    v_xor_b32 v225, 32, v224
    v_xor_b32 v226, 64, v224
    v_xor_b32 v227, 96, v224
    v_lshrrev_b32 v180, 2, v184
    v_mul_u32_u24 v182, 384, v180
    v_bfe_u32 v183, v180, 1, 2
    v_lshl_add_u32 v182, v183, 5, v182
    v_and_b32 v183, 3, v184
    v_lshl_add_u32 v197, v183, 3, v182
    v_xor_b32 v198, 32, v197
    v_xor_b32 v199, 64, v197
    v_xor_b32 v200, 96, v197
    v_add_u32 v250, 148480, v197
    v_add_u32 v251, 148480, v198
    v_add_u32 v252, 148480, v199
    v_add_u32 v253, 148480, v200
    v_mov_b32 v188, 0
    v_mov_b32 v180, 0x3f803f80
    v_accvgpr_write_b32 a216, v180
    v_accvgpr_write_b32 a217, v180
    v_accvgpr_write_b32 a218, v180
    v_accvgpr_write_b32 a219, v180
    s_add_u32 m0, s30, 49152
    s_add_u32 s21, s31, 12288
    buffer_load_dwordx4 v201, s[4:7], s21 offen offset:0 nt lds
    buffer_load_dwordx4 v202, s[4:7], s21 offen offset:1024 nt lds
    buffer_load_dwordx4 v203, s[4:7], s21 offen offset:2048 nt lds
    s_add_u32 m0, s30, 0
    s_add_u32 s21, s31, 0
    buffer_load_dwordx4 v204, s[8:11], s21 offen offset:0 nt lds
    buffer_load_dwordx4 v205, s[8:11], s21 offen offset:1024 nt lds
    buffer_load_dwordx4 v206, s[8:11], s21 offen offset:2048 nt lds
    s_add_u32 m0, s30, 148480
    s_add_u32 s21, s31, 12288
    buffer_load_dwordx4 v204, s[8:11], s21 offen offset:0 nt lds
    buffer_load_dwordx4 v205, s[8:11], s21 offen offset:1024 nt lds
    buffer_load_dwordx4 v206, s[8:11], s21 offen offset:2048 nt lds
    s_add_u32 m0, s55, 6144
    s_add_u32 s27, s44, 6144
    buffer_load_dwordx4 v207, s[12:15], s27 offen offset:0 nt lds
    buffer_load_dwordx4 v207, s[12:15], s27 offen offset:1024 nt lds
    s_waitcnt vmcnt(17)
    s_barrier
    ds_read_b128 a[72:75], v195 offset:0
    ds_read_b128 a[76:79], v196 offset:0
    ds_read_b128 a[80:83], v195 offset:128
    ds_read_b128 a[84:87], v196 offset:128
    ds_read_b128 a[88:91], v195 offset:256
    ds_read_b128 a[92:95], v196 offset:256
    ds_read_b128 a[96:99], v195 offset:6144
    ds_read_b128 a[100:103], v196 offset:6144
    ds_read_b128 a[104:107], v195 offset:6272
    ds_read_b128 a[108:111], v196 offset:6272
    ds_read_b128 a[112:115], v195 offset:6400
    ds_read_b128 a[116:119], v196 offset:6400
    s_waitcnt vmcnt(11)
    ds_read_b128 a[0:3], v210 offset:0
    ds_read_b128 a[4:7], v211 offset:0
    ds_read_b128 a[8:11], v212 offset:0
    ds_read_b128 a[12:15], v213 offset:0
    ds_read_b128 a[16:19], v214 offset:0
    ds_read_b128 a[20:23], v215 offset:0
    s_waitcnt lgkmcnt(0)
    v_mfma_f32_16x16x32_bf16 v[144:147], a[72:75], a[0:3], 0
    v_mfma_f32_16x16x32_bf16 v[144:147], a[76:79], a[4:7], v[144:147]
    v_mfma_f32_16x16x32_bf16 v[144:147], a[80:83], a[8:11], v[144:147]
    v_mfma_f32_16x16x32_bf16 v[144:147], a[84:87], a[12:15], v[144:147]
    v_mfma_f32_16x16x32_bf16 v[144:147], a[88:91], a[16:19], v[144:147]
    v_mfma_f32_16x16x32_bf16 v[144:147], a[92:95], a[20:23], v[144:147]
    v_mfma_f32_16x16x32_bf16 v[148:151], a[96:99], a[0:3], 0
    v_mfma_f32_16x16x32_bf16 v[148:151], a[100:103], a[4:7], v[148:151]
    v_mfma_f32_16x16x32_bf16 v[148:151], a[104:107], a[8:11], v[148:151]
    v_mfma_f32_16x16x32_bf16 v[148:151], a[108:111], a[12:15], v[148:151]
    v_mfma_f32_16x16x32_bf16 v[148:151], a[112:115], a[16:19], v[148:151]
    v_mfma_f32_16x16x32_bf16 v[148:151], a[116:119], a[20:23], v[148:151]
    s_add_u32 m0, s55, 6144
    s_add_u32 s27, s44, 6144
    buffer_load_dwordx4 v207, s[12:15], s27 offen offset:2048 nt lds
    s_add_u32 m0, s55, 9216
    s_add_u32 s27, s44, 9216
    buffer_load_dwordx4 v207, s[12:15], s27 offen offset:0 nt lds
    buffer_load_dwordx4 v207, s[12:15], s27 offen offset:1024 nt lds
    buffer_load_dwordx4 v207, s[12:15], s27 offen offset:2048 nt lds
    s_waitcnt vmcnt(9)
    s_barrier
    ds_read_b128 a[168:171], v195 offset:12288
    ds_read_b128 a[172:175], v196 offset:12288
    ds_read_b128 a[176:179], v195 offset:12416
    ds_read_b128 a[180:183], v196 offset:12416
    ds_read_b128 a[184:187], v195 offset:12544
    ds_read_b128 a[188:191], v196 offset:12544
    ds_read_b128 a[192:195], v195 offset:18432
    ds_read_b128 a[196:199], v196 offset:18432
    ds_read_b128 a[200:203], v195 offset:18560
    ds_read_b128 a[204:207], v196 offset:18560
    ds_read_b128 a[208:211], v195 offset:18688
    ds_read_b128 a[212:215], v196 offset:18688
    ds_read_b64_tr_b16 a[120:121], v197 offset:0
    ds_read_b64_tr_b16 a[122:123], v197 offset:6144
    ds_read_b64_tr_b16 a[124:125], v198 offset:0
    ds_read_b64_tr_b16 a[126:127], v198 offset:6144
    ds_read_b64_tr_b16 a[128:129], v199 offset:0
    ds_read_b64_tr_b16 a[130:131], v199 offset:6144
    ds_read_b64_tr_b16 a[132:133], v200 offset:0
    ds_read_b64_tr_b16 a[134:135], v200 offset:6144
    ds_read_b64_tr_b16 a[136:137], v197 offset:128
    ds_read_b64_tr_b16 a[138:139], v197 offset:6272
    ds_read_b64_tr_b16 a[140:141], v198 offset:128
    ds_read_b64_tr_b16 a[142:143], v198 offset:6272
    ds_read_b64_tr_b16 a[144:145], v199 offset:128
    ds_read_b64_tr_b16 a[146:147], v199 offset:6272
    ds_read_b64_tr_b16 a[148:149], v200 offset:128
    ds_read_b64_tr_b16 a[150:151], v200 offset:6272
    ds_read_b64_tr_b16 a[152:153], v197 offset:256
    ds_read_b64_tr_b16 a[154:155], v197 offset:6400
    ds_read_b64_tr_b16 a[156:157], v198 offset:256
    ds_read_b64_tr_b16 a[158:159], v198 offset:6400
    ds_read_b64_tr_b16 a[160:161], v199 offset:256
    ds_read_b64_tr_b16 a[162:163], v199 offset:6400
    ds_read_b64_tr_b16 a[164:165], v200 offset:256
    ds_read_b64_tr_b16 a[166:167], v200 offset:6400
    s_waitcnt lgkmcnt(14)
    v_mfma_f32_16x16x32_bf16 v[152:155], a[168:171], a[0:3], 0
    v_mfma_f32_16x16x32_bf16 v[152:155], a[172:175], a[4:7], v[152:155]
    v_mfma_f32_16x16x32_bf16 v[152:155], a[176:179], a[8:11], v[152:155]
    v_mfma_f32_16x16x32_bf16 v[152:155], a[180:183], a[12:15], v[152:155]
    v_mfma_f32_16x16x32_bf16 v[152:155], a[184:187], a[16:19], v[152:155]
    v_mfma_f32_16x16x32_bf16 v[152:155], a[188:191], a[20:23], v[152:155]
    v_mfma_f32_16x16x32_bf16 v[156:159], a[192:195], a[0:3], 0
    v_mfma_f32_16x16x32_bf16 v[156:159], a[196:199], a[4:7], v[156:159]
    v_mfma_f32_16x16x32_bf16 v[156:159], a[200:203], a[8:11], v[156:159]
    v_mfma_f32_16x16x32_bf16 v[156:159], a[204:207], a[12:15], v[156:159]
    v_mfma_f32_16x16x32_bf16 v[156:159], a[208:211], a[16:19], v[156:159]
    v_mfma_f32_16x16x32_bf16 v[156:159], a[212:215], a[20:23], v[156:159]
    s_add_u32 m0, s55, 12288
    s_add_u32 s27, s44, 12288
    buffer_load_dwordx4 v207, s[12:15], s27 offen offset:0 nt lds
    buffer_load_dwordx4 v207, s[12:15], s27 offen offset:1024 nt lds
    buffer_load_dwordx4 v207, s[12:15], s27 offen offset:2048 nt lds
    v_max3_f32 v244, v144, v145, v146
    v_max3_f32 v244, v244, v147, v148
    v_max3_f32 v244, v244, v149, v150
    v_max3_f32 v244, v244, v151, v152
    v_max3_f32 v244, v244, v153, v154
    v_max3_f32 v244, v244, v155, v156
    v_max3_f32 v244, v244, v157, v158
    v_max_f32 v244, v244, v159
    v_mov_b32 v245, v244
    s_nop 1
    v_permlane32_swap_b32 v244, v245
    v_max_f32 v244, v244, v245
    v_mov_b32 v245, v244
    s_nop 1
    v_permlane16_swap_b32 v244, v245
    v_max_f32 v244, v244, v245
    v_mul_f32 v192, s25, v244
    v_add_f32 v192, 0x41100000, v192
    v_fma_f32 v180, v144, s25, -v192
    v_fma_f32 v181, v145, s25, -v192
    v_exp_f32 v180, v180
    v_exp_f32 v181, v181
    v_fma_f32 v182, v146, s25, -v192
    v_fma_f32 v183, v147, s25, -v192
    v_exp_f32 v182, v182
    v_exp_f32 v183, v183
    v_cvt_pk_bf16_f32 v168, v180, v181
    v_fma_f32 v184, v148, s25, -v192
    v_fma_f32 v185, v149, s25, -v192
    v_exp_f32 v184, v184
    v_cvt_pk_bf16_f32 v169, v182, v183
    v_exp_f32 v185, v185
    v_fma_f32 v186, v150, s25, -v192
    v_fma_f32 v187, v151, s25, -v192
    v_exp_f32 v186, v186
    v_cvt_pk_bf16_f32 v170, v184, v185
    v_exp_f32 v187, v187
    s_nop 0
    v_cvt_pk_bf16_f32 v171, v186, v187
    s_waitcnt vmcnt(9) lgkmcnt(0)
    s_barrier
    v_mfma_f32_16x16x32_bf16 v[232:235], a[216:219], v[168:171], 0
    v_fma_f32 v180, v152, s25, -v192
    v_fma_f32 v181, v153, s25, -v192
    v_exp_f32 v180, v180
    v_mfma_f32_16x16x32_bf16 v[0:3], a[120:123], v[168:171], 0
    ds_read_b64_tr_b16 a[120:121], v250 offset:0
    ds_read_b64_tr_b16 a[122:123], v250 offset:6144
    v_exp_f32 v181, v181
    v_mfma_f32_16x16x32_bf16 v[4:7], a[124:127], v[168:171], 0
    ds_read_b64_tr_b16 a[124:125], v251 offset:0
    ds_read_b64_tr_b16 a[126:127], v251 offset:6144
    v_fma_f32 v182, v154, s25, -v192
    v_mfma_f32_16x16x32_bf16 v[8:11], a[128:131], v[168:171], 0
    ds_read_b64_tr_b16 a[128:129], v252 offset:0
    ds_read_b64_tr_b16 a[130:131], v252 offset:6144
    v_fma_f32 v183, v155, s25, -v192
    v_exp_f32 v182, v182
    v_mfma_f32_16x16x32_bf16 v[12:15], a[132:135], v[168:171], 0
    ds_read_b64_tr_b16 a[132:133], v253 offset:0
    ds_read_b64_tr_b16 a[134:135], v253 offset:6144
    v_exp_f32 v183, v183
    v_mfma_f32_16x16x32_bf16 v[16:19], a[136:139], v[168:171], 0
    ds_read_b64_tr_b16 a[136:137], v250 offset:128
    ds_read_b64_tr_b16 a[138:139], v250 offset:6272
    v_cvt_pk_bf16_f32 v172, v180, v181
    v_mfma_f32_16x16x32_bf16 v[20:23], a[140:143], v[168:171], 0
    ds_read_b64_tr_b16 a[140:141], v251 offset:128
    ds_read_b64_tr_b16 a[142:143], v251 offset:6272
    v_fma_f32 v184, v156, s25, -v192
    v_fma_f32 v185, v157, s25, -v192
    v_exp_f32 v184, v184
    v_mfma_f32_16x16x32_bf16 v[24:27], a[144:147], v[168:171], 0
    ds_read_b64_tr_b16 a[144:145], v252 offset:128
    ds_read_b64_tr_b16 a[146:147], v252 offset:6272
    v_cvt_pk_bf16_f32 v173, v182, v183
    v_mfma_f32_16x16x32_bf16 v[28:31], a[148:151], v[168:171], 0
    ds_read_b64_tr_b16 a[148:149], v253 offset:128
    ds_read_b64_tr_b16 a[150:151], v253 offset:6272
    v_exp_f32 v185, v185
    v_mfma_f32_16x16x32_bf16 v[32:35], a[152:155], v[168:171], 0
    ds_read_b64_tr_b16 a[152:153], v250 offset:256
    ds_read_b64_tr_b16 a[154:155], v250 offset:6400
    v_fma_f32 v186, v158, s25, -v192
    v_fma_f32 v187, v159, s25, -v192
    v_mfma_f32_16x16x32_bf16 v[36:39], a[156:159], v[168:171], 0
    ds_read_b64_tr_b16 a[156:157], v251 offset:256
    ds_read_b64_tr_b16 a[158:159], v251 offset:6400
    v_exp_f32 v186, v186
    v_mfma_f32_16x16x32_bf16 v[40:43], a[160:163], v[168:171], 0
    ds_read_b64_tr_b16 a[160:161], v252 offset:256
    ds_read_b64_tr_b16 a[162:163], v252 offset:6400
    v_cvt_pk_bf16_f32 v174, v184, v185
    v_exp_f32 v187, v187
    v_mfma_f32_16x16x32_bf16 v[44:47], a[164:167], v[168:171], 0
    ds_read_b64_tr_b16 a[164:165], v253 offset:256
    ds_read_b64_tr_b16 a[166:167], v253 offset:6400
    v_cvt_pk_bf16_f32 v175, v186, v187
    s_nop 1
    v_mfma_f32_16x16x32_bf16 v[232:235], a[216:219], v[172:175], v[232:235]
    s_waitcnt lgkmcnt(10)
    v_mfma_f32_16x16x32_bf16 v[0:3], a[120:123], v[172:175], v[0:3]
    v_mfma_f32_16x16x32_bf16 v[4:7], a[124:127], v[172:175], v[4:7]
    v_mfma_f32_16x16x32_bf16 v[8:11], a[128:131], v[172:175], v[8:11]
    v_mfma_f32_16x16x32_bf16 v[12:15], a[132:135], v[172:175], v[12:15]
    v_mfma_f32_16x16x32_bf16 v[16:19], a[136:139], v[172:175], v[16:19]
    v_mfma_f32_16x16x32_bf16 v[20:23], a[140:143], v[172:175], v[20:23]
    v_mfma_f32_16x16x32_bf16 v[24:27], a[144:147], v[172:175], v[24:27]
    s_waitcnt lgkmcnt(0)
    v_mfma_f32_16x16x32_bf16 v[28:31], a[148:151], v[172:175], v[28:31]
    v_mfma_f32_16x16x32_bf16 v[32:35], a[152:155], v[172:175], v[32:35]
    v_mfma_f32_16x16x32_bf16 v[36:39], a[156:159], v[172:175], v[36:39]
    v_mfma_f32_16x16x32_bf16 v[40:43], a[160:163], v[172:175], v[40:43]
    v_mfma_f32_16x16x32_bf16 v[44:47], a[164:167], v[172:175], v[44:47]
    s_add_u32 m0, s55, 15360
    s_add_u32 s27, s44, 15360
    buffer_load_dwordx4 v207, s[12:15], s27 offen offset:0 nt lds
    buffer_load_dwordx4 v207, s[12:15], s27 offen offset:1024 nt lds
    buffer_load_dwordx4 v207, s[12:15], s27 offen offset:2048 nt lds
    s_add_u32 m0, s30, 61440
    s_add_u32 s21, s31, 24576
    buffer_load_dwordx4 v201, s[4:7], s21 offen offset:0 nt lds
    buffer_load_dwordx4 v202, s[4:7], s21 offen offset:1024 nt lds
    buffer_load_dwordx4 v203, s[4:7], s21 offen offset:2048 nt lds
    s_waitcnt vmcnt(9)
    ds_read_b128 a[24:27], v210 offset:6144
    ds_read_b128 a[28:31], v211 offset:6144
    ds_read_b128 a[32:35], v212 offset:6144
    ds_read_b128 a[36:39], v213 offset:6144
    ds_read_b128 a[40:43], v214 offset:6144
    ds_read_b128 a[44:47], v215 offset:6144
    s_waitcnt lgkmcnt(5)
    v_mfma_f32_16x16x32_bf16 v[152:155], a[168:171], a[24:27], 0
    s_waitcnt lgkmcnt(4)
    v_mfma_f32_16x16x32_bf16 v[152:155], a[172:175], a[28:31], v[152:155]
    s_waitcnt lgkmcnt(3)
    v_mfma_f32_16x16x32_bf16 v[152:155], a[176:179], a[32:35], v[152:155]
    s_waitcnt lgkmcnt(2)
    v_mfma_f32_16x16x32_bf16 v[152:155], a[180:183], a[36:39], v[152:155]
    s_waitcnt lgkmcnt(1)
    v_mfma_f32_16x16x32_bf16 v[152:155], a[184:187], a[40:43], v[152:155]
    s_waitcnt lgkmcnt(0)
    v_mfma_f32_16x16x32_bf16 v[152:155], a[188:191], a[44:47], v[152:155]
    v_mfma_f32_16x16x32_bf16 v[156:159], a[192:195], a[24:27], 0
    v_mfma_f32_16x16x32_bf16 v[156:159], a[196:199], a[28:31], v[156:159]
    v_mfma_f32_16x16x32_bf16 v[156:159], a[200:203], a[32:35], v[156:159]
    v_mfma_f32_16x16x32_bf16 v[156:159], a[204:207], a[36:39], v[156:159]
    v_mfma_f32_16x16x32_bf16 v[156:159], a[208:211], a[40:43], v[156:159]
    v_mfma_f32_16x16x32_bf16 v[156:159], a[212:215], a[44:47], v[156:159]
    v_mfma_f32_16x16x32_bf16 v[144:147], a[72:75], a[24:27], 0
    v_mfma_f32_16x16x32_bf16 v[144:147], a[76:79], a[28:31], v[144:147]
    v_mfma_f32_16x16x32_bf16 v[144:147], a[80:83], a[32:35], v[144:147]
    v_mfma_f32_16x16x32_bf16 v[144:147], a[84:87], a[36:39], v[144:147]
    v_mfma_f32_16x16x32_bf16 v[144:147], a[88:91], a[40:43], v[144:147]
    v_mfma_f32_16x16x32_bf16 v[144:147], a[92:95], a[44:47], v[144:147]
    v_mfma_f32_16x16x32_bf16 v[148:151], a[96:99], a[24:27], 0
    v_mfma_f32_16x16x32_bf16 v[148:151], a[100:103], a[28:31], v[148:151]
    v_mfma_f32_16x16x32_bf16 v[148:151], a[104:107], a[32:35], v[148:151]
    v_mfma_f32_16x16x32_bf16 v[148:151], a[108:111], a[36:39], v[148:151]
    v_mfma_f32_16x16x32_bf16 v[148:151], a[112:115], a[40:43], v[148:151]
    v_mfma_f32_16x16x32_bf16 v[148:151], a[116:119], a[44:47], v[148:151]
    s_nop 1
    v_max3_f32 v244, v144, v145, v146
    s_nop 4
    v_max3_f32 v244, v244, v147, v148
    v_max3_f32 v244, v244, v149, v150
    v_max3_f32 v244, v244, v151, v152
    v_max3_f32 v244, v244, v153, v154
    v_max3_f32 v244, v244, v155, v156
    v_max3_f32 v244, v244, v157, v158
    v_max_f32 v244, v244, v159
    v_mov_b32 v245, v244
    s_nop 1
    v_permlane32_swap_b32 v244, v245
    v_max_f32 v244, v244, v245
    v_mov_b32 v245, v244
    s_nop 1
    v_permlane16_swap_b32 v244, v245
    v_max_f32 v244, v244, v245
    v_mul_f32 v193, s25, v244
    v_add_f32 v193, 0x41100000, v193
    v_fma_f32 v180, v152, s25, -v193
    v_fma_f32 v181, v153, s25, -v193
    v_exp_f32 v180, v180
    v_exp_f32 v181, v181
    v_fma_f32 v182, v154, s25, -v193
    v_fma_f32 v183, v155, s25, -v193
    v_exp_f32 v182, v182
    v_exp_f32 v183, v183
    v_cvt_pk_bf16_f32 v172, v180, v181
    v_fma_f32 v184, v156, s25, -v193
    v_fma_f32 v185, v157, s25, -v193
    v_exp_f32 v184, v184
    v_cvt_pk_bf16_f32 v173, v182, v183
    v_exp_f32 v185, v185
    v_fma_f32 v186, v158, s25, -v193
    v_fma_f32 v187, v159, s25, -v193
    v_exp_f32 v186, v186
    v_cvt_pk_bf16_f32 v174, v184, v185
    v_exp_f32 v187, v187
    s_nop 0
    v_cvt_pk_bf16_f32 v175, v186, v187
    s_nop 1
    v_mfma_f32_16x16x32_bf16 v[236:239], a[216:219], v[172:175], 0
    v_fma_f32 v180, v144, s25, -v193
    v_fma_f32 v181, v145, s25, -v193
    v_exp_f32 v180, v180
    v_mfma_f32_16x16x32_bf16 v[48:51], a[120:123], v[172:175], 0
    ds_read_b64_tr_b16 a[120:121], v197 offset:0
    ds_read_b64_tr_b16 a[122:123], v197 offset:6144
    v_exp_f32 v181, v181
    v_mfma_f32_16x16x32_bf16 v[52:55], a[124:127], v[172:175], 0
    ds_read_b64_tr_b16 a[124:125], v198 offset:0
    ds_read_b64_tr_b16 a[126:127], v198 offset:6144
    v_fma_f32 v182, v146, s25, -v193
    v_mfma_f32_16x16x32_bf16 v[56:59], a[128:131], v[172:175], 0
    ds_read_b64_tr_b16 a[128:129], v199 offset:0
    ds_read_b64_tr_b16 a[130:131], v199 offset:6144
    v_fma_f32 v183, v147, s25, -v193
    v_exp_f32 v182, v182
    v_mfma_f32_16x16x32_bf16 v[60:63], a[132:135], v[172:175], 0
    ds_read_b64_tr_b16 a[132:133], v200 offset:0
    ds_read_b64_tr_b16 a[134:135], v200 offset:6144
    v_exp_f32 v183, v183
    v_mfma_f32_16x16x32_bf16 v[64:67], a[136:139], v[172:175], 0
    ds_read_b64_tr_b16 a[136:137], v197 offset:128
    ds_read_b64_tr_b16 a[138:139], v197 offset:6272
    v_cvt_pk_bf16_f32 v168, v180, v181
    v_mfma_f32_16x16x32_bf16 v[68:71], a[140:143], v[172:175], 0
    ds_read_b64_tr_b16 a[140:141], v198 offset:128
    ds_read_b64_tr_b16 a[142:143], v198 offset:6272
    v_fma_f32 v184, v148, s25, -v193
    v_fma_f32 v185, v149, s25, -v193
    v_exp_f32 v184, v184
    v_mfma_f32_16x16x32_bf16 v[72:75], a[144:147], v[172:175], 0
    ds_read_b64_tr_b16 a[144:145], v199 offset:128
    ds_read_b64_tr_b16 a[146:147], v199 offset:6272
    v_cvt_pk_bf16_f32 v169, v182, v183
    v_mfma_f32_16x16x32_bf16 v[76:79], a[148:151], v[172:175], 0
    ds_read_b64_tr_b16 a[148:149], v200 offset:128
    ds_read_b64_tr_b16 a[150:151], v200 offset:6272
    v_exp_f32 v185, v185
    v_mfma_f32_16x16x32_bf16 v[80:83], a[152:155], v[172:175], 0
    ds_read_b64_tr_b16 a[152:153], v197 offset:256
    ds_read_b64_tr_b16 a[154:155], v197 offset:6400
    v_fma_f32 v186, v150, s25, -v193
    v_fma_f32 v187, v151, s25, -v193
    v_mfma_f32_16x16x32_bf16 v[84:87], a[156:159], v[172:175], 0
    ds_read_b64_tr_b16 a[156:157], v198 offset:256
    ds_read_b64_tr_b16 a[158:159], v198 offset:6400
    v_exp_f32 v186, v186
    v_mfma_f32_16x16x32_bf16 v[88:91], a[160:163], v[172:175], 0
    ds_read_b64_tr_b16 a[160:161], v199 offset:256
    ds_read_b64_tr_b16 a[162:163], v199 offset:6400
    v_cvt_pk_bf16_f32 v170, v184, v185
    v_exp_f32 v187, v187
    v_mfma_f32_16x16x32_bf16 v[92:95], a[164:167], v[172:175], 0
    ds_read_b64_tr_b16 a[164:165], v200 offset:256
    ds_read_b64_tr_b16 a[166:167], v200 offset:6400
    v_cvt_pk_bf16_f32 v171, v186, v187
    s_nop 1
    v_mfma_f32_16x16x32_bf16 v[236:239], a[216:219], v[168:171], v[236:239]
    s_waitcnt lgkmcnt(10)
    v_mfma_f32_16x16x32_bf16 v[48:51], a[120:123], v[168:171], v[48:51]
    v_mfma_f32_16x16x32_bf16 v[52:55], a[124:127], v[168:171], v[52:55]
    v_mfma_f32_16x16x32_bf16 v[56:59], a[128:131], v[168:171], v[56:59]
    v_mfma_f32_16x16x32_bf16 v[60:63], a[132:135], v[168:171], v[60:63]
    v_mfma_f32_16x16x32_bf16 v[64:67], a[136:139], v[168:171], v[64:67]
    v_mfma_f32_16x16x32_bf16 v[68:71], a[140:143], v[168:171], v[68:71]
    v_mfma_f32_16x16x32_bf16 v[72:75], a[144:147], v[168:171], v[72:75]
    s_waitcnt lgkmcnt(0)
    v_mfma_f32_16x16x32_bf16 v[76:79], a[148:151], v[168:171], v[76:79]
    v_mfma_f32_16x16x32_bf16 v[80:83], a[152:155], v[168:171], v[80:83]
    v_mfma_f32_16x16x32_bf16 v[84:87], a[156:159], v[168:171], v[84:87]
    v_mfma_f32_16x16x32_bf16 v[88:91], a[160:163], v[168:171], v[88:91]
    v_mfma_f32_16x16x32_bf16 v[92:95], a[164:167], v[168:171], v[92:95]
    s_add_u32 m0, s30, 24576
    s_add_u32 s21, s31, 24576
    buffer_load_dwordx4 v204, s[8:11], s21 offen offset:0 nt lds
    buffer_load_dwordx4 v205, s[8:11], s21 offen offset:1024 nt lds
    buffer_load_dwordx4 v206, s[8:11], s21 offen offset:2048 nt lds
    s_add_u32 m0, s30, 36864
    s_add_u32 s21, s31, 36864
    buffer_load_dwordx4 v201, s[4:7], s21 offen offset:0 nt lds
    buffer_load_dwordx4 v202, s[4:7], s21 offen offset:1024 nt lds
    buffer_load_dwordx4 v203, s[4:7], s21 offen offset:2048 nt lds
    s_waitcnt lgkmcnt(0)
    s_barrier
    s_add_u32 m0, s30, 0
    s_add_u32 s21, s31, 36864
    buffer_load_dwordx4 v204, s[8:11], s21 offen offset:0 nt lds
    buffer_load_dwordx4 v205, s[8:11], s21 offen offset:1024 nt lds
    buffer_load_dwordx4 v206, s[8:11], s21 offen offset:2048 nt lds
    s_waitcnt vmcnt(12)
    ds_read_b128 a[48:51], v210 offset:12288
    ds_read_b128 a[52:55], v211 offset:12288
    ds_read_b128 a[56:59], v212 offset:12288
    ds_read_b128 a[60:63], v213 offset:12288
    ds_read_b128 a[64:67], v214 offset:12288
    ds_read_b128 a[68:71], v215 offset:12288
    s_waitcnt lgkmcnt(5)
    v_mfma_f32_16x16x32_bf16 v[144:147], a[72:75], a[48:51], 0
    s_waitcnt lgkmcnt(4)
    v_mfma_f32_16x16x32_bf16 v[144:147], a[76:79], a[52:55], v[144:147]
    s_waitcnt lgkmcnt(3)
    v_mfma_f32_16x16x32_bf16 v[144:147], a[80:83], a[56:59], v[144:147]
    s_waitcnt lgkmcnt(2)
    v_mfma_f32_16x16x32_bf16 v[144:147], a[84:87], a[60:63], v[144:147]
    s_waitcnt lgkmcnt(1)
    v_mfma_f32_16x16x32_bf16 v[144:147], a[88:91], a[64:67], v[144:147]
    s_waitcnt lgkmcnt(0)
    v_mfma_f32_16x16x32_bf16 v[144:147], a[92:95], a[68:71], v[144:147]
    v_mfma_f32_16x16x32_bf16 v[148:151], a[96:99], a[48:51], 0
    v_mfma_f32_16x16x32_bf16 v[148:151], a[100:103], a[52:55], v[148:151]
    v_mfma_f32_16x16x32_bf16 v[148:151], a[104:107], a[56:59], v[148:151]
    v_mfma_f32_16x16x32_bf16 v[148:151], a[108:111], a[60:63], v[148:151]
    s_waitcnt vmcnt(9) lgkmcnt(0)
    v_mfma_f32_16x16x32_bf16 v[148:151], a[112:115], a[64:67], v[148:151]
    s_barrier
    v_mfma_f32_16x16x32_bf16 v[148:151], a[116:119], a[68:71], v[148:151]
    v_mfma_f32_16x16x32_bf16 v[160:163], a[168:171], a[48:51], 0
    ds_read_b128 a[72:75], v195 offset:24576
    v_mfma_f32_16x16x32_bf16 v[160:163], a[172:175], a[52:55], v[160:163]
    ds_read_b128 a[76:79], v196 offset:24576
    v_max3_f32 v244, v144, v145, v146
    s_nop 2
    v_max3_f32 v244, v244, v147, v148
    v_max3_f32 v244, v244, v149, v150
    v_max_f32 v244, v244, v151
    v_mfma_f32_16x16x32_bf16 v[160:163], a[176:179], a[56:59], v[160:163]
    ds_read_b128 a[80:83], v195 offset:24704
    v_mov_b32 v245, v244
    s_nop 1
    v_permlane32_swap_b32 v244, v245
    v_max_f32 v244, v244, v245
    v_mfma_f32_16x16x32_bf16 v[160:163], a[180:183], a[60:63], v[160:163]
    ds_read_b128 a[84:87], v196 offset:24704
    v_mov_b32 v245, v244
    s_nop 1
    v_permlane16_swap_b32 v244, v245
    v_max_f32 v244, v244, v245
    v_mfma_f32_16x16x32_bf16 v[160:163], a[184:187], a[64:67], v[160:163]
    ds_read_b128 a[88:91], v195 offset:24832
    v_mul_f32 v194, s25, v244
    v_add_f32 v194, 0x41100000, v194
    v_fma_f32 v180, v144, s25, -v194
    v_fma_f32 v181, v145, s25, -v194
    v_mfma_f32_16x16x32_bf16 v[160:163], a[188:191], a[68:71], v[160:163]
    ds_read_b128 a[92:95], v196 offset:24832
    v_exp_f32 v180, v180
    v_exp_f32 v181, v181
    v_mfma_f32_16x16x32_bf16 v[164:167], a[192:195], a[48:51], 0
    ds_read_b128 a[96:99], v195 offset:30720
    v_fma_f32 v182, v146, s25, -v194
    v_fma_f32 v183, v147, s25, -v194
    v_exp_f32 v182, v182
    v_mfma_f32_16x16x32_bf16 v[164:167], a[196:199], a[52:55], v[164:167]
    ds_read_b128 a[100:103], v196 offset:30720
    v_exp_f32 v183, v183
    v_cvt_pk_bf16_f32 v168, v180, v181
    v_mfma_f32_16x16x32_bf16 v[164:167], a[200:203], a[56:59], v[164:167]
    ds_read_b128 a[104:107], v195 offset:30848
    v_fma_f32 v184, v148, s25, -v194
    v_fma_f32 v185, v149, s25, -v194
    v_exp_f32 v184, v184
    v_mfma_f32_16x16x32_bf16 v[164:167], a[204:207], a[60:63], v[164:167]
    ds_read_b128 a[108:111], v196 offset:30848
    v_cvt_pk_bf16_f32 v169, v182, v183
    v_exp_f32 v185, v185
    v_fma_f32 v186, v150, s25, -v194
    v_mfma_f32_16x16x32_bf16 v[164:167], a[208:211], a[64:67], v[164:167]
    ds_read_b128 a[112:115], v195 offset:30976
    v_fma_f32 v187, v151, s25, -v194
    v_exp_f32 v186, v186
    v_cvt_pk_bf16_f32 v170, v184, v185
    v_mfma_f32_16x16x32_bf16 v[164:167], a[212:215], a[68:71], v[164:167]
    ds_read_b128 a[116:119], v196 offset:30976
    v_exp_f32 v187, v187
    s_nop 0
    v_cvt_pk_bf16_f32 v171, v186, v187
    s_nop 1
    v_mfma_f32_16x16x32_bf16 v[240:243], a[216:219], v[168:171], 0
    v_fma_f32 v180, v160, s25, -v194
    v_mfma_f32_16x16x32_bf16 v[96:99], a[120:123], v[168:171], 0
    ds_read_b64_tr_b16 a[120:121], v250 offset:0
    ds_read_b64_tr_b16 a[122:123], v250 offset:6144
    v_fma_f32 v181, v161, s25, -v194
    v_fma_f32 v182, v162, s25, -v194
    v_mfma_f32_16x16x32_bf16 v[100:103], a[124:127], v[168:171], 0
    ds_read_b64_tr_b16 a[124:125], v251 offset:0
    ds_read_b64_tr_b16 a[126:127], v251 offset:6144
    v_fma_f32 v183, v163, s25, -v194
    v_mfma_f32_16x16x32_bf16 v[104:107], a[128:131], v[168:171], 0
    ds_read_b64_tr_b16 a[128:129], v252 offset:0
    ds_read_b64_tr_b16 a[130:131], v252 offset:6144
    v_mfma_f32_16x16x32_bf16 v[108:111], a[132:135], v[168:171], 0
    ds_read_b64_tr_b16 a[132:133], v253 offset:0
    ds_read_b64_tr_b16 a[134:135], v253 offset:6144
    v_exp_f32 v180, v180
    v_mfma_f32_16x16x32_bf16 v[112:115], a[136:139], v[168:171], 0
    ds_read_b64_tr_b16 a[136:137], v250 offset:128
    ds_read_b64_tr_b16 a[138:139], v250 offset:6272
    v_fma_f32 v184, v164, s25, -v194
    v_mfma_f32_16x16x32_bf16 v[116:119], a[140:143], v[168:171], 0
    ds_read_b64_tr_b16 a[140:141], v251 offset:128
    ds_read_b64_tr_b16 a[142:143], v251 offset:6272
    v_exp_f32 v181, v181
    v_mfma_f32_16x16x32_bf16 v[120:123], a[144:147], v[168:171], 0
    ds_read_b64_tr_b16 a[144:145], v252 offset:128
    ds_read_b64_tr_b16 a[146:147], v252 offset:6272
    v_mfma_f32_16x16x32_bf16 v[124:127], a[148:151], v[168:171], 0
    ds_read_b64_tr_b16 a[148:149], v253 offset:128
    ds_read_b64_tr_b16 a[150:151], v253 offset:6272
    v_fma_f32 v185, v165, s25, -v194
    v_mfma_f32_16x16x32_bf16 v[128:131], a[152:155], v[168:171], 0
    ds_read_b64_tr_b16 a[152:153], v250 offset:256
    ds_read_b64_tr_b16 a[154:155], v250 offset:6400
    v_exp_f32 v182, v182
    v_mfma_f32_16x16x32_bf16 v[132:135], a[156:159], v[168:171], 0
    ds_read_b64_tr_b16 a[156:157], v251 offset:256
    ds_read_b64_tr_b16 a[158:159], v251 offset:6400
    v_cvt_pk_bf16_f32 v176, v180, v181
    v_mfma_f32_16x16x32_bf16 v[136:139], a[160:163], v[168:171], 0
    ds_read_b64_tr_b16 a[160:161], v252 offset:256
    ds_read_b64_tr_b16 a[162:163], v252 offset:6400
    v_mfma_f32_16x16x32_bf16 v[140:143], a[164:167], v[168:171], 0
    s_waitcnt lgkmcnt(10)
    ds_read_b64_tr_b16 a[164:165], v253 offset:256
    ds_read_b64_tr_b16 a[166:167], v253 offset:6400
    v_fma_f32 v186, v166, s25, -v194
    v_mfma_f32_16x16x32_bf16 v[144:147], a[72:75], a[0:3], 0
    v_exp_f32 v183, v183
    v_mfma_f32_16x16x32_bf16 v[144:147], a[76:79], a[4:7], v[144:147]
    v_exp_f32 v184, v184
    v_mfma_f32_16x16x32_bf16 v[144:147], a[80:83], a[8:11], v[144:147]
    v_fma_f32 v187, v167, s25, -v194
    v_mfma_f32_16x16x32_bf16 v[144:147], a[84:87], a[12:15], v[144:147]
    v_exp_f32 v185, v185
    v_mfma_f32_16x16x32_bf16 v[144:147], a[88:91], a[16:19], v[144:147]
    v_cvt_pk_bf16_f32 v177, v182, v183
    v_mfma_f32_16x16x32_bf16 v[144:147], a[92:95], a[20:23], v[144:147]
    v_exp_f32 v186, v186
    v_mfma_f32_16x16x32_bf16 v[148:151], a[96:99], a[0:3], 0
    v_cvt_pk_bf16_f32 v178, v184, v185
    v_mfma_f32_16x16x32_bf16 v[148:151], a[100:103], a[4:7], v[148:151]
    s_waitcnt vmcnt(6) lgkmcnt(0)
    v_exp_f32 v187, v187
    v_mfma_f32_16x16x32_bf16 v[148:151], a[104:107], a[8:11], v[148:151]
    s_barrier
    v_mfma_f32_16x16x32_bf16 v[148:151], a[108:111], a[12:15], v[148:151]
    v_cvt_pk_bf16_f32 v179, v186, v187
    v_fma_f32 v180, v144, s25, -v192
    v_mfma_f32_16x16x32_bf16 v[148:151], a[112:115], a[16:19], v[148:151]
    v_mfma_f32_16x16x32_bf16 v[148:151], a[116:119], a[20:23], v[148:151]
    v_mfma_f32_16x16x32_bf16 v[240:243], a[216:219], v[176:179], v[240:243]
    v_fma_f32 v181, v145, s25, -v192
    v_fma_f32 v182, v146, s25, -v192
    s_add_u32 m0, s30, 12288
    s_add_u32 s21, s31, 49152
    v_mfma_f32_16x16x32_bf16 v[96:99], a[120:123], v[176:179], v[96:99]
    ds_read_b64_tr_b16 a[120:121], v197 offset:24576
    ds_read_b64_tr_b16 a[122:123], v197 offset:30720
    buffer_load_dwordx4 v204, s[8:11], s21 offen offset:0 nt lds
    v_mfma_f32_16x16x32_bf16 v[100:103], a[124:127], v[176:179], v[100:103]
    v_exp_f32 v180, v180
    v_mfma_f32_16x16x32_bf16 v[104:107], a[128:131], v[176:179], v[104:107]
    ds_read_b64_tr_b16 a[124:125], v198 offset:24576
    ds_read_b64_tr_b16 a[126:127], v198 offset:30720
    buffer_load_dwordx4 v205, s[8:11], s21 offen offset:1024 nt lds
    v_mfma_f32_16x16x32_bf16 v[108:111], a[132:135], v[176:179], v[108:111]
    v_exp_f32 v181, v181
    v_mfma_f32_16x16x32_bf16 v[112:115], a[136:139], v[176:179], v[112:115]
    s_nop 0
    buffer_load_dwordx4 v206, s[8:11], s21 offen offset:2048 nt lds
    v_fma_f32 v183, v147, s25, -v192
    v_fma_f32 v184, v148, s25, -v192
    v_mfma_f32_16x16x32_bf16 v[116:119], a[140:143], v[176:179], v[116:119]
    ds_read_b64_tr_b16 a[128:129], v199 offset:24576
    ds_read_b64_tr_b16 a[130:131], v199 offset:30720
    s_add_u32 m0, s30, 49152
    s_add_u32 s21, s31, 49152
    v_mfma_f32_16x16x32_bf16 v[120:123], a[144:147], v[176:179], v[120:123]
    s_nop 0
    buffer_load_dwordx4 v201, s[4:7], s21 offen offset:0 nt lds
    v_exp_f32 v182, v182
    v_mfma_f32_16x16x32_bf16 v[124:127], a[148:151], v[176:179], v[124:127]
    ds_read_b64_tr_b16 a[132:133], v200 offset:24576
    ds_read_b64_tr_b16 a[134:135], v200 offset:30720
    v_mfma_f32_16x16x32_bf16 v[128:131], a[152:155], v[176:179], v[128:131]
    s_nop 0
    buffer_load_dwordx4 v202, s[4:7], s21 offen offset:1024 nt lds
    v_exp_f32 v183, v183
    v_mfma_f32_16x16x32_bf16 v[132:135], a[156:159], v[176:179], v[132:135]
    v_fma_f32 v185, v149, s25, -v192
    v_cvt_pk_bf16_f32 v168, v180, v181
    v_mfma_f32_16x16x32_bf16 v[136:139], a[160:163], v[176:179], v[136:139]
    ds_read_b64_tr_b16 a[136:137], v197 offset:24704
    ds_read_b64_tr_b16 a[138:139], v197 offset:30848
    buffer_load_dwordx4 v203, s[4:7], s21 offen offset:2048 nt lds
    v_mfma_f32_16x16x32_bf16 v[140:143], a[164:167], v[176:179], v[140:143]
    v_exp_f32 v184, v184
    s_mov_b32 s14, 0
    s_mov_b32 m0, 147456
    v_mfma_f32_16x16x32_bf16 v[152:155], a[72:75], a[24:27], 0
    ds_read_b64_tr_b16 a[140:141], v198 offset:24704
    ds_read_b64_tr_b16 a[142:143], v198 offset:30848
    buffer_load_dwordx4 v207, s[12:15], s45 offen offset:0 nt lds
    v_mfma_f32_16x16x32_bf16 v[152:155], a[76:79], a[28:31], v[152:155]
    v_fma_f32 v186, v150, s25, -v192
    v_cvt_pk_bf16_f32 v169, v182, v183
    v_mfma_f32_16x16x32_bf16 v[152:155], a[80:83], a[32:35], v[152:155]
    s_nop 0
    buffer_load_dwordx4 v207, s[12:15], s45 offen offset:0 nt lds
    v_exp_f32 v185, v185
    v_mfma_f32_16x16x32_bf16 v[152:155], a[84:87], a[36:39], v[152:155]
    ds_read_b64_tr_b16 a[144:145], v199 offset:24704
    ds_read_b64_tr_b16 a[146:147], v199 offset:30848
    v_mfma_f32_16x16x32_bf16 v[152:155], a[88:91], a[40:43], v[152:155]
    s_nop 0
    buffer_load_dwordx4 v207, s[12:15], s45 offen offset:0 nt lds
    v_exp_f32 v186, v186
    v_mfma_f32_16x16x32_bf16 v[152:155], a[92:95], a[44:47], v[152:155]
    ds_read_b64_tr_b16 a[148:149], v200 offset:24704
    ds_read_b64_tr_b16 a[150:151], v200 offset:30848
    s_mov_b32 s14, 0
    s_mov_b32 m0, 147456
    v_mfma_f32_16x16x32_bf16 v[156:159], a[96:99], a[24:27], 0
    s_nop 0
    buffer_load_dwordx4 v207, s[12:15], s45 offen offset:0 nt lds
    v_fma_f32 v187, v151, s25, -v192
    v_cvt_pk_bf16_f32 v170, v184, v185
    v_mfma_f32_16x16x32_bf16 v[156:159], a[100:103], a[28:31], v[156:159]
    ds_read_b64_tr_b16 a[152:153], v197 offset:24832
    ds_read_b64_tr_b16 a[154:155], v197 offset:30976
    v_mfma_f32_16x16x32_bf16 v[156:159], a[104:107], a[32:35], v[156:159]
    v_exp_f32 v187, v187
    v_mfma_f32_16x16x32_bf16 v[156:159], a[108:111], a[36:39], v[156:159]
    ds_read_b64_tr_b16 a[156:157], v198 offset:24832
    ds_read_b64_tr_b16 a[158:159], v198 offset:30976
    v_mfma_f32_16x16x32_bf16 v[156:159], a[112:115], a[40:43], v[156:159]
    v_cvt_pk_bf16_f32 v171, v186, v187
    v_mfma_f32_16x16x32_bf16 v[156:159], a[116:119], a[44:47], v[156:159]
    ds_read_b64_tr_b16 a[160:161], v199 offset:24832
    ds_read_b64_tr_b16 a[162:163], v199 offset:30976
    s_add_u32 s21, s31, 61440
    s_waitcnt lgkmcnt(4)
    s_branch L_g0_0
.p2align 6
L_loop0:
    v_mfma_f32_16x16x32_bf16 v[236:239], a[216:219], v[172:175], v[236:239]
    ds_read_b128 a[96:99], v195 offset:18432
    v_fma_f32 v180, v160, s25, -v194
    v_mfma_f32_16x16x32_bf16 v[48:51], a[120:123], v[172:175], v[48:51]
    v_fma_f32 v181, v161, s25, -v194
    v_fma_f32 v182, v162, s25, -v194
    v_mfma_f32_16x16x32_bf16 v[52:55], a[124:127], v[172:175], v[52:55]
    ds_read_b128 a[100:103], v196 offset:18432
    v_fma_f32 v183, v163, s25, -v194
    v_mfma_f32_16x16x32_bf16 v[56:59], a[128:131], v[172:175], v[56:59]
    s_add_u32 s51, s51, s50
    buffer_load_dwordx4 v202, s[4:7], s21 offen offset:1024 nt lds
    v_mfma_f32_16x16x32_bf16 v[60:63], a[132:135], v[172:175], v[60:63]
    s_add_u32 s52, s52, s50
    v_exp_f32 v180, v180
    v_mfma_f32_16x16x32_bf16 v[64:67], a[136:139], v[172:175], v[64:67]
    s_bitcmp1_b32 s36, s20
    ds_read_b128 a[104:107], v195 offset:18560
    v_fma_f32 v184, v164, s25, -v194
    v_mfma_f32_16x16x32_bf16 v[68:71], a[140:143], v[172:175], v[68:71]
    s_cselect_b32 s14, s54, 0
    v_exp_f32 v181, v181
    v_mfma_f32_16x16x32_bf16 v[72:75], a[144:147], v[172:175], v[72:75]
    s_cselect_b32 s50, 1024, 0
    buffer_load_dwordx4 v203, s[4:7], s21 offen offset:2048 nt lds
    v_mfma_f32_16x16x32_bf16 v[76:79], a[148:151], v[172:175], v[76:79]
    s_cselect_b32 m0, s52, 147456
    ds_read_b128 a[108:111], v196 offset:18560
    v_fma_f32 v185, v165, s25, -v194
    v_mfma_f32_16x16x32_bf16 v[80:83], a[152:155], v[172:175], v[80:83]
    v_exp_f32 v182, v182
    v_mfma_f32_16x16x32_bf16 v[84:87], a[156:159], v[172:175], v[84:87]
    ds_read_b128 a[112:115], v195 offset:18688
    v_cvt_pk_bf16_f32 v176, v180, v181
    v_mfma_f32_16x16x32_bf16 v[88:91], a[160:163], v[172:175], v[88:91]
    s_add_u32 s20, s20, 1
    buffer_load_dwordx4 v207, s[12:15], s51 offen offset:0 nt lds
    v_mfma_f32_16x16x32_bf16 v[92:95], a[164:167], v[172:175], v[92:95]
    s_waitcnt lgkmcnt(2)
    ds_read_b128 a[116:119], v196 offset:18688
    v_fma_f32 v186, v166, s25, -v194
    v_mfma_f32_16x16x32_bf16 v[144:147], a[72:75], a[0:3], 0
    s_add_u32 s51, s51, s50
    v_exp_f32 v183, v183
    v_mfma_f32_16x16x32_bf16 v[144:147], a[76:79], a[4:7], v[144:147]
    s_add_u32 s52, s52, s50
    v_exp_f32 v184, v184
    v_mfma_f32_16x16x32_bf16 v[144:147], a[80:83], a[8:11], v[144:147]
    s_bitcmp1_b32 s33, s20
    v_fma_f32 v187, v167, s25, -v194
    v_mfma_f32_16x16x32_bf16 v[144:147], a[84:87], a[12:15], v[144:147]
    s_cselect_b32 s14, s54, 0
    v_exp_f32 v185, v185
    v_mfma_f32_16x16x32_bf16 v[144:147], a[88:91], a[16:19], v[144:147]
    s_cselect_b32 s50, 1024, 0
    v_cvt_pk_bf16_f32 v177, v182, v183
    v_mfma_f32_16x16x32_bf16 v[144:147], a[92:95], a[20:23], v[144:147]
    s_cselect_b32 m0, s52, 147456
    v_exp_f32 v186, v186
    v_mfma_f32_16x16x32_bf16 v[148:151], a[96:99], a[0:3], 0
    v_cvt_pk_bf16_f32 v178, v184, v185
    v_mfma_f32_16x16x32_bf16 v[148:151], a[100:103], a[4:7], v[148:151]
    v_exp_f32 v187, v187
    v_mfma_f32_16x16x32_bf16 v[148:151], a[104:107], a[8:11], v[148:151]
    s_waitcnt lgkmcnt(0)
    v_mfma_f32_16x16x32_bf16 v[148:151], a[108:111], a[12:15], v[148:151]
    v_cvt_pk_bf16_f32 v179, v186, v187
    v_fma_f32 v180, v144, s25, -v192
    v_mfma_f32_16x16x32_bf16 v[148:151], a[112:115], a[16:19], v[148:151]
    s_nop 0
    buffer_load_dwordx4 v207, s[12:15], s51 offen offset:0 nt lds
    v_mfma_f32_16x16x32_bf16 v[148:151], a[116:119], a[20:23], v[148:151]
    v_mfma_f32_16x16x32_bf16 v[240:243], a[216:219], v[176:179], v[240:243]
    v_fma_f32 v181, v145, s25, -v192
    v_fma_f32 v182, v146, s25, -v192
    v_mfma_f32_16x16x32_bf16 v[96:99], a[120:123], v[176:179], v[96:99]
    ds_read_b64_tr_b16 a[120:121], v197 offset:12288
    ds_read_b64_tr_b16 a[122:123], v197 offset:18432
    v_mfma_f32_16x16x32_bf16 v[100:103], a[124:127], v[176:179], v[100:103]
    v_exp_f32 v180, v180
    v_mfma_f32_16x16x32_bf16 v[104:107], a[128:131], v[176:179], v[104:107]
    ds_read_b64_tr_b16 a[124:125], v198 offset:12288
    ds_read_b64_tr_b16 a[126:127], v198 offset:18432
    v_mfma_f32_16x16x32_bf16 v[108:111], a[132:135], v[176:179], v[108:111]
    v_exp_f32 v181, v181
    v_mfma_f32_16x16x32_bf16 v[112:115], a[136:139], v[176:179], v[112:115]
    v_fma_f32 v183, v147, s25, -v192
    v_fma_f32 v184, v148, s25, -v192
    v_mfma_f32_16x16x32_bf16 v[116:119], a[140:143], v[176:179], v[116:119]
    ds_read_b64_tr_b16 a[128:129], v199 offset:12288
    ds_read_b64_tr_b16 a[130:131], v199 offset:18432
    v_mfma_f32_16x16x32_bf16 v[120:123], a[144:147], v[176:179], v[120:123]
    v_exp_f32 v182, v182
    v_mfma_f32_16x16x32_bf16 v[124:127], a[148:151], v[176:179], v[124:127]
    ds_read_b64_tr_b16 a[132:133], v200 offset:12288
    ds_read_b64_tr_b16 a[134:135], v200 offset:18432
    v_mfma_f32_16x16x32_bf16 v[128:131], a[152:155], v[176:179], v[128:131]
    v_exp_f32 v183, v183
    v_mfma_f32_16x16x32_bf16 v[132:135], a[156:159], v[176:179], v[132:135]
    v_fma_f32 v185, v149, s25, -v192
    v_cvt_pk_bf16_f32 v168, v180, v181
    v_mfma_f32_16x16x32_bf16 v[136:139], a[160:163], v[176:179], v[136:139]
    ds_read_b64_tr_b16 a[136:137], v197 offset:12416
    ds_read_b64_tr_b16 a[138:139], v197 offset:18560
    v_mfma_f32_16x16x32_bf16 v[140:143], a[164:167], v[176:179], v[140:143]
    v_exp_f32 v184, v184
    v_mfma_f32_16x16x32_bf16 v[152:155], a[72:75], a[24:27], 0
    s_cmp_eq_u32 s20, 13
    ds_read_b64_tr_b16 a[140:141], v198 offset:12416
    ds_read_b64_tr_b16 a[142:143], v198 offset:18560
    v_mfma_f32_16x16x32_bf16 v[152:155], a[76:79], a[28:31], v[152:155]
    s_cselect_b32 s34, s32, 12288
    v_fma_f32 v186, v150, s25, -v192
    v_cvt_pk_bf16_f32 v169, v182, v183
    v_mfma_f32_16x16x32_bf16 v[152:155], a[80:83], a[32:35], v[152:155]
    s_add_u32 s21, s21, s34
    v_exp_f32 v185, v185
    v_mfma_f32_16x16x32_bf16 v[152:155], a[84:87], a[36:39], v[152:155]
    ds_read_b64_tr_b16 a[144:145], v199 offset:12416
    ds_read_b64_tr_b16 a[146:147], v199 offset:18560
    v_mfma_f32_16x16x32_bf16 v[152:155], a[88:91], a[40:43], v[152:155]
    v_exp_f32 v186, v186
    v_mfma_f32_16x16x32_bf16 v[152:155], a[92:95], a[44:47], v[152:155]
    ds_read_b64_tr_b16 a[148:149], v200 offset:12416
    ds_read_b64_tr_b16 a[150:151], v200 offset:18560
    v_mfma_f32_16x16x32_bf16 v[156:159], a[96:99], a[24:27], 0
    v_fma_f32 v187, v151, s25, -v192
    v_cvt_pk_bf16_f32 v170, v184, v185
    v_mfma_f32_16x16x32_bf16 v[156:159], a[100:103], a[28:31], v[156:159]
    ds_read_b64_tr_b16 a[152:153], v197 offset:12544
    ds_read_b64_tr_b16 a[154:155], v197 offset:18688
    v_mfma_f32_16x16x32_bf16 v[156:159], a[104:107], a[32:35], v[156:159]
    v_exp_f32 v187, v187
    v_mfma_f32_16x16x32_bf16 v[156:159], a[108:111], a[36:39], v[156:159]
    ds_read_b64_tr_b16 a[156:157], v198 offset:12544
    ds_read_b64_tr_b16 a[158:159], v198 offset:18688
    v_mfma_f32_16x16x32_bf16 v[156:159], a[112:115], a[40:43], v[156:159]
    v_cvt_pk_bf16_f32 v171, v186, v187
    v_mfma_f32_16x16x32_bf16 v[156:159], a[116:119], a[44:47], v[156:159]
    ds_read_b64_tr_b16 a[160:161], v199 offset:12544
    ds_read_b64_tr_b16 a[162:163], v199 offset:18688
    v_mfma_f32_16x16x32_bf16 v[232:235], a[216:219], v[168:171], v[232:235]
    s_waitcnt lgkmcnt(6)
    v_fma_f32 v180, v152, s25, -v193
    v_fma_f32 v181, v153, s25, -v193
    v_mfma_f32_16x16x32_bf16 v[0:3], a[120:123], v[168:171], v[0:3]
    ds_read_b64_tr_b16 a[164:165], v200 offset:12544
    ds_read_b64_tr_b16 a[166:167], v200 offset:18688
    v_mfma_f32_16x16x32_bf16 v[4:7], a[124:127], v[168:171], v[4:7]
    v_exp_f32 v180, v180
    v_mfma_f32_16x16x32_bf16 v[8:11], a[128:131], v[168:171], v[8:11]
    v_fma_f32 v182, v154, s25, -v193
    v_fma_f32 v183, v155, s25, -v193
    v_mfma_f32_16x16x32_bf16 v[12:15], a[132:135], v[168:171], v[12:15]
    v_exp_f32 v181, v181
    v_mfma_f32_16x16x32_bf16 v[16:19], a[136:139], v[168:171], v[16:19]
    s_add_u32 m0, s30, 12288
    v_exp_f32 v182, v182
    v_mfma_f32_16x16x32_bf16 v[20:23], a[140:143], v[168:171], v[20:23]
    v_fma_f32 v184, v156, s25, -v193
    v_cvt_pk_bf16_f32 v172, v180, v181
    v_mfma_f32_16x16x32_bf16 v[24:27], a[144:147], v[168:171], v[24:27]
    v_exp_f32 v183, v183
    v_mfma_f32_16x16x32_bf16 v[28:31], a[148:151], v[168:171], v[28:31]
    s_waitcnt lgkmcnt(0)
    v_fma_f32 v185, v157, s25, -v193
    v_fma_f32 v186, v158, s25, -v193
    v_mfma_f32_16x16x32_bf16 v[32:35], a[152:155], v[168:171], v[32:35]
    s_waitcnt vmcnt(10) lgkmcnt(0)
    v_exp_f32 v184, v184
    v_mfma_f32_16x16x32_bf16 v[36:39], a[156:159], v[168:171], v[36:39]
    s_barrier
    v_mfma_f32_16x16x32_bf16 v[40:43], a[160:163], v[168:171], v[40:43]
    v_mfma_f32_16x16x32_bf16 v[44:47], a[164:167], v[168:171], v[44:47]
    s_nop 0
    buffer_load_dwordx4 v204, s[8:11], s21 offen offset:0 nt lds
    v_mfma_f32_16x16x32_bf16 v[160:163], a[72:75], a[48:51], 0
    v_exp_f32 v185, v185
    v_mfma_f32_16x16x32_bf16 v[160:163], a[76:79], a[52:55], v[160:163]
    ds_read_b128 a[72:75], v195 offset:24576
    v_fma_f32 v187, v159, s25, -v193
    v_mfma_f32_16x16x32_bf16 v[160:163], a[80:83], a[56:59], v[160:163]
    v_exp_f32 v186, v186
    v_mfma_f32_16x16x32_bf16 v[160:163], a[84:87], a[60:63], v[160:163]
    s_nop 0
    buffer_load_dwordx4 v205, s[8:11], s21 offen offset:1024 nt lds
    v_mfma_f32_16x16x32_bf16 v[160:163], a[88:91], a[64:67], v[160:163]
    ds_read_b128 a[76:79], v196 offset:24576
    v_cvt_pk_bf16_f32 v173, v182, v183
    v_mfma_f32_16x16x32_bf16 v[160:163], a[92:95], a[68:71], v[160:163]
    v_exp_f32 v187, v187
    v_mfma_f32_16x16x32_bf16 v[164:167], a[96:99], a[48:51], 0
    ds_read_b128 a[80:83], v195 offset:24704
    v_cvt_pk_bf16_f32 v174, v184, v185
    v_mfma_f32_16x16x32_bf16 v[164:167], a[100:103], a[52:55], v[164:167]
    s_nop 0
    buffer_load_dwordx4 v206, s[8:11], s21 offen offset:2048 nt lds
    v_mfma_f32_16x16x32_bf16 v[164:167], a[104:107], a[56:59], v[164:167]
    s_add_u32 m0, s30, 49152
    ds_read_b128 a[84:87], v196 offset:24704
    v_cvt_pk_bf16_f32 v175, v186, v187
    v_mfma_f32_16x16x32_bf16 v[164:167], a[108:111], a[60:63], v[164:167]
    ds_read_b128 a[88:91], v195 offset:24832
    ds_read_b128 a[92:95], v196 offset:24832
    v_mfma_f32_16x16x32_bf16 v[164:167], a[112:115], a[64:67], v[164:167]
    s_nop 0
    buffer_load_dwordx4 v201, s[4:7], s21 offen offset:0 nt lds
    v_mfma_f32_16x16x32_bf16 v[164:167], a[116:119], a[68:71], v[164:167]
    v_mfma_f32_16x16x32_bf16 v[236:239], a[216:219], v[172:175], v[236:239]
    ds_read_b128 a[96:99], v195 offset:30720
    v_fma_f32 v180, v160, s25, -v194
    v_mfma_f32_16x16x32_bf16 v[48:51], a[120:123], v[172:175], v[48:51]
    v_fma_f32 v181, v161, s25, -v194
    v_fma_f32 v182, v162, s25, -v194
    v_mfma_f32_16x16x32_bf16 v[52:55], a[124:127], v[172:175], v[52:55]
    ds_read_b128 a[100:103], v196 offset:30720
    v_fma_f32 v183, v163, s25, -v194
    v_mfma_f32_16x16x32_bf16 v[56:59], a[128:131], v[172:175], v[56:59]
    s_add_u32 s51, s51, s50
    buffer_load_dwordx4 v202, s[4:7], s21 offen offset:1024 nt lds
    v_mfma_f32_16x16x32_bf16 v[60:63], a[132:135], v[172:175], v[60:63]
    s_add_u32 s52, s52, s50
    v_exp_f32 v180, v180
    v_mfma_f32_16x16x32_bf16 v[64:67], a[136:139], v[172:175], v[64:67]
    s_bitcmp1_b32 s36, s20
    ds_read_b128 a[104:107], v195 offset:30848
    v_fma_f32 v184, v164, s25, -v194
    v_mfma_f32_16x16x32_bf16 v[68:71], a[140:143], v[172:175], v[68:71]
    s_cselect_b32 s14, s54, 0
    v_exp_f32 v181, v181
    v_mfma_f32_16x16x32_bf16 v[72:75], a[144:147], v[172:175], v[72:75]
    s_cselect_b32 s50, 1024, 0
    buffer_load_dwordx4 v203, s[4:7], s21 offen offset:2048 nt lds
    v_mfma_f32_16x16x32_bf16 v[76:79], a[148:151], v[172:175], v[76:79]
    s_cselect_b32 m0, s52, 147456
    ds_read_b128 a[108:111], v196 offset:30848
    v_fma_f32 v185, v165, s25, -v194
    v_mfma_f32_16x16x32_bf16 v[80:83], a[152:155], v[172:175], v[80:83]
    v_exp_f32 v182, v182
    v_mfma_f32_16x16x32_bf16 v[84:87], a[156:159], v[172:175], v[84:87]
    ds_read_b128 a[112:115], v195 offset:30976
    v_cvt_pk_bf16_f32 v176, v180, v181
    v_mfma_f32_16x16x32_bf16 v[88:91], a[160:163], v[172:175], v[88:91]
    s_add_u32 s20, s20, 1
    buffer_load_dwordx4 v207, s[12:15], s51 offen offset:0 nt lds
    v_mfma_f32_16x16x32_bf16 v[92:95], a[164:167], v[172:175], v[92:95]
    s_waitcnt lgkmcnt(2)
    ds_read_b128 a[116:119], v196 offset:30976
    v_fma_f32 v186, v166, s25, -v194
    v_mfma_f32_16x16x32_bf16 v[144:147], a[72:75], a[0:3], 0
    s_add_u32 s51, s51, s50
    v_exp_f32 v183, v183
    v_mfma_f32_16x16x32_bf16 v[144:147], a[76:79], a[4:7], v[144:147]
    s_add_u32 s52, s52, s50
    v_exp_f32 v184, v184
    v_mfma_f32_16x16x32_bf16 v[144:147], a[80:83], a[8:11], v[144:147]
    s_bitcmp1_b32 s33, s20
    v_fma_f32 v187, v167, s25, -v194
    v_mfma_f32_16x16x32_bf16 v[144:147], a[84:87], a[12:15], v[144:147]
    s_cselect_b32 s14, s54, 0
    v_exp_f32 v185, v185
    v_mfma_f32_16x16x32_bf16 v[144:147], a[88:91], a[16:19], v[144:147]
    s_cselect_b32 s50, 1024, 0
    v_cvt_pk_bf16_f32 v177, v182, v183
    v_mfma_f32_16x16x32_bf16 v[144:147], a[92:95], a[20:23], v[144:147]
    s_cselect_b32 m0, s52, 147456
    v_exp_f32 v186, v186
    v_mfma_f32_16x16x32_bf16 v[148:151], a[96:99], a[0:3], 0
    v_cvt_pk_bf16_f32 v178, v184, v185
    v_mfma_f32_16x16x32_bf16 v[148:151], a[100:103], a[4:7], v[148:151]
    v_exp_f32 v187, v187
    v_mfma_f32_16x16x32_bf16 v[148:151], a[104:107], a[8:11], v[148:151]
    s_waitcnt lgkmcnt(0)
    v_mfma_f32_16x16x32_bf16 v[148:151], a[108:111], a[12:15], v[148:151]
    v_cvt_pk_bf16_f32 v179, v186, v187
    v_fma_f32 v180, v144, s25, -v192
    v_mfma_f32_16x16x32_bf16 v[148:151], a[112:115], a[16:19], v[148:151]
    s_nop 0
    buffer_load_dwordx4 v207, s[12:15], s51 offen offset:0 nt lds
    v_mfma_f32_16x16x32_bf16 v[148:151], a[116:119], a[20:23], v[148:151]
    v_mfma_f32_16x16x32_bf16 v[240:243], a[216:219], v[176:179], v[240:243]
    v_fma_f32 v181, v145, s25, -v192
    v_fma_f32 v182, v146, s25, -v192
    v_mfma_f32_16x16x32_bf16 v[96:99], a[120:123], v[176:179], v[96:99]
    ds_read_b64_tr_b16 a[120:121], v197 offset:24576
    ds_read_b64_tr_b16 a[122:123], v197 offset:30720
    v_mfma_f32_16x16x32_bf16 v[100:103], a[124:127], v[176:179], v[100:103]
    v_exp_f32 v180, v180
    v_mfma_f32_16x16x32_bf16 v[104:107], a[128:131], v[176:179], v[104:107]
    ds_read_b64_tr_b16 a[124:125], v198 offset:24576
    ds_read_b64_tr_b16 a[126:127], v198 offset:30720
    v_mfma_f32_16x16x32_bf16 v[108:111], a[132:135], v[176:179], v[108:111]
    v_exp_f32 v181, v181
    v_mfma_f32_16x16x32_bf16 v[112:115], a[136:139], v[176:179], v[112:115]
    v_fma_f32 v183, v147, s25, -v192
    v_fma_f32 v184, v148, s25, -v192
    v_mfma_f32_16x16x32_bf16 v[116:119], a[140:143], v[176:179], v[116:119]
    ds_read_b64_tr_b16 a[128:129], v199 offset:24576
    ds_read_b64_tr_b16 a[130:131], v199 offset:30720
    v_mfma_f32_16x16x32_bf16 v[120:123], a[144:147], v[176:179], v[120:123]
    v_exp_f32 v182, v182
    v_mfma_f32_16x16x32_bf16 v[124:127], a[148:151], v[176:179], v[124:127]
    ds_read_b64_tr_b16 a[132:133], v200 offset:24576
    ds_read_b64_tr_b16 a[134:135], v200 offset:30720
    v_mfma_f32_16x16x32_bf16 v[128:131], a[152:155], v[176:179], v[128:131]
    v_exp_f32 v183, v183
    v_mfma_f32_16x16x32_bf16 v[132:135], a[156:159], v[176:179], v[132:135]
    v_fma_f32 v185, v149, s25, -v192
    v_cvt_pk_bf16_f32 v168, v180, v181
    v_mfma_f32_16x16x32_bf16 v[136:139], a[160:163], v[176:179], v[136:139]
    ds_read_b64_tr_b16 a[136:137], v197 offset:24704
    ds_read_b64_tr_b16 a[138:139], v197 offset:30848
    v_mfma_f32_16x16x32_bf16 v[140:143], a[164:167], v[176:179], v[140:143]
    v_exp_f32 v184, v184
    v_mfma_f32_16x16x32_bf16 v[152:155], a[72:75], a[24:27], 0
    s_cmp_eq_u32 s20, 13
    ds_read_b64_tr_b16 a[140:141], v198 offset:24704
    ds_read_b64_tr_b16 a[142:143], v198 offset:30848
    v_mfma_f32_16x16x32_bf16 v[152:155], a[76:79], a[28:31], v[152:155]
    s_cselect_b32 s34, s32, 12288
    v_fma_f32 v186, v150, s25, -v192
    v_cvt_pk_bf16_f32 v169, v182, v183
    v_mfma_f32_16x16x32_bf16 v[152:155], a[80:83], a[32:35], v[152:155]
    s_add_u32 s21, s21, s34
    v_exp_f32 v185, v185
    v_mfma_f32_16x16x32_bf16 v[152:155], a[84:87], a[36:39], v[152:155]
    ds_read_b64_tr_b16 a[144:145], v199 offset:24704
    ds_read_b64_tr_b16 a[146:147], v199 offset:30848
    v_mfma_f32_16x16x32_bf16 v[152:155], a[88:91], a[40:43], v[152:155]
    v_exp_f32 v186, v186
    v_mfma_f32_16x16x32_bf16 v[152:155], a[92:95], a[44:47], v[152:155]
    ds_read_b64_tr_b16 a[148:149], v200 offset:24704
    ds_read_b64_tr_b16 a[150:151], v200 offset:30848
    v_mfma_f32_16x16x32_bf16 v[156:159], a[96:99], a[24:27], 0
    v_fma_f32 v187, v151, s25, -v192
    v_cvt_pk_bf16_f32 v170, v184, v185
    v_mfma_f32_16x16x32_bf16 v[156:159], a[100:103], a[28:31], v[156:159]
    ds_read_b64_tr_b16 a[152:153], v197 offset:24832
    ds_read_b64_tr_b16 a[154:155], v197 offset:30976
    v_mfma_f32_16x16x32_bf16 v[156:159], a[104:107], a[32:35], v[156:159]
    v_exp_f32 v187, v187
    v_mfma_f32_16x16x32_bf16 v[156:159], a[108:111], a[36:39], v[156:159]
    ds_read_b64_tr_b16 a[156:157], v198 offset:24832
    ds_read_b64_tr_b16 a[158:159], v198 offset:30976
    v_mfma_f32_16x16x32_bf16 v[156:159], a[112:115], a[40:43], v[156:159]
    v_cvt_pk_bf16_f32 v171, v186, v187
    v_mfma_f32_16x16x32_bf16 v[156:159], a[116:119], a[44:47], v[156:159]
    ds_read_b64_tr_b16 a[160:161], v199 offset:24832
    ds_read_b64_tr_b16 a[162:163], v199 offset:30976
L_g0_0:
    v_mfma_f32_16x16x32_bf16 v[232:235], a[216:219], v[168:171], v[232:235]
    s_waitcnt lgkmcnt(6)
    v_fma_f32 v180, v152, s25, -v193
    v_fma_f32 v181, v153, s25, -v193
    v_mfma_f32_16x16x32_bf16 v[0:3], a[120:123], v[168:171], v[0:3]
    ds_read_b64_tr_b16 a[164:165], v200 offset:24832
    ds_read_b64_tr_b16 a[166:167], v200 offset:30976
    v_mfma_f32_16x16x32_bf16 v[4:7], a[124:127], v[168:171], v[4:7]
    v_exp_f32 v180, v180
    v_mfma_f32_16x16x32_bf16 v[8:11], a[128:131], v[168:171], v[8:11]
    v_fma_f32 v182, v154, s25, -v193
    v_fma_f32 v183, v155, s25, -v193
    v_mfma_f32_16x16x32_bf16 v[12:15], a[132:135], v[168:171], v[12:15]
    v_exp_f32 v181, v181
    v_mfma_f32_16x16x32_bf16 v[16:19], a[136:139], v[168:171], v[16:19]
    s_add_u32 m0, s30, 24576
    v_exp_f32 v182, v182
    v_mfma_f32_16x16x32_bf16 v[20:23], a[140:143], v[168:171], v[20:23]
    v_fma_f32 v184, v156, s25, -v193
    v_cvt_pk_bf16_f32 v172, v180, v181
    v_mfma_f32_16x16x32_bf16 v[24:27], a[144:147], v[168:171], v[24:27]
    v_exp_f32 v183, v183
    v_mfma_f32_16x16x32_bf16 v[28:31], a[148:151], v[168:171], v[28:31]
    s_waitcnt lgkmcnt(0)
    v_fma_f32 v185, v157, s25, -v193
    v_fma_f32 v186, v158, s25, -v193
    v_mfma_f32_16x16x32_bf16 v[32:35], a[152:155], v[168:171], v[32:35]
    s_waitcnt vmcnt(10) lgkmcnt(0)
    v_exp_f32 v184, v184
    v_mfma_f32_16x16x32_bf16 v[36:39], a[156:159], v[168:171], v[36:39]
    s_barrier
    v_mfma_f32_16x16x32_bf16 v[40:43], a[160:163], v[168:171], v[40:43]
    v_mfma_f32_16x16x32_bf16 v[44:47], a[164:167], v[168:171], v[44:47]
    s_nop 0
    buffer_load_dwordx4 v204, s[8:11], s21 offen offset:0 nt lds
    v_mfma_f32_16x16x32_bf16 v[160:163], a[72:75], a[48:51], 0
    v_exp_f32 v185, v185
    v_mfma_f32_16x16x32_bf16 v[160:163], a[76:79], a[52:55], v[160:163]
    ds_read_b128 a[72:75], v195 offset:0
    v_fma_f32 v187, v159, s25, -v193
    v_mfma_f32_16x16x32_bf16 v[160:163], a[80:83], a[56:59], v[160:163]
    v_exp_f32 v186, v186
    v_mfma_f32_16x16x32_bf16 v[160:163], a[84:87], a[60:63], v[160:163]
    s_nop 0
    buffer_load_dwordx4 v205, s[8:11], s21 offen offset:1024 nt lds
    v_mfma_f32_16x16x32_bf16 v[160:163], a[88:91], a[64:67], v[160:163]
    ds_read_b128 a[76:79], v196 offset:0
    v_cvt_pk_bf16_f32 v173, v182, v183
    v_mfma_f32_16x16x32_bf16 v[160:163], a[92:95], a[68:71], v[160:163]
    v_exp_f32 v187, v187
    v_mfma_f32_16x16x32_bf16 v[164:167], a[96:99], a[48:51], 0
    ds_read_b128 a[80:83], v195 offset:128
    v_cvt_pk_bf16_f32 v174, v184, v185
    v_mfma_f32_16x16x32_bf16 v[164:167], a[100:103], a[52:55], v[164:167]
    s_nop 0
    buffer_load_dwordx4 v206, s[8:11], s21 offen offset:2048 nt lds
    v_mfma_f32_16x16x32_bf16 v[164:167], a[104:107], a[56:59], v[164:167]
    s_add_u32 m0, s30, 61440
    ds_read_b128 a[84:87], v196 offset:128
    v_cvt_pk_bf16_f32 v175, v186, v187
    v_mfma_f32_16x16x32_bf16 v[164:167], a[108:111], a[60:63], v[164:167]
    ds_read_b128 a[88:91], v195 offset:256
    ds_read_b128 a[92:95], v196 offset:256
    v_mfma_f32_16x16x32_bf16 v[164:167], a[112:115], a[64:67], v[164:167]
    s_nop 0
    buffer_load_dwordx4 v201, s[4:7], s21 offen offset:0 nt lds
    v_mfma_f32_16x16x32_bf16 v[164:167], a[116:119], a[68:71], v[164:167]
    v_mfma_f32_16x16x32_bf16 v[236:239], a[216:219], v[172:175], v[236:239]
    ds_read_b128 a[96:99], v195 offset:6144
    v_fma_f32 v180, v160, s25, -v194
    v_mfma_f32_16x16x32_bf16 v[48:51], a[120:123], v[172:175], v[48:51]
    v_fma_f32 v181, v161, s25, -v194
    v_fma_f32 v182, v162, s25, -v194
    v_mfma_f32_16x16x32_bf16 v[52:55], a[124:127], v[172:175], v[52:55]
    ds_read_b128 a[100:103], v196 offset:6144
    v_fma_f32 v183, v163, s25, -v194
    v_mfma_f32_16x16x32_bf16 v[56:59], a[128:131], v[172:175], v[56:59]
    s_add_u32 s51, s51, s50
    buffer_load_dwordx4 v202, s[4:7], s21 offen offset:1024 nt lds
    v_mfma_f32_16x16x32_bf16 v[60:63], a[132:135], v[172:175], v[60:63]
    s_add_u32 s52, s52, s50
    v_exp_f32 v180, v180
    v_mfma_f32_16x16x32_bf16 v[64:67], a[136:139], v[172:175], v[64:67]
    s_bitcmp1_b32 s36, s20
    ds_read_b128 a[104:107], v195 offset:6272
    v_fma_f32 v184, v164, s25, -v194
    v_mfma_f32_16x16x32_bf16 v[68:71], a[140:143], v[172:175], v[68:71]
    s_cselect_b32 s14, s54, 0
    v_exp_f32 v181, v181
    v_mfma_f32_16x16x32_bf16 v[72:75], a[144:147], v[172:175], v[72:75]
    s_cselect_b32 s50, 1024, 0
    buffer_load_dwordx4 v203, s[4:7], s21 offen offset:2048 nt lds
    v_mfma_f32_16x16x32_bf16 v[76:79], a[148:151], v[172:175], v[76:79]
    s_cselect_b32 m0, s52, 147456
    ds_read_b128 a[108:111], v196 offset:6272
    v_fma_f32 v185, v165, s25, -v194
    v_mfma_f32_16x16x32_bf16 v[80:83], a[152:155], v[172:175], v[80:83]
    v_exp_f32 v182, v182
    v_mfma_f32_16x16x32_bf16 v[84:87], a[156:159], v[172:175], v[84:87]
    ds_read_b128 a[112:115], v195 offset:6400
    v_cvt_pk_bf16_f32 v176, v180, v181
    v_mfma_f32_16x16x32_bf16 v[88:91], a[160:163], v[172:175], v[88:91]
    s_add_u32 s20, s20, 1
    buffer_load_dwordx4 v207, s[12:15], s51 offen offset:0 nt lds
    v_mfma_f32_16x16x32_bf16 v[92:95], a[164:167], v[172:175], v[92:95]
    s_waitcnt lgkmcnt(2)
    ds_read_b128 a[116:119], v196 offset:6400
    v_fma_f32 v186, v166, s25, -v194
    v_mfma_f32_16x16x32_bf16 v[144:147], a[72:75], a[0:3], 0
    s_add_u32 s51, s51, s50
    v_exp_f32 v183, v183
    v_mfma_f32_16x16x32_bf16 v[144:147], a[76:79], a[4:7], v[144:147]
    s_add_u32 s52, s52, s50
    v_exp_f32 v184, v184
    v_mfma_f32_16x16x32_bf16 v[144:147], a[80:83], a[8:11], v[144:147]
    s_bitcmp1_b32 s33, s20
    v_fma_f32 v187, v167, s25, -v194
    v_mfma_f32_16x16x32_bf16 v[144:147], a[84:87], a[12:15], v[144:147]
    s_cselect_b32 s14, s54, 0
    v_exp_f32 v185, v185
    v_mfma_f32_16x16x32_bf16 v[144:147], a[88:91], a[16:19], v[144:147]
    s_cselect_b32 s50, 1024, 0
    v_cvt_pk_bf16_f32 v177, v182, v183
    v_mfma_f32_16x16x32_bf16 v[144:147], a[92:95], a[20:23], v[144:147]
    s_cselect_b32 m0, s52, 147456
    v_exp_f32 v186, v186
    v_mfma_f32_16x16x32_bf16 v[148:151], a[96:99], a[0:3], 0
    v_cvt_pk_bf16_f32 v178, v184, v185
    v_mfma_f32_16x16x32_bf16 v[148:151], a[100:103], a[4:7], v[148:151]
    v_exp_f32 v187, v187
    v_mfma_f32_16x16x32_bf16 v[148:151], a[104:107], a[8:11], v[148:151]
    s_waitcnt lgkmcnt(0)
    v_mfma_f32_16x16x32_bf16 v[148:151], a[108:111], a[12:15], v[148:151]
    v_cvt_pk_bf16_f32 v179, v186, v187
    v_fma_f32 v180, v144, s25, -v192
    v_mfma_f32_16x16x32_bf16 v[148:151], a[112:115], a[16:19], v[148:151]
    s_nop 0
    buffer_load_dwordx4 v207, s[12:15], s51 offen offset:0 nt lds
    v_mfma_f32_16x16x32_bf16 v[148:151], a[116:119], a[20:23], v[148:151]
    v_mfma_f32_16x16x32_bf16 v[240:243], a[216:219], v[176:179], v[240:243]
    v_fma_f32 v181, v145, s25, -v192
    v_fma_f32 v182, v146, s25, -v192
    v_mfma_f32_16x16x32_bf16 v[96:99], a[120:123], v[176:179], v[96:99]
    ds_read_b64_tr_b16 a[120:121], v197 offset:0
    ds_read_b64_tr_b16 a[122:123], v197 offset:6144
    v_mfma_f32_16x16x32_bf16 v[100:103], a[124:127], v[176:179], v[100:103]
    v_exp_f32 v180, v180
    v_mfma_f32_16x16x32_bf16 v[104:107], a[128:131], v[176:179], v[104:107]
    ds_read_b64_tr_b16 a[124:125], v198 offset:0
    ds_read_b64_tr_b16 a[126:127], v198 offset:6144
    v_mfma_f32_16x16x32_bf16 v[108:111], a[132:135], v[176:179], v[108:111]
    v_exp_f32 v181, v181
    v_mfma_f32_16x16x32_bf16 v[112:115], a[136:139], v[176:179], v[112:115]
    v_fma_f32 v183, v147, s25, -v192
    v_fma_f32 v184, v148, s25, -v192
    v_mfma_f32_16x16x32_bf16 v[116:119], a[140:143], v[176:179], v[116:119]
    ds_read_b64_tr_b16 a[128:129], v199 offset:0
    ds_read_b64_tr_b16 a[130:131], v199 offset:6144
    v_mfma_f32_16x16x32_bf16 v[120:123], a[144:147], v[176:179], v[120:123]
    v_exp_f32 v182, v182
    v_mfma_f32_16x16x32_bf16 v[124:127], a[148:151], v[176:179], v[124:127]
    ds_read_b64_tr_b16 a[132:133], v200 offset:0
    ds_read_b64_tr_b16 a[134:135], v200 offset:6144
    v_mfma_f32_16x16x32_bf16 v[128:131], a[152:155], v[176:179], v[128:131]
    v_exp_f32 v183, v183
    v_mfma_f32_16x16x32_bf16 v[132:135], a[156:159], v[176:179], v[132:135]
    v_fma_f32 v185, v149, s25, -v192
    v_cvt_pk_bf16_f32 v168, v180, v181
    v_mfma_f32_16x16x32_bf16 v[136:139], a[160:163], v[176:179], v[136:139]
    ds_read_b64_tr_b16 a[136:137], v197 offset:128
    ds_read_b64_tr_b16 a[138:139], v197 offset:6272
    v_mfma_f32_16x16x32_bf16 v[140:143], a[164:167], v[176:179], v[140:143]
    v_exp_f32 v184, v184
    v_mfma_f32_16x16x32_bf16 v[152:155], a[72:75], a[24:27], 0
    s_cmp_eq_u32 s20, 13
    ds_read_b64_tr_b16 a[140:141], v198 offset:128
    ds_read_b64_tr_b16 a[142:143], v198 offset:6272
    v_mfma_f32_16x16x32_bf16 v[152:155], a[76:79], a[28:31], v[152:155]
    s_cselect_b32 s34, s32, 12288
    v_fma_f32 v186, v150, s25, -v192
    v_cvt_pk_bf16_f32 v169, v182, v183
    v_mfma_f32_16x16x32_bf16 v[152:155], a[80:83], a[32:35], v[152:155]
    s_add_u32 s21, s21, s34
    v_exp_f32 v185, v185
    v_mfma_f32_16x16x32_bf16 v[152:155], a[84:87], a[36:39], v[152:155]
    ds_read_b64_tr_b16 a[144:145], v199 offset:128
    ds_read_b64_tr_b16 a[146:147], v199 offset:6272
    v_mfma_f32_16x16x32_bf16 v[152:155], a[88:91], a[40:43], v[152:155]
    v_exp_f32 v186, v186
    v_mfma_f32_16x16x32_bf16 v[152:155], a[92:95], a[44:47], v[152:155]
    ds_read_b64_tr_b16 a[148:149], v200 offset:128
    ds_read_b64_tr_b16 a[150:151], v200 offset:6272
    v_mfma_f32_16x16x32_bf16 v[156:159], a[96:99], a[24:27], 0
    v_fma_f32 v187, v151, s25, -v192
    v_cvt_pk_bf16_f32 v170, v184, v185
    v_mfma_f32_16x16x32_bf16 v[156:159], a[100:103], a[28:31], v[156:159]
    ds_read_b64_tr_b16 a[152:153], v197 offset:256
    ds_read_b64_tr_b16 a[154:155], v197 offset:6400
    v_mfma_f32_16x16x32_bf16 v[156:159], a[104:107], a[32:35], v[156:159]
    v_exp_f32 v187, v187
    v_mfma_f32_16x16x32_bf16 v[156:159], a[108:111], a[36:39], v[156:159]
    ds_read_b64_tr_b16 a[156:157], v198 offset:256
    ds_read_b64_tr_b16 a[158:159], v198 offset:6400
    v_mfma_f32_16x16x32_bf16 v[156:159], a[112:115], a[40:43], v[156:159]
    v_cvt_pk_bf16_f32 v171, v186, v187
    v_mfma_f32_16x16x32_bf16 v[156:159], a[116:119], a[44:47], v[156:159]
    ds_read_b64_tr_b16 a[160:161], v199 offset:256
    ds_read_b64_tr_b16 a[162:163], v199 offset:6400
    v_mfma_f32_16x16x32_bf16 v[232:235], a[216:219], v[168:171], v[232:235]
    s_waitcnt lgkmcnt(6)
    v_fma_f32 v180, v152, s25, -v193
    v_fma_f32 v181, v153, s25, -v193
    v_mfma_f32_16x16x32_bf16 v[0:3], a[120:123], v[168:171], v[0:3]
    ds_read_b64_tr_b16 a[164:165], v200 offset:256
    ds_read_b64_tr_b16 a[166:167], v200 offset:6400
    v_mfma_f32_16x16x32_bf16 v[4:7], a[124:127], v[168:171], v[4:7]
    v_exp_f32 v180, v180
    v_mfma_f32_16x16x32_bf16 v[8:11], a[128:131], v[168:171], v[8:11]
    v_fma_f32 v182, v154, s25, -v193
    v_fma_f32 v183, v155, s25, -v193
    v_mfma_f32_16x16x32_bf16 v[12:15], a[132:135], v[168:171], v[12:15]
    v_exp_f32 v181, v181
    v_mfma_f32_16x16x32_bf16 v[16:19], a[136:139], v[168:171], v[16:19]
    s_add_u32 m0, s30, 0
    v_exp_f32 v182, v182
    v_mfma_f32_16x16x32_bf16 v[20:23], a[140:143], v[168:171], v[20:23]
    v_fma_f32 v184, v156, s25, -v193
    v_cvt_pk_bf16_f32 v172, v180, v181
    v_mfma_f32_16x16x32_bf16 v[24:27], a[144:147], v[168:171], v[24:27]
    v_exp_f32 v183, v183
    v_mfma_f32_16x16x32_bf16 v[28:31], a[148:151], v[168:171], v[28:31]
    s_waitcnt lgkmcnt(0)
    v_fma_f32 v185, v157, s25, -v193
    v_fma_f32 v186, v158, s25, -v193
    v_mfma_f32_16x16x32_bf16 v[32:35], a[152:155], v[168:171], v[32:35]
    s_waitcnt vmcnt(10) lgkmcnt(0)
    v_exp_f32 v184, v184
    v_mfma_f32_16x16x32_bf16 v[36:39], a[156:159], v[168:171], v[36:39]
    s_barrier
    v_mfma_f32_16x16x32_bf16 v[40:43], a[160:163], v[168:171], v[40:43]
    v_mfma_f32_16x16x32_bf16 v[44:47], a[164:167], v[168:171], v[44:47]
    s_nop 0
    buffer_load_dwordx4 v204, s[8:11], s21 offen offset:0 nt lds
    v_mfma_f32_16x16x32_bf16 v[160:163], a[72:75], a[48:51], 0
    v_exp_f32 v185, v185
    v_mfma_f32_16x16x32_bf16 v[160:163], a[76:79], a[52:55], v[160:163]
    ds_read_b128 a[72:75], v195 offset:12288
    v_fma_f32 v187, v159, s25, -v193
    v_mfma_f32_16x16x32_bf16 v[160:163], a[80:83], a[56:59], v[160:163]
    v_exp_f32 v186, v186
    v_mfma_f32_16x16x32_bf16 v[160:163], a[84:87], a[60:63], v[160:163]
    s_nop 0
    buffer_load_dwordx4 v205, s[8:11], s21 offen offset:1024 nt lds
    v_mfma_f32_16x16x32_bf16 v[160:163], a[88:91], a[64:67], v[160:163]
    ds_read_b128 a[76:79], v196 offset:12288
    v_cvt_pk_bf16_f32 v173, v182, v183
    v_mfma_f32_16x16x32_bf16 v[160:163], a[92:95], a[68:71], v[160:163]
    v_exp_f32 v187, v187
    v_mfma_f32_16x16x32_bf16 v[164:167], a[96:99], a[48:51], 0
    ds_read_b128 a[80:83], v195 offset:12416
    v_cvt_pk_bf16_f32 v174, v184, v185
    v_mfma_f32_16x16x32_bf16 v[164:167], a[100:103], a[52:55], v[164:167]
    s_nop 0
    buffer_load_dwordx4 v206, s[8:11], s21 offen offset:2048 nt lds
    v_mfma_f32_16x16x32_bf16 v[164:167], a[104:107], a[56:59], v[164:167]
    s_add_u32 m0, s30, 36864
    ds_read_b128 a[84:87], v196 offset:12416
    v_cvt_pk_bf16_f32 v175, v186, v187
    v_mfma_f32_16x16x32_bf16 v[164:167], a[108:111], a[60:63], v[164:167]
    ds_read_b128 a[88:91], v195 offset:12544
    ds_read_b128 a[92:95], v196 offset:12544
    v_mfma_f32_16x16x32_bf16 v[164:167], a[112:115], a[64:67], v[164:167]
    s_cmp_lg_u32 s20, s47
    buffer_load_dwordx4 v201, s[4:7], s21 offen offset:0 nt lds
    v_mfma_f32_16x16x32_bf16 v[164:167], a[116:119], a[68:71], v[164:167]
    s_cbranch_scc1 L_loop0
L_T:
    v_mfma_f32_16x16x32_bf16 v[236:239], a[216:219], v[172:175], v[236:239]
    s_waitcnt vmcnt(37)
    ds_read_b128 a[96:99], v195 offset:18432
    ds_read_b128 a[0:3], v210 offset:0
    v_fma_f32 v180, v160, s25, -v194
    v_mfma_f32_16x16x32_bf16 v[48:51], a[120:123], v[172:175], v[48:51]
    ds_read_b128 a[4:7], v211 offset:0
    v_fma_f32 v181, v161, s25, -v194
    v_fma_f32 v182, v162, s25, -v194
    v_mfma_f32_16x16x32_bf16 v[52:55], a[124:127], v[172:175], v[52:55]
    ds_read_b128 a[100:103], v196 offset:18432
    ds_read_b128 a[8:11], v212 offset:0
    v_fma_f32 v183, v163, s25, -v194
    v_max_u32 v188, v188, v232
    v_rcp_f32 v232, v232
    v_mfma_f32_16x16x32_bf16 v[56:59], a[128:131], v[172:175], v[56:59]
    s_nop 0
    buffer_load_dwordx4 v202, s[4:7], s21 offen offset:1024 nt lds
    ds_read_b128 a[12:15], v213 offset:0
    v_pk_mul_f32 v[0:1], v[0:1], v[232:233] op_sel_hi:[1,0]
    v_pk_mul_f32 v[2:3], v[2:3], v[232:233] op_sel_hi:[1,0]
    v_pk_mul_f32 v[4:5], v[4:5], v[232:233] op_sel_hi:[1,0]
    v_pk_mul_f32 v[6:7], v[6:7], v[232:233] op_sel_hi:[1,0]
    v_pk_mul_f32 v[8:9], v[8:9], v[232:233] op_sel_hi:[1,0]
    v_pk_mul_f32 v[10:11], v[10:11], v[232:233] op_sel_hi:[1,0]
    v_pk_mul_f32 v[12:13], v[12:13], v[232:233] op_sel_hi:[1,0]
    v_pk_mul_f32 v[14:15], v[14:15], v[232:233] op_sel_hi:[1,0]
    v_mfma_f32_16x16x32_bf16 v[60:63], a[132:135], v[172:175], v[60:63]
    ds_read_b128 a[16:19], v214 offset:0
    v_exp_f32 v180, v180
    v_mfma_f32_16x16x32_bf16 v[64:67], a[136:139], v[172:175], v[64:67]
    ds_read_b128 a[104:107], v195 offset:18560
    ds_read_b128 a[20:23], v215 offset:0
    v_fma_f32 v184, v164, s25, -v194
    v_cvt_pk_bf16_f32 v0, v0, v1
    v_mfma_f32_16x16x32_bf16 v[68:71], a[140:143], v[172:175], v[68:71]
    v_exp_f32 v181, v181
    v_cvt_pk_bf16_f32 v1, v2, v3
    v_mfma_f32_16x16x32_bf16 v[72:75], a[144:147], v[172:175], v[72:75]
    s_nop 0
    buffer_load_dwordx4 v203, s[4:7], s21 offen offset:2048 nt lds
    ds_write_b64 v216, v[0:1] offset:0
    v_cvt_pk_bf16_f32 v4, v4, v5
    v_mfma_f32_16x16x32_bf16 v[76:79], a[148:151], v[172:175], v[76:79]
    ds_read_b128 a[108:111], v196 offset:18560
    v_fma_f32 v185, v165, s25, -v194
    v_cvt_pk_bf16_f32 v5, v6, v7
    s_mov_b32 s14, s54
    s_add_u32 m0, s55, 15360
    s_add_u32 s28, s45, 15360
    v_mfma_f32_16x16x32_bf16 v[80:83], a[152:155], v[172:175], v[80:83]
    ds_write_b64 v217, v[4:5] offset:0
    buffer_load_dwordx4 v207, s[12:15], s28 offen offset:0 nt lds
    v_exp_f32 v182, v182
    v_cvt_pk_bf16_f32 v8, v8, v9
    v_cvt_pk_bf16_f32 v9, v10, v11
    v_mfma_f32_16x16x32_bf16 v[84:87], a[156:159], v[172:175], v[84:87]
    ds_read_b128 a[112:115], v195 offset:18688
    ds_write_b64 v218, v[8:9] offset:0
    v_cvt_pk_bf16_f32 v176, v180, v181
    v_mfma_f32_16x16x32_bf16 v[88:91], a[160:163], v[172:175], v[88:91]
    s_add_u32 s20, s20, 1
    v_cvt_pk_bf16_f32 v12, v12, v13
    v_cvt_pk_bf16_f32 v13, v14, v15
    v_mfma_f32_16x16x32_bf16 v[92:95], a[164:167], v[172:175], v[92:95]
    s_waitcnt lgkmcnt(5)
    ds_read_b128 a[116:119], v196 offset:18688
    ds_write_b64 v219, v[12:13] offset:0
    v_fma_f32 v186, v166, s25, -v194
    v_mfma_f32_16x16x32_bf16 v[144:147], a[72:75], a[0:3], 0
    s_nop 0
    buffer_load_dwordx4 v207, s[12:15], s28 offen offset:1024 nt lds
    v_exp_f32 v183, v183
    v_pk_mul_f32 v[16:17], v[16:17], v[232:233] op_sel_hi:[1,0]
    v_pk_mul_f32 v[18:19], v[18:19], v[232:233] op_sel_hi:[1,0]
    v_pk_mul_f32 v[20:21], v[20:21], v[232:233] op_sel_hi:[1,0]
    v_pk_mul_f32 v[22:23], v[22:23], v[232:233] op_sel_hi:[1,0]
    v_pk_mul_f32 v[24:25], v[24:25], v[232:233] op_sel_hi:[1,0]
    v_pk_mul_f32 v[26:27], v[26:27], v[232:233] op_sel_hi:[1,0]
    v_pk_mul_f32 v[28:29], v[28:29], v[232:233] op_sel_hi:[1,0]
    v_pk_mul_f32 v[30:31], v[30:31], v[232:233] op_sel_hi:[1,0]
    v_mfma_f32_16x16x32_bf16 v[144:147], a[76:79], a[4:7], v[144:147]
    v_exp_f32 v184, v184
    s_mov_b32 s18, s54
    s_add_u32 s53, s44, 3072
    s_add_u32 s27, s31, 25350144
    v_mfma_f32_16x16x32_bf16 v[144:147], a[80:83], a[8:11], v[144:147]
    s_waitcnt vmcnt(17)
    ds_read_b128 a[24:27], v210 offset:6144
    v_fma_f32 v187, v167, s25, -v194
    v_cvt_pk_bf16_f32 v16, v16, v17
    v_mfma_f32_16x16x32_bf16 v[144:147], a[84:87], a[12:15], v[144:147]
    ds_read_b128 a[28:31], v211 offset:6144
    v_exp_f32 v185, v185
    v_cvt_pk_bf16_f32 v17, v18, v19
    v_mfma_f32_16x16x32_bf16 v[144:147], a[88:91], a[16:19], v[144:147]
    ds_read_b128 a[32:35], v212 offset:6144
    ds_write_b64 v220, v[16:17] offset:0
    buffer_load_dwordx4 v207, s[12:15], s28 offen offset:2048 nt lds
    v_cvt_pk_bf16_f32 v177, v182, v183
    v_cvt_pk_bf16_f32 v20, v20, v21
    v_mfma_f32_16x16x32_bf16 v[144:147], a[92:95], a[20:23], v[144:147]
    ds_read_b128 a[36:39], v213 offset:6144
    v_exp_f32 v186, v186
    v_cvt_pk_bf16_f32 v21, v22, v23
    v_mfma_f32_16x16x32_bf16 v[148:151], a[96:99], a[0:3], 0
    ds_read_b128 a[40:43], v214 offset:6144
    ds_write_b64 v221, v[20:21] offset:0
    v_cvt_pk_bf16_f32 v178, v184, v185
    v_cvt_pk_bf16_f32 v24, v24, v25
    v_cvt_pk_bf16_f32 v25, v26, v27
    v_mfma_f32_16x16x32_bf16 v[148:151], a[100:103], a[4:7], v[148:151]
    ds_read_b128 a[44:47], v215 offset:6144
    ds_write_b64 v222, v[24:25] offset:0
    v_exp_f32 v187, v187
    v_mfma_f32_16x16x32_bf16 v[148:151], a[104:107], a[8:11], v[148:151]
    s_waitcnt lgkmcnt(8)
    v_cvt_pk_bf16_f32 v28, v28, v29
    v_cvt_pk_bf16_f32 v29, v30, v31
    v_mfma_f32_16x16x32_bf16 v[148:151], a[108:111], a[12:15], v[148:151]
    ds_write_b64 v223, v[28:29] offset:0
    v_cvt_pk_bf16_f32 v179, v186, v187
    v_mfma_f32_16x16x32_bf16 v[148:151], a[112:115], a[16:19], v[148:151]
    v_pk_mul_f32 v[32:33], v[32:33], v[232:233] op_sel_hi:[1,0]
    v_pk_mul_f32 v[34:35], v[34:35], v[232:233] op_sel_hi:[1,0]
    v_pk_mul_f32 v[36:37], v[36:37], v[232:233] op_sel_hi:[1,0]
    v_pk_mul_f32 v[38:39], v[38:39], v[232:233] op_sel_hi:[1,0]
    v_pk_mul_f32 v[40:41], v[40:41], v[232:233] op_sel_hi:[1,0]
    v_pk_mul_f32 v[42:43], v[42:43], v[232:233] op_sel_hi:[1,0]
    v_pk_mul_f32 v[44:45], v[44:45], v[232:233] op_sel_hi:[1,0]
    v_pk_mul_f32 v[46:47], v[46:47], v[232:233] op_sel_hi:[1,0]
    v_mfma_f32_16x16x32_bf16 v[148:151], a[116:119], a[20:23], v[148:151]
    v_mfma_f32_16x16x32_bf16 v[240:243], a[216:219], v[176:179], v[240:243]
    v_cvt_pk_bf16_f32 v32, v32, v33
    v_mfma_f32_16x16x32_bf16 v[96:99], a[120:123], v[176:179], v[96:99]
    ds_read_b64_tr_b16 a[120:121], v197 offset:12288
    ds_read_b64_tr_b16 a[122:123], v197 offset:18432
    v_max3_f32 v244, v144, v145, v146
    s_nop 1
    v_max3_f32 v244, v244, v147, v148
    v_cvt_pk_bf16_f32 v33, v34, v35
    v_mfma_f32_16x16x32_bf16 v[100:103], a[124:127], v[176:179], v[100:103]
    ds_write_b64 v224, v[32:33] offset:0
    v_max3_f32 v244, v244, v149, v150
    v_max_f32 v244, v244, v151
    v_cvt_pk_bf16_f32 v36, v36, v37
    v_mfma_f32_16x16x32_bf16 v[104:107], a[128:131], v[176:179], v[104:107]
    ds_read_b64_tr_b16 a[124:125], v198 offset:12288
    ds_read_b64_tr_b16 a[126:127], v198 offset:18432
    v_mov_b32 v245, v244
    s_nop 1
    v_permlane32_swap_b32 v244, v245
    v_cvt_pk_bf16_f32 v37, v38, v39
    v_mfma_f32_16x16x32_bf16 v[108:111], a[132:135], v[176:179], v[108:111]
    ds_write_b64 v225, v[36:37] offset:0
    v_max_f32 v244, v244, v245
    v_cvt_pk_bf16_f32 v40, v40, v41
    v_cvt_pk_bf16_f32 v41, v42, v43
    v_mfma_f32_16x16x32_bf16 v[112:115], a[136:139], v[176:179], v[112:115]
    ds_write_b64 v226, v[40:41] offset:0
    v_mov_b32 v245, v244
    s_nop 1
    v_permlane16_swap_b32 v244, v245
    v_add_u32 v208, s55, v207
    v_mfma_f32_16x16x32_bf16 v[116:119], a[140:143], v[176:179], v[116:119]
    ds_read_b64_tr_b16 a[128:129], v199 offset:12288
    ds_read_b64_tr_b16 a[130:131], v199 offset:18432
    v_max_f32 v244, v244, v245
    v_cvt_pk_bf16_f32 v44, v44, v45
    v_cvt_pk_bf16_f32 v45, v46, v47
    v_mfma_f32_16x16x32_bf16 v[120:123], a[144:147], v[176:179], v[120:123]
    ds_write_b64 v227, v[44:45] offset:0
    v_mul_f32 v192, s25, v244
    v_add_f32 v192, 0x41100000, v192
    v_mfma_f32_16x16x32_bf16 v[124:127], a[148:151], v[176:179], v[124:127]
    ds_read_b64_tr_b16 a[132:133], v200 offset:12288
    ds_read_b64_tr_b16 a[134:135], v200 offset:18432
    v_fma_f32 v180, v144, s25, -v192
    v_fma_f32 v181, v145, s25, -v192
    v_max_u32 v188, v188, v236
    v_rcp_f32 v236, v236
    v_mfma_f32_16x16x32_bf16 v[128:131], a[152:155], v[176:179], v[128:131]
    v_exp_f32 v180, v180
    v_pk_mul_f32 v[48:49], v[48:49], v[236:237] op_sel_hi:[1,0]
    v_pk_mul_f32 v[50:51], v[50:51], v[236:237] op_sel_hi:[1,0]
    v_pk_mul_f32 v[52:53], v[52:53], v[236:237] op_sel_hi:[1,0]
    v_pk_mul_f32 v[54:55], v[54:55], v[236:237] op_sel_hi:[1,0]
    v_pk_mul_f32 v[56:57], v[56:57], v[236:237] op_sel_hi:[1,0]
    v_pk_mul_f32 v[58:59], v[58:59], v[236:237] op_sel_hi:[1,0]
    v_pk_mul_f32 v[60:61], v[60:61], v[236:237] op_sel_hi:[1,0]
    v_pk_mul_f32 v[62:63], v[62:63], v[236:237] op_sel_hi:[1,0]
    v_mfma_f32_16x16x32_bf16 v[132:135], a[156:159], v[176:179], v[132:135]
    v_exp_f32 v181, v181
    v_mfma_f32_16x16x32_bf16 v[136:139], a[160:163], v[176:179], v[136:139]
    ds_read_b64_tr_b16 a[136:137], v197 offset:12416
    ds_read_b64_tr_b16 a[138:139], v197 offset:18560
    ds_read_b128 a[168:171], v208 offset:0
    v_fma_f32 v182, v146, s25, -v192
    v_mfma_f32_16x16x32_bf16 v[140:143], a[164:167], v[176:179], v[140:143]
    s_waitcnt lgkmcnt(6)
    ds_read_b128 a[172:175], v208 offset:1024
    v_fma_f32 v183, v147, s25, -v192
    v_exp_f32 v182, v182
    v_cvt_pk_bf16_f32 v48, v48, v49
    v_cvt_pk_bf16_f32 v49, v50, v51
    v_mfma_f32_16x16x32_bf16 v[152:155], a[72:75], a[24:27], 0
    s_cmp_eq_u32 s20, 13
    ds_read_b64_tr_b16 a[140:141], v198 offset:12416
    ds_read_b64_tr_b16 a[142:143], v198 offset:18560
    ds_write_b64 v216, v[48:49] offset:6144
    ds_read_b128 a[176:179], v208 offset:2048
    v_exp_f32 v183, v183
    v_cvt_pk_bf16_f32 v52, v52, v53
    v_mfma_f32_16x16x32_bf16 v[152:155], a[76:79], a[28:31], v[152:155]
    s_cselect_b32 s34, s32, 12288
    v_cvt_pk_bf16_f32 v168, v180, v181
    v_cvt_pk_bf16_f32 v53, v54, v55
    v_mfma_f32_16x16x32_bf16 v[152:155], a[80:83], a[32:35], v[152:155]
    s_add_u32 s21, s21, s34
    ds_write_b64 v217, v[52:53] offset:6144
    v_fma_f32 v184, v148, s25, -v192
    v_fma_f32 v185, v149, s25, -v192
    v_cvt_pk_bf16_f32 v56, v56, v57
    v_mfma_f32_16x16x32_bf16 v[152:155], a[84:87], a[36:39], v[152:155]
    ds_read_b64_tr_b16 a[144:145], v199 offset:12416
    ds_read_b64_tr_b16 a[146:147], v199 offset:18560
    v_exp_f32 v184, v184
    v_cvt_pk_bf16_f32 v57, v58, v59
    v_mfma_f32_16x16x32_bf16 v[152:155], a[88:91], a[40:43], v[152:155]
    ds_write_b64 v218, v[56:57] offset:6144
    v_cvt_pk_bf16_f32 v169, v182, v183
    v_exp_f32 v185, v185
    v_cvt_pk_bf16_f32 v60, v60, v61
    v_cvt_pk_bf16_f32 v61, v62, v63
    v_add_u32 v208, 3072, v208
    v_mfma_f32_16x16x32_bf16 v[152:155], a[92:95], a[44:47], v[152:155]
    ds_read_b64_tr_b16 a[148:149], v200 offset:12416
    ds_read_b64_tr_b16 a[150:151], v200 offset:18560
    ds_write_b64 v219, v[60:61] offset:6144
    v_fma_f32 v186, v150, s25, -v192
    v_mfma_f32_16x16x32_bf16 v[156:159], a[96:99], a[24:27], 0
    s_waitcnt lgkmcnt(7)
    buffer_store_dwordx4 a[168:171], v209, s[16:19], s44 offen offset:0 nt
    v_fma_f32 v187, v151, s25, -v192
    v_exp_f32 v186, v186
    v_pk_mul_f32 v[64:65], v[64:65], v[236:237] op_sel_hi:[1,0]
    v_pk_mul_f32 v[66:67], v[66:67], v[236:237] op_sel_hi:[1,0]
    v_pk_mul_f32 v[68:69], v[68:69], v[236:237] op_sel_hi:[1,0]
    v_pk_mul_f32 v[70:71], v[70:71], v[236:237] op_sel_hi:[1,0]
    v_pk_mul_f32 v[72:73], v[72:73], v[236:237] op_sel_hi:[1,0]
    v_pk_mul_f32 v[74:75], v[74:75], v[236:237] op_sel_hi:[1,0]
    v_pk_mul_f32 v[76:77], v[76:77], v[236:237] op_sel_hi:[1,0]
    v_pk_mul_f32 v[78:79], v[78:79], v[236:237] op_sel_hi:[1,0]
    v_mfma_f32_16x16x32_bf16 v[156:159], a[100:103], a[28:31], v[156:159]
    ds_read_b64_tr_b16 a[152:153], v197 offset:12544
    ds_read_b64_tr_b16 a[154:155], v197 offset:18688
    v_cvt_pk_bf16_f32 v170, v184, v185
    v_mfma_f32_16x16x32_bf16 v[156:159], a[104:107], a[32:35], v[156:159]
    v_exp_f32 v187, v187
    v_mfma_f32_16x16x32_bf16 v[156:159], a[108:111], a[36:39], v[156:159]
    ds_read_b64_tr_b16 a[156:157], v198 offset:12544
    ds_read_b64_tr_b16 a[158:159], v198 offset:18688
    v_cvt_pk_bf16_f32 v171, v186, v187
    v_cvt_pk_bf16_f32 v64, v64, v65
    v_cvt_pk_bf16_f32 v65, v66, v67
    v_mfma_f32_16x16x32_bf16 v[156:159], a[112:115], a[40:43], v[156:159]
    ds_write_b64 v220, v[64:65] offset:6144
    v_mfma_f32_16x16x32_bf16 v[156:159], a[116:119], a[44:47], v[156:159]
    ds_read_b64_tr_b16 a[160:161], v199 offset:12544
    ds_read_b64_tr_b16 a[162:163], v199 offset:18688
    buffer_store_dwordx4 a[172:175], v209, s[16:19], s44 offen offset:1024 nt
    v_cvt_pk_bf16_f32 v68, v68, v69
    v_cvt_pk_bf16_f32 v69, v70, v71
    v_mfma_f32_16x16x32_bf16 v[232:235], a[216:219], v[168:171], 0
    ds_write_b64 v221, v[68:69] offset:6144
    v_mfma_f32_16x16x32_bf16 v[0:3], a[120:123], v[168:171], 0
    ds_read_b64_tr_b16 a[164:165], v200 offset:12544
    ds_read_b64_tr_b16 a[166:167], v200 offset:18688
    v_max3_f32 v244, v152, v153, v154
    v_max3_f32 v244, v244, v155, v156
    v_cvt_pk_bf16_f32 v72, v72, v73
    v_cvt_pk_bf16_f32 v73, v74, v75
    v_mfma_f32_16x16x32_bf16 v[4:7], a[124:127], v[168:171], 0
    ds_write_b64 v222, v[72:73] offset:6144
    v_max3_f32 v244, v244, v157, v158
    v_max_f32 v244, v244, v159
    v_cvt_pk_bf16_f32 v76, v76, v77
    v_mfma_f32_16x16x32_bf16 v[8:11], a[128:131], v[168:171], 0
    v_mov_b32 v245, v244
    s_nop 1
    v_permlane32_swap_b32 v244, v245
    v_cvt_pk_bf16_f32 v77, v78, v79
    v_mfma_f32_16x16x32_bf16 v[12:15], a[132:135], v[168:171], 0
    ds_write_b64 v223, v[76:77] offset:6144
    buffer_store_dwordx4 a[176:179], v209, s[16:19], s44 offen offset:2048 nt
    v_max_f32 v244, v244, v245
    v_pk_mul_f32 v[80:81], v[80:81], v[236:237] op_sel_hi:[1,0]
    v_pk_mul_f32 v[82:83], v[82:83], v[236:237] op_sel_hi:[1,0]
    v_pk_mul_f32 v[84:85], v[84:85], v[236:237] op_sel_hi:[1,0]
    v_pk_mul_f32 v[86:87], v[86:87], v[236:237] op_sel_hi:[1,0]
    v_pk_mul_f32 v[88:89], v[88:89], v[236:237] op_sel_hi:[1,0]
    v_pk_mul_f32 v[90:91], v[90:91], v[236:237] op_sel_hi:[1,0]
    v_pk_mul_f32 v[92:93], v[92:93], v[236:237] op_sel_hi:[1,0]
    v_pk_mul_f32 v[94:95], v[94:95], v[236:237] op_sel_hi:[1,0]
    v_mfma_f32_16x16x32_bf16 v[16:19], a[136:139], v[168:171], 0
    s_waitcnt vmcnt(3)
    s_add_u32 m0, s30, 12288
    ds_read_b128 a[48:51], v210 offset:12288
    v_mov_b32 v245, v244
    s_nop 1
    v_permlane16_swap_b32 v244, v245
    v_mfma_f32_16x16x32_bf16 v[20:23], a[140:143], v[168:171], 0
    s_waitcnt lgkmcnt(5)
    ds_read_b128 a[52:55], v211 offset:12288
    v_max_f32 v244, v244, v245
    v_mfma_f32_16x16x32_bf16 v[24:27], a[144:147], v[168:171], 0
    ds_read_b128 a[56:59], v212 offset:12288
    v_mul_f32 v193, s25, v244
    v_add_f32 v193, 0x41100000, v193
    v_cvt_pk_bf16_f32 v80, v80, v81
    v_mfma_f32_16x16x32_bf16 v[28:31], a[148:151], v[168:171], 0
    ds_read_b128 a[60:63], v213 offset:12288
    v_fma_f32 v180, v152, s25, -v193
    v_fma_f32 v181, v153, s25, -v193
    v_cvt_pk_bf16_f32 v81, v82, v83
    v_mfma_f32_16x16x32_bf16 v[32:35], a[152:155], v[168:171], 0
    ds_read_b128 a[64:67], v214 offset:12288
    ds_write_b64 v224, v[80:81] offset:6144
    v_exp_f32 v180, v180
    v_cvt_pk_bf16_f32 v84, v84, v85
    v_cvt_pk_bf16_f32 v85, v86, v87
    v_mfma_f32_16x16x32_bf16 v[36:39], a[156:159], v[168:171], 0
    s_waitcnt vmcnt(14) lgkmcnt(0)
    ds_read_b128 a[68:71], v215 offset:12288
    ds_write_b64 v225, v[84:85] offset:6144
    v_exp_f32 v181, v181
    v_mfma_f32_16x16x32_bf16 v[40:43], a[160:163], v[168:171], 0
    s_barrier
    v_fma_f32 v182, v154, s25, -v193
    v_cvt_pk_bf16_f32 v88, v88, v89
    v_cvt_pk_bf16_f32 v89, v90, v91
    v_mfma_f32_16x16x32_bf16 v[44:47], a[164:167], v[168:171], 0
    s_nop 0
    buffer_load_dwordx4 v204, s[8:11], s21 offen offset:0 nt lds
    ds_write_b64 v226, v[88:89] offset:6144
    v_fma_f32 v183, v155, s25, -v193
    v_exp_f32 v182, v182
    v_mfma_f32_16x16x32_bf16 v[160:163], a[72:75], a[48:51], 0
    v_exp_f32 v183, v183
    v_cvt_pk_bf16_f32 v92, v92, v93
    v_cvt_pk_bf16_f32 v93, v94, v95
    v_mfma_f32_16x16x32_bf16 v[160:163], a[76:79], a[52:55], v[160:163]
    ds_read_b128 a[72:75], v195 offset:24576
    ds_write_b64 v227, v[92:93] offset:6144
    v_cvt_pk_bf16_f32 v172, v180, v181
    v_mfma_f32_16x16x32_bf16 v[160:163], a[80:83], a[56:59], v[160:163]
    v_fma_f32 v184, v156, s25, -v193
    v_fma_f32 v185, v157, s25, -v193
    v_max_u32 v188, v188, v240
    v_rcp_f32 v240, v240
    v_mfma_f32_16x16x32_bf16 v[160:163], a[84:87], a[60:63], v[160:163]
    s_nop 0
    buffer_load_dwordx4 v205, s[8:11], s21 offen offset:1024 nt lds
    v_exp_f32 v184, v184
    v_pk_mul_f32 v[96:97], v[96:97], v[240:241] op_sel_hi:[1,0]
    v_pk_mul_f32 v[98:99], v[98:99], v[240:241] op_sel_hi:[1,0]
    v_pk_mul_f32 v[100:101], v[100:101], v[240:241] op_sel_hi:[1,0]
    v_pk_mul_f32 v[102:103], v[102:103], v[240:241] op_sel_hi:[1,0]
    v_pk_mul_f32 v[104:105], v[104:105], v[240:241] op_sel_hi:[1,0]
    v_pk_mul_f32 v[106:107], v[106:107], v[240:241] op_sel_hi:[1,0]
    v_pk_mul_f32 v[108:109], v[108:109], v[240:241] op_sel_hi:[1,0]
    v_pk_mul_f32 v[110:111], v[110:111], v[240:241] op_sel_hi:[1,0]
    v_mfma_f32_16x16x32_bf16 v[160:163], a[88:91], a[64:67], v[160:163]
    s_waitcnt lgkmcnt(3)
    ds_read_b128 a[76:79], v196 offset:24576
    v_cvt_pk_bf16_f32 v173, v182, v183
    v_exp_f32 v185, v185
    v_mfma_f32_16x16x32_bf16 v[160:163], a[92:95], a[68:71], v[160:163]
    v_fma_f32 v186, v158, s25, -v193
    v_cvt_pk_bf16_f32 v96, v96, v97
    v_mfma_f32_16x16x32_bf16 v[164:167], a[96:99], a[48:51], 0
    ds_read_b128 a[80:83], v195 offset:24704
    v_fma_f32 v187, v159, s25, -v193
    v_exp_f32 v186, v186
    v_cvt_pk_bf16_f32 v97, v98, v99
    v_mfma_f32_16x16x32_bf16 v[164:167], a[100:103], a[52:55], v[164:167]
    s_nop 0
    buffer_load_dwordx4 v206, s[8:11], s21 offen offset:2048 nt lds
    ds_write_b64 v216, v[96:97] offset:12288
    v_cvt_pk_bf16_f32 v174, v184, v185
    v_cvt_pk_bf16_f32 v100, v100, v101
    v_mfma_f32_16x16x32_bf16 v[164:167], a[104:107], a[56:59], v[164:167]
    s_add_u32 m0, s30, 49152
    ds_read_b128 a[84:87], v196 offset:24704
    v_exp_f32 v187, v187
    v_cvt_pk_bf16_f32 v101, v102, v103
    v_mfma_f32_16x16x32_bf16 v[164:167], a[108:111], a[60:63], v[164:167]
    ds_read_b128 a[88:91], v195 offset:24832
    ds_write_b64 v217, v[100:101] offset:12288
    v_cvt_pk_bf16_f32 v175, v186, v187
    v_cvt_pk_bf16_f32 v104, v104, v105
    v_cvt_pk_bf16_f32 v105, v106, v107
    v_mfma_f32_16x16x32_bf16 v[164:167], a[112:115], a[64:67], v[164:167]
    ds_read_b128 a[92:95], v196 offset:24832
    ds_write_b64 v218, v[104:105] offset:12288
    v_mfma_f32_16x16x32_bf16 v[164:167], a[116:119], a[68:71], v[164:167]
    s_nop 0
    buffer_load_dwordx4 v201, s[4:7], s21 offen offset:0 nt lds
    v_cvt_pk_bf16_f32 v108, v108, v109
    v_cvt_pk_bf16_f32 v109, v110, v111
    v_mfma_f32_16x16x32_bf16 v[236:239], a[216:219], v[172:175], 0
    ds_read_b128 a[96:99], v195 offset:30720
    ds_write_b64 v219, v[108:109] offset:12288
    v_mfma_f32_16x16x32_bf16 v[48:51], a[120:123], v[172:175], 0
    v_max3_f32 v244, v160, v161, v162
    v_max3_f32 v244, v244, v163, v164
    v_pk_mul_f32 v[112:113], v[112:113], v[240:241] op_sel_hi:[1,0]
    v_pk_mul_f32 v[114:115], v[114:115], v[240:241] op_sel_hi:[1,0]
    v_pk_mul_f32 v[116:117], v[116:117], v[240:241] op_sel_hi:[1,0]
    v_pk_mul_f32 v[118:119], v[118:119], v[240:241] op_sel_hi:[1,0]
    v_pk_mul_f32 v[120:121], v[120:121], v[240:241] op_sel_hi:[1,0]
    v_pk_mul_f32 v[122:123], v[122:123], v[240:241] op_sel_hi:[1,0]
    v_pk_mul_f32 v[124:125], v[124:125], v[240:241] op_sel_hi:[1,0]
    v_pk_mul_f32 v[126:127], v[126:127], v[240:241] op_sel_hi:[1,0]
    v_mfma_f32_16x16x32_bf16 v[52:55], a[124:127], v[172:175], 0
    ds_read_b128 a[100:103], v196 offset:30720
    v_max3_f32 v244, v244, v165, v166
    v_max_f32 v244, v244, v167
    v_mfma_f32_16x16x32_bf16 v[56:59], a[128:131], v[172:175], 0
    s_nop 0
    buffer_load_dwordx4 v202, s[4:7], s21 offen offset:1024 nt lds
    v_mov_b32 v245, v244
    s_nop 1
    v_permlane32_swap_b32 v244, v245
    v_cvt_pk_bf16_f32 v112, v112, v113
    v_mfma_f32_16x16x32_bf16 v[60:63], a[132:135], v[172:175], 0
    v_max_f32 v244, v244, v245
    v_cvt_pk_bf16_f32 v113, v114, v115
    v_mfma_f32_16x16x32_bf16 v[64:67], a[136:139], v[172:175], 0
    ds_read_b128 a[104:107], v195 offset:30848
    ds_write_b64 v220, v[112:113] offset:12288
    v_mov_b32 v245, v244
    s_nop 1
    v_permlane16_swap_b32 v244, v245
    v_cvt_pk_bf16_f32 v116, v116, v117
    v_mfma_f32_16x16x32_bf16 v[68:71], a[140:143], v[172:175], 0
    v_max_f32 v244, v244, v245
    v_cvt_pk_bf16_f32 v117, v118, v119
    v_mfma_f32_16x16x32_bf16 v[72:75], a[144:147], v[172:175], 0
    s_nop 0
    buffer_load_dwordx4 v203, s[4:7], s21 offen offset:2048 nt lds
    ds_write_b64 v221, v[116:117] offset:12288
    v_mul_f32 v194, s25, v244
    v_add_f32 v194, 0x41100000, v194
    v_cvt_pk_bf16_f32 v120, v120, v121
    v_cvt_pk_bf16_f32 v121, v122, v123
    v_mfma_f32_16x16x32_bf16 v[76:79], a[148:151], v[172:175], 0
    ds_read_b128 a[108:111], v196 offset:30848
    ds_write_b64 v222, v[120:121] offset:12288
    v_fma_f32 v180, v160, s25, -v194
    v_fma_f32 v181, v161, s25, -v194
    v_mfma_f32_16x16x32_bf16 v[80:83], a[152:155], v[172:175], 0
    v_exp_f32 v180, v180
    v_cvt_pk_bf16_f32 v124, v124, v125
    v_cvt_pk_bf16_f32 v125, v126, v127
    s_add_u32 m0, s30, 148480
    v_mfma_f32_16x16x32_bf16 v[84:87], a[156:159], v[172:175], 0
    ds_read_b128 a[112:115], v195 offset:30976
    ds_write_b64 v223, v[124:125] offset:12288
    v_exp_f32 v181, v181
    v_mfma_f32_16x16x32_bf16 v[88:91], a[160:163], v[172:175], 0
    s_add_u32 s20, s20, 1
    buffer_load_dwordx4 v201, s[4:7], s27 offen offset:0 nt lds
    v_fma_f32 v182, v162, s25, -v194
    v_pk_mul_f32 v[128:129], v[128:129], v[240:241] op_sel_hi:[1,0]
    v_pk_mul_f32 v[130:131], v[130:131], v[240:241] op_sel_hi:[1,0]
    v_pk_mul_f32 v[132:133], v[132:133], v[240:241] op_sel_hi:[1,0]
    v_pk_mul_f32 v[134:135], v[134:135], v[240:241] op_sel_hi:[1,0]
    v_pk_mul_f32 v[136:137], v[136:137], v[240:241] op_sel_hi:[1,0]
    v_pk_mul_f32 v[138:139], v[138:139], v[240:241] op_sel_hi:[1,0]
    v_pk_mul_f32 v[140:141], v[140:141], v[240:241] op_sel_hi:[1,0]
    v_pk_mul_f32 v[142:143], v[142:143], v[240:241] op_sel_hi:[1,0]
    v_mfma_f32_16x16x32_bf16 v[92:95], a[164:167], v[172:175], 0
    s_waitcnt lgkmcnt(5)
    ds_read_b128 a[116:119], v196 offset:30976
    v_fma_f32 v183, v163, s25, -v194
    v_exp_f32 v182, v182
    v_mfma_f32_16x16x32_bf16 v[144:147], a[72:75], a[0:3], 0
    s_bitcmp1_b32 s37, s20
    v_exp_f32 v183, v183
    v_cvt_pk_bf16_f32 v128, v128, v129
    v_mfma_f32_16x16x32_bf16 v[144:147], a[76:79], a[4:7], v[144:147]
    s_cselect_b32 s18, s54, 0
    v_cvt_pk_bf16_f32 v176, v180, v181
    v_cvt_pk_bf16_f32 v129, v130, v131
    v_mfma_f32_16x16x32_bf16 v[144:147], a[80:83], a[8:11], v[144:147]
    s_cselect_b32 s63, 1024, 0
    ds_read_b128 v[228:231], v208 offset:0
    ds_write_b64 v224, v[128:129] offset:12288
    buffer_load_dwordx4 v202, s[4:7], s27 offen offset:1024 nt lds
    v_fma_f32 v184, v164, s25, -v194
    v_fma_f32 v185, v165, s25, -v194
    v_cvt_pk_bf16_f32 v132, v132, v133
    v_mfma_f32_16x16x32_bf16 v[144:147], a[84:87], a[12:15], v[144:147]
    v_exp_f32 v184, v184
    v_cvt_pk_bf16_f32 v133, v134, v135
    v_mfma_f32_16x16x32_bf16 v[144:147], a[88:91], a[16:19], v[144:147]
    ds_write_b64 v225, v[132:133] offset:12288
    v_cvt_pk_bf16_f32 v177, v182, v183
    v_exp_f32 v185, v185
    v_cvt_pk_bf16_f32 v136, v136, v137
    v_cvt_pk_bf16_f32 v137, v138, v139
    v_mfma_f32_16x16x32_bf16 v[144:147], a[92:95], a[20:23], v[144:147]
    ds_write_b64 v226, v[136:137] offset:12288
    v_fma_f32 v186, v166, s25, -v194
    v_mfma_f32_16x16x32_bf16 v[148:151], a[96:99], a[0:3], 0
    s_nop 0
    buffer_load_dwordx4 v203, s[4:7], s27 offen offset:2048 nt lds
    v_fma_f32 v187, v167, s25, -v194
    v_exp_f32 v186, v186
    v_cvt_pk_bf16_f32 v140, v140, v141
    v_cvt_pk_bf16_f32 v141, v142, v143
    v_mfma_f32_16x16x32_bf16 v[148:151], a[100:103], a[4:7], v[148:151]
    ds_write_b64 v227, v[140:141] offset:12288
    v_cvt_pk_bf16_f32 v178, v184, v185
    v_mfma_f32_16x16x32_bf16 v[148:151], a[104:107], a[8:11], v[148:151]
    s_waitcnt lgkmcnt(3)
    v_exp_f32 v187, v187
    v_mfma_f32_16x16x32_bf16 v[148:151], a[108:111], a[12:15], v[148:151]
    v_cvt_pk_bf16_f32 v179, v186, v187
    v_mfma_f32_16x16x32_bf16 v[148:151], a[112:115], a[16:19], v[148:151]
    s_nop 0
    buffer_store_dwordx4 v[228:231], v209, s[16:19], s53 offen offset:0 nt
    v_mfma_f32_16x16x32_bf16 v[148:151], a[116:119], a[20:23], v[148:151]
    v_fma_f32 v180, v144, s25, -v192
    v_mfma_f32_16x16x32_bf16 v[240:243], a[216:219], v[176:179], 0
    s_add_u32 s53, s53, s63
    v_fma_f32 v181, v145, s25, -v192
    v_fma_f32 v182, v146, s25, -v192
    v_mfma_f32_16x16x32_bf16 v[96:99], a[120:123], v[176:179], 0
    ds_read_b64_tr_b16 a[120:121], v197 offset:24576
    ds_read_b64_tr_b16 a[122:123], v197 offset:30720
    v_mfma_f32_16x16x32_bf16 v[100:103], a[124:127], v[176:179], 0
    v_exp_f32 v180, v180
    v_mfma_f32_16x16x32_bf16 v[104:107], a[128:131], v[176:179], 0
    ds_read_b64_tr_b16 a[124:125], v198 offset:24576
    ds_read_b64_tr_b16 a[126:127], v198 offset:30720
    v_mfma_f32_16x16x32_bf16 v[108:111], a[132:135], v[176:179], 0
    v_exp_f32 v181, v181
    v_mfma_f32_16x16x32_bf16 v[112:115], a[136:139], v[176:179], 0
    v_fma_f32 v183, v147, s25, -v192
    v_fma_f32 v184, v148, s25, -v192
    v_mfma_f32_16x16x32_bf16 v[116:119], a[140:143], v[176:179], 0
    ds_read_b64_tr_b16 a[128:129], v199 offset:24576
    ds_read_b64_tr_b16 a[130:131], v199 offset:30720
    v_mfma_f32_16x16x32_bf16 v[120:123], a[144:147], v[176:179], 0
    v_exp_f32 v182, v182
    v_mfma_f32_16x16x32_bf16 v[124:127], a[148:151], v[176:179], 0
    ds_read_b64_tr_b16 a[132:133], v200 offset:24576
    ds_read_b64_tr_b16 a[134:135], v200 offset:30720
    v_mfma_f32_16x16x32_bf16 v[128:131], a[152:155], v[176:179], 0
    v_exp_f32 v183, v183
    v_mfma_f32_16x16x32_bf16 v[132:135], a[156:159], v[176:179], 0
    v_fma_f32 v185, v149, s25, -v192
    v_cvt_pk_bf16_f32 v168, v180, v181
    v_mfma_f32_16x16x32_bf16 v[136:139], a[160:163], v[176:179], 0
    ds_read_b64_tr_b16 a[136:137], v197 offset:24704
    ds_read_b64_tr_b16 a[138:139], v197 offset:30848
    v_mfma_f32_16x16x32_bf16 v[140:143], a[164:167], v[176:179], 0
    v_exp_f32 v184, v184
    s_bitcmp0_b32 s3, 0
    s_cbranch_scc1 L_mid0
    s_branch L_mid1
.p2align 6
L_lp2_0:
    v_mfma_f32_16x16x32_bf16 v[240:243], a[216:219], v[176:179], v[240:243]
    s_add_u32 s53, s53, s63
    v_fma_f32 v181, v145, s25, -v192
    v_fma_f32 v182, v146, s25, -v192
    v_mfma_f32_16x16x32_bf16 v[96:99], a[120:123], v[176:179], v[96:99]
    ds_read_b64_tr_b16 a[120:121], v197 offset:0
    ds_read_b64_tr_b16 a[122:123], v197 offset:6144
    v_mfma_f32_16x16x32_bf16 v[100:103], a[124:127], v[176:179], v[100:103]
    v_exp_f32 v180, v180
    v_mfma_f32_16x16x32_bf16 v[104:107], a[128:131], v[176:179], v[104:107]
    ds_read_b64_tr_b16 a[124:125], v198 offset:0
    ds_read_b64_tr_b16 a[126:127], v198 offset:6144
    v_mfma_f32_16x16x32_bf16 v[108:111], a[132:135], v[176:179], v[108:111]
    v_exp_f32 v181, v181
    v_mfma_f32_16x16x32_bf16 v[112:115], a[136:139], v[176:179], v[112:115]
    v_fma_f32 v183, v147, s25, -v192
    v_fma_f32 v184, v148, s25, -v192
    v_mfma_f32_16x16x32_bf16 v[116:119], a[140:143], v[176:179], v[116:119]
    ds_read_b64_tr_b16 a[128:129], v199 offset:0
    ds_read_b64_tr_b16 a[130:131], v199 offset:6144
    v_mfma_f32_16x16x32_bf16 v[120:123], a[144:147], v[176:179], v[120:123]
    v_exp_f32 v182, v182
    v_mfma_f32_16x16x32_bf16 v[124:127], a[148:151], v[176:179], v[124:127]
    ds_read_b64_tr_b16 a[132:133], v200 offset:0
    ds_read_b64_tr_b16 a[134:135], v200 offset:6144
    v_mfma_f32_16x16x32_bf16 v[128:131], a[152:155], v[176:179], v[128:131]
    v_exp_f32 v183, v183
    v_mfma_f32_16x16x32_bf16 v[132:135], a[156:159], v[176:179], v[132:135]
    v_fma_f32 v185, v149, s25, -v192
    v_cvt_pk_bf16_f32 v168, v180, v181
    v_mfma_f32_16x16x32_bf16 v[136:139], a[160:163], v[176:179], v[136:139]
    ds_read_b64_tr_b16 a[136:137], v197 offset:128
    ds_read_b64_tr_b16 a[138:139], v197 offset:6272
    v_mfma_f32_16x16x32_bf16 v[140:143], a[164:167], v[176:179], v[140:143]
    v_exp_f32 v184, v184
    v_mfma_f32_16x16x32_bf16 v[152:155], a[72:75], a[24:27], 0
    s_add_u32 s21, s21, 12288
    ds_read_b64_tr_b16 a[140:141], v198 offset:128
    ds_read_b64_tr_b16 a[142:143], v198 offset:6272
    v_mfma_f32_16x16x32_bf16 v[152:155], a[76:79], a[28:31], v[152:155]
    s_cmp_lt_u32 s20, 29
    v_fma_f32 v186, v150, s25, -v192
    v_cvt_pk_bf16_f32 v169, v182, v183
    v_mfma_f32_16x16x32_bf16 v[152:155], a[80:83], a[32:35], v[152:155]
    s_cselect_b32 s10, s49, 0
    v_exp_f32 v185, v185
    v_mfma_f32_16x16x32_bf16 v[152:155], a[84:87], a[36:39], v[152:155]
    s_cmp_lt_u32 s20, 28
    ds_read_b64_tr_b16 a[144:145], v199 offset:128
    ds_read_b64_tr_b16 a[146:147], v199 offset:6272
    v_mfma_f32_16x16x32_bf16 v[152:155], a[88:91], a[40:43], v[152:155]
    s_cselect_b32 s6, s49, 0
    v_exp_f32 v186, v186
    v_mfma_f32_16x16x32_bf16 v[152:155], a[92:95], a[44:47], v[152:155]
    ds_read_b64_tr_b16 a[148:149], v200 offset:128
    ds_read_b64_tr_b16 a[150:151], v200 offset:6272
    v_mfma_f32_16x16x32_bf16 v[156:159], a[96:99], a[24:27], 0
    v_fma_f32 v187, v151, s25, -v192
    v_cvt_pk_bf16_f32 v170, v184, v185
    v_mfma_f32_16x16x32_bf16 v[156:159], a[100:103], a[28:31], v[156:159]
    ds_read_b64_tr_b16 a[152:153], v197 offset:256
    ds_read_b64_tr_b16 a[154:155], v197 offset:6400
    v_mfma_f32_16x16x32_bf16 v[156:159], a[104:107], a[32:35], v[156:159]
    v_exp_f32 v187, v187
    v_mfma_f32_16x16x32_bf16 v[156:159], a[108:111], a[36:39], v[156:159]
    ds_read_b64_tr_b16 a[156:157], v198 offset:256
    ds_read_b64_tr_b16 a[158:159], v198 offset:6400
    v_mfma_f32_16x16x32_bf16 v[156:159], a[112:115], a[40:43], v[156:159]
    v_add_u32 v208, s63, v208
    v_cvt_pk_bf16_f32 v171, v186, v187
    v_mfma_f32_16x16x32_bf16 v[156:159], a[116:119], a[44:47], v[156:159]
    ds_read_b64_tr_b16 a[160:161], v199 offset:256
    ds_read_b64_tr_b16 a[162:163], v199 offset:6400
    v_mfma_f32_16x16x32_bf16 v[232:235], a[216:219], v[168:171], v[232:235]
    s_waitcnt lgkmcnt(6)
    v_fma_f32 v180, v152, s25, -v193
    v_fma_f32 v181, v153, s25, -v193
    v_mfma_f32_16x16x32_bf16 v[0:3], a[120:123], v[168:171], v[0:3]
    ds_read_b64_tr_b16 a[164:165], v200 offset:256
    ds_read_b64_tr_b16 a[166:167], v200 offset:6400
    v_mfma_f32_16x16x32_bf16 v[4:7], a[124:127], v[168:171], v[4:7]
    v_exp_f32 v180, v180
    v_mfma_f32_16x16x32_bf16 v[8:11], a[128:131], v[168:171], v[8:11]
    v_fma_f32 v182, v154, s25, -v193
    v_fma_f32 v183, v155, s25, -v193
    v_mfma_f32_16x16x32_bf16 v[12:15], a[132:135], v[168:171], v[12:15]
    v_exp_f32 v181, v181
    v_mfma_f32_16x16x32_bf16 v[16:19], a[136:139], v[168:171], v[16:19]
    s_add_u32 m0, s30, 0
    v_exp_f32 v182, v182
    v_mfma_f32_16x16x32_bf16 v[20:23], a[140:143], v[168:171], v[20:23]
    v_fma_f32 v184, v156, s25, -v193
    v_cvt_pk_bf16_f32 v172, v180, v181
    v_mfma_f32_16x16x32_bf16 v[24:27], a[144:147], v[168:171], v[24:27]
    v_exp_f32 v183, v183
    v_mfma_f32_16x16x32_bf16 v[28:31], a[148:151], v[168:171], v[28:31]
    s_waitcnt vmcnt(8) lgkmcnt(0)
    v_fma_f32 v185, v157, s25, -v193
    v_fma_f32 v186, v158, s25, -v193
    v_mfma_f32_16x16x32_bf16 v[32:35], a[152:155], v[168:171], v[32:35]
    s_barrier
    v_mfma_f32_16x16x32_bf16 v[36:39], a[156:159], v[168:171], v[36:39]
    v_mfma_f32_16x16x32_bf16 v[40:43], a[160:163], v[168:171], v[40:43]
    v_exp_f32 v184, v184
    v_mfma_f32_16x16x32_bf16 v[44:47], a[164:167], v[168:171], v[44:47]
    s_nop 0
    buffer_load_dwordx4 v204, s[8:11], s21 offen offset:0 nt lds
    v_mfma_f32_16x16x32_bf16 v[160:163], a[72:75], a[48:51], 0
    v_exp_f32 v185, v185
    v_mfma_f32_16x16x32_bf16 v[160:163], a[76:79], a[52:55], v[160:163]
    ds_read_b128 a[72:75], v195 offset:12288
    v_fma_f32 v187, v159, s25, -v193
    v_mfma_f32_16x16x32_bf16 v[160:163], a[80:83], a[56:59], v[160:163]
    v_exp_f32 v186, v186
    v_mfma_f32_16x16x32_bf16 v[160:163], a[84:87], a[60:63], v[160:163]
    s_nop 0
    buffer_load_dwordx4 v205, s[8:11], s21 offen offset:1024 nt lds
    v_mfma_f32_16x16x32_bf16 v[160:163], a[88:91], a[64:67], v[160:163]
    ds_read_b128 a[76:79], v196 offset:12288
    v_cvt_pk_bf16_f32 v173, v182, v183
    v_mfma_f32_16x16x32_bf16 v[160:163], a[92:95], a[68:71], v[160:163]
    v_exp_f32 v187, v187
    v_mfma_f32_16x16x32_bf16 v[164:167], a[96:99], a[48:51], 0
    ds_read_b128 a[80:83], v195 offset:12416
    v_cvt_pk_bf16_f32 v174, v184, v185
    v_mfma_f32_16x16x32_bf16 v[164:167], a[100:103], a[52:55], v[164:167]
    s_nop 0
    buffer_load_dwordx4 v206, s[8:11], s21 offen offset:2048 nt lds
    v_mfma_f32_16x16x32_bf16 v[164:167], a[104:107], a[56:59], v[164:167]
    s_add_u32 m0, s30, 36864
    ds_read_b128 a[84:87], v196 offset:12416
    v_cvt_pk_bf16_f32 v175, v186, v187
    v_mfma_f32_16x16x32_bf16 v[164:167], a[108:111], a[60:63], v[164:167]
    ds_read_b128 a[88:91], v195 offset:12544
    v_mfma_f32_16x16x32_bf16 v[164:167], a[112:115], a[64:67], v[164:167]
    ds_read_b128 a[92:95], v196 offset:12544
    v_mfma_f32_16x16x32_bf16 v[164:167], a[116:119], a[68:71], v[164:167]
    s_nop 0
    buffer_load_dwordx4 v201, s[4:7], s21 offen offset:0 nt lds
    v_mfma_f32_16x16x32_bf16 v[236:239], a[216:219], v[172:175], v[236:239]
    ds_read_b128 a[96:99], v195 offset:18432
    v_fma_f32 v180, v160, s25, -v194
    v_mfma_f32_16x16x32_bf16 v[48:51], a[120:123], v[172:175], v[48:51]
    v_fma_f32 v181, v161, s25, -v194
    v_fma_f32 v182, v162, s25, -v194
    v_mfma_f32_16x16x32_bf16 v[52:55], a[124:127], v[172:175], v[52:55]
    ds_read_b128 a[100:103], v196 offset:18432
    v_fma_f32 v183, v163, s25, -v194
    v_mfma_f32_16x16x32_bf16 v[56:59], a[128:131], v[172:175], v[56:59]
    s_nop 0
    buffer_load_dwordx4 v202, s[4:7], s21 offen offset:1024 nt lds
    v_mfma_f32_16x16x32_bf16 v[60:63], a[132:135], v[172:175], v[60:63]
    v_exp_f32 v180, v180
    v_mfma_f32_16x16x32_bf16 v[64:67], a[136:139], v[172:175], v[64:67]
    ds_read_b128 a[104:107], v195 offset:18560
    v_fma_f32 v184, v164, s25, -v194
    v_mfma_f32_16x16x32_bf16 v[68:71], a[140:143], v[172:175], v[68:71]
    v_exp_f32 v181, v181
    v_mfma_f32_16x16x32_bf16 v[72:75], a[144:147], v[172:175], v[72:75]
    s_nop 0
    buffer_load_dwordx4 v203, s[4:7], s21 offen offset:2048 nt lds
    v_mfma_f32_16x16x32_bf16 v[76:79], a[148:151], v[172:175], v[76:79]
    ds_read_b128 a[108:111], v196 offset:18560
    v_fma_f32 v185, v165, s25, -v194
    v_mfma_f32_16x16x32_bf16 v[80:83], a[152:155], v[172:175], v[80:83]
    v_exp_f32 v182, v182
    v_mfma_f32_16x16x32_bf16 v[84:87], a[156:159], v[172:175], v[84:87]
    ds_read_b128 a[112:115], v195 offset:18688
    v_cvt_pk_bf16_f32 v176, v180, v181
    v_mfma_f32_16x16x32_bf16 v[88:91], a[160:163], v[172:175], v[88:91]
    s_add_u32 s20, s20, 1
    v_mfma_f32_16x16x32_bf16 v[92:95], a[164:167], v[172:175], v[92:95]
    s_waitcnt lgkmcnt(2)
    ds_read_b128 a[116:119], v196 offset:18688
    v_fma_f32 v186, v166, s25, -v194
    v_mfma_f32_16x16x32_bf16 v[144:147], a[72:75], a[0:3], 0
    s_bitcmp1_b32 s37, s20
    v_exp_f32 v183, v183
    v_mfma_f32_16x16x32_bf16 v[144:147], a[76:79], a[4:7], v[144:147]
    s_cselect_b32 s18, s54, 0
    v_exp_f32 v184, v184
    v_mfma_f32_16x16x32_bf16 v[144:147], a[80:83], a[8:11], v[144:147]
    s_cselect_b32 s63, 1024, 0
    ds_read_b128 v[228:231], v208 offset:0
    v_fma_f32 v187, v167, s25, -v194
    v_mfma_f32_16x16x32_bf16 v[144:147], a[84:87], a[12:15], v[144:147]
    v_exp_f32 v185, v185
    v_mfma_f32_16x16x32_bf16 v[144:147], a[88:91], a[16:19], v[144:147]
    v_cvt_pk_bf16_f32 v177, v182, v183
    v_mfma_f32_16x16x32_bf16 v[144:147], a[92:95], a[20:23], v[144:147]
    v_exp_f32 v186, v186
    v_mfma_f32_16x16x32_bf16 v[148:151], a[96:99], a[0:3], 0
    v_cvt_pk_bf16_f32 v178, v184, v185
    v_mfma_f32_16x16x32_bf16 v[148:151], a[100:103], a[4:7], v[148:151]
    v_exp_f32 v187, v187
    v_mfma_f32_16x16x32_bf16 v[148:151], a[104:107], a[8:11], v[148:151]
    s_waitcnt lgkmcnt(0)
    v_mfma_f32_16x16x32_bf16 v[148:151], a[108:111], a[12:15], v[148:151]
    v_cvt_pk_bf16_f32 v179, v186, v187
    v_fma_f32 v180, v144, s25, -v192
    v_mfma_f32_16x16x32_bf16 v[148:151], a[112:115], a[16:19], v[148:151]
    s_nop 0
    buffer_store_dwordx4 v[228:231], v209, s[16:19], s53 offen offset:0 nt
    v_mfma_f32_16x16x32_bf16 v[148:151], a[116:119], a[20:23], v[148:151]
    v_mfma_f32_16x16x32_bf16 v[240:243], a[216:219], v[176:179], v[240:243]
    s_add_u32 s53, s53, s63
    v_fma_f32 v181, v145, s25, -v192
    v_fma_f32 v182, v146, s25, -v192
    v_mfma_f32_16x16x32_bf16 v[96:99], a[120:123], v[176:179], v[96:99]
    ds_read_b64_tr_b16 a[120:121], v197 offset:12288
    ds_read_b64_tr_b16 a[122:123], v197 offset:18432
    v_mfma_f32_16x16x32_bf16 v[100:103], a[124:127], v[176:179], v[100:103]
    v_exp_f32 v180, v180
    v_mfma_f32_16x16x32_bf16 v[104:107], a[128:131], v[176:179], v[104:107]
    ds_read_b64_tr_b16 a[124:125], v198 offset:12288
    ds_read_b64_tr_b16 a[126:127], v198 offset:18432
    v_mfma_f32_16x16x32_bf16 v[108:111], a[132:135], v[176:179], v[108:111]
    v_exp_f32 v181, v181
    v_mfma_f32_16x16x32_bf16 v[112:115], a[136:139], v[176:179], v[112:115]
    v_fma_f32 v183, v147, s25, -v192
    v_fma_f32 v184, v148, s25, -v192
    v_mfma_f32_16x16x32_bf16 v[116:119], a[140:143], v[176:179], v[116:119]
    ds_read_b64_tr_b16 a[128:129], v199 offset:12288
    ds_read_b64_tr_b16 a[130:131], v199 offset:18432
    v_mfma_f32_16x16x32_bf16 v[120:123], a[144:147], v[176:179], v[120:123]
    v_exp_f32 v182, v182
    v_mfma_f32_16x16x32_bf16 v[124:127], a[148:151], v[176:179], v[124:127]
    ds_read_b64_tr_b16 a[132:133], v200 offset:12288
    ds_read_b64_tr_b16 a[134:135], v200 offset:18432
    v_mfma_f32_16x16x32_bf16 v[128:131], a[152:155], v[176:179], v[128:131]
    v_exp_f32 v183, v183
    v_mfma_f32_16x16x32_bf16 v[132:135], a[156:159], v[176:179], v[132:135]
    v_fma_f32 v185, v149, s25, -v192
    v_cvt_pk_bf16_f32 v168, v180, v181
    v_mfma_f32_16x16x32_bf16 v[136:139], a[160:163], v[176:179], v[136:139]
    ds_read_b64_tr_b16 a[136:137], v197 offset:12416
    ds_read_b64_tr_b16 a[138:139], v197 offset:18560
    v_mfma_f32_16x16x32_bf16 v[140:143], a[164:167], v[176:179], v[140:143]
    v_exp_f32 v184, v184
    v_mfma_f32_16x16x32_bf16 v[152:155], a[72:75], a[24:27], 0
    s_add_u32 s21, s21, 12288
    ds_read_b64_tr_b16 a[140:141], v198 offset:12416
    ds_read_b64_tr_b16 a[142:143], v198 offset:18560
    v_mfma_f32_16x16x32_bf16 v[152:155], a[76:79], a[28:31], v[152:155]
    s_cmp_lt_u32 s20, 29
    v_fma_f32 v186, v150, s25, -v192
    v_cvt_pk_bf16_f32 v169, v182, v183
    v_mfma_f32_16x16x32_bf16 v[152:155], a[80:83], a[32:35], v[152:155]
    s_cselect_b32 s10, s49, 0
    v_exp_f32 v185, v185
    v_mfma_f32_16x16x32_bf16 v[152:155], a[84:87], a[36:39], v[152:155]
    s_cmp_lt_u32 s20, 28
    ds_read_b64_tr_b16 a[144:145], v199 offset:12416
    ds_read_b64_tr_b16 a[146:147], v199 offset:18560
    v_mfma_f32_16x16x32_bf16 v[152:155], a[88:91], a[40:43], v[152:155]
    s_cselect_b32 s6, s49, 0
    v_exp_f32 v186, v186
    v_mfma_f32_16x16x32_bf16 v[152:155], a[92:95], a[44:47], v[152:155]
    ds_read_b64_tr_b16 a[148:149], v200 offset:12416
    ds_read_b64_tr_b16 a[150:151], v200 offset:18560
    v_mfma_f32_16x16x32_bf16 v[156:159], a[96:99], a[24:27], 0
    v_fma_f32 v187, v151, s25, -v192
    v_cvt_pk_bf16_f32 v170, v184, v185
    v_mfma_f32_16x16x32_bf16 v[156:159], a[100:103], a[28:31], v[156:159]
    ds_read_b64_tr_b16 a[152:153], v197 offset:12544
    ds_read_b64_tr_b16 a[154:155], v197 offset:18688
    v_mfma_f32_16x16x32_bf16 v[156:159], a[104:107], a[32:35], v[156:159]
    v_exp_f32 v187, v187
    v_mfma_f32_16x16x32_bf16 v[156:159], a[108:111], a[36:39], v[156:159]
    ds_read_b64_tr_b16 a[156:157], v198 offset:12544
    ds_read_b64_tr_b16 a[158:159], v198 offset:18688
    v_mfma_f32_16x16x32_bf16 v[156:159], a[112:115], a[40:43], v[156:159]
    v_add_u32 v208, s63, v208
    v_cvt_pk_bf16_f32 v171, v186, v187
    v_mfma_f32_16x16x32_bf16 v[156:159], a[116:119], a[44:47], v[156:159]
    ds_read_b64_tr_b16 a[160:161], v199 offset:12544
    ds_read_b64_tr_b16 a[162:163], v199 offset:18688
    v_mfma_f32_16x16x32_bf16 v[232:235], a[216:219], v[168:171], v[232:235]
    s_waitcnt lgkmcnt(6)
    v_fma_f32 v180, v152, s25, -v193
    v_fma_f32 v181, v153, s25, -v193
    v_mfma_f32_16x16x32_bf16 v[0:3], a[120:123], v[168:171], v[0:3]
    ds_read_b64_tr_b16 a[164:165], v200 offset:12544
    ds_read_b64_tr_b16 a[166:167], v200 offset:18688
    v_mfma_f32_16x16x32_bf16 v[4:7], a[124:127], v[168:171], v[4:7]
    v_exp_f32 v180, v180
    v_mfma_f32_16x16x32_bf16 v[8:11], a[128:131], v[168:171], v[8:11]
    v_fma_f32 v182, v154, s25, -v193
    v_fma_f32 v183, v155, s25, -v193
    v_mfma_f32_16x16x32_bf16 v[12:15], a[132:135], v[168:171], v[12:15]
    v_exp_f32 v181, v181
    v_mfma_f32_16x16x32_bf16 v[16:19], a[136:139], v[168:171], v[16:19]
    s_add_u32 m0, s30, 12288
    v_exp_f32 v182, v182
    v_mfma_f32_16x16x32_bf16 v[20:23], a[140:143], v[168:171], v[20:23]
    v_fma_f32 v184, v156, s25, -v193
    v_cvt_pk_bf16_f32 v172, v180, v181
    v_mfma_f32_16x16x32_bf16 v[24:27], a[144:147], v[168:171], v[24:27]
    v_exp_f32 v183, v183
    v_mfma_f32_16x16x32_bf16 v[28:31], a[148:151], v[168:171], v[28:31]
    s_waitcnt vmcnt(8) lgkmcnt(0)
    v_fma_f32 v185, v157, s25, -v193
    v_fma_f32 v186, v158, s25, -v193
    v_mfma_f32_16x16x32_bf16 v[32:35], a[152:155], v[168:171], v[32:35]
    s_barrier
    v_mfma_f32_16x16x32_bf16 v[36:39], a[156:159], v[168:171], v[36:39]
    v_mfma_f32_16x16x32_bf16 v[40:43], a[160:163], v[168:171], v[40:43]
    v_exp_f32 v184, v184
    v_mfma_f32_16x16x32_bf16 v[44:47], a[164:167], v[168:171], v[44:47]
    s_nop 0
    buffer_load_dwordx4 v204, s[8:11], s21 offen offset:0 nt lds
    v_mfma_f32_16x16x32_bf16 v[160:163], a[72:75], a[48:51], 0
    v_exp_f32 v185, v185
    v_mfma_f32_16x16x32_bf16 v[160:163], a[76:79], a[52:55], v[160:163]
    ds_read_b128 a[72:75], v195 offset:24576
    v_fma_f32 v187, v159, s25, -v193
    v_mfma_f32_16x16x32_bf16 v[160:163], a[80:83], a[56:59], v[160:163]
    v_exp_f32 v186, v186
    v_mfma_f32_16x16x32_bf16 v[160:163], a[84:87], a[60:63], v[160:163]
    s_nop 0
    buffer_load_dwordx4 v205, s[8:11], s21 offen offset:1024 nt lds
    v_mfma_f32_16x16x32_bf16 v[160:163], a[88:91], a[64:67], v[160:163]
    ds_read_b128 a[76:79], v196 offset:24576
    v_cvt_pk_bf16_f32 v173, v182, v183
    v_mfma_f32_16x16x32_bf16 v[160:163], a[92:95], a[68:71], v[160:163]
    v_exp_f32 v187, v187
    v_mfma_f32_16x16x32_bf16 v[164:167], a[96:99], a[48:51], 0
    ds_read_b128 a[80:83], v195 offset:24704
    v_cvt_pk_bf16_f32 v174, v184, v185
    v_mfma_f32_16x16x32_bf16 v[164:167], a[100:103], a[52:55], v[164:167]
    s_nop 0
    buffer_load_dwordx4 v206, s[8:11], s21 offen offset:2048 nt lds
    v_mfma_f32_16x16x32_bf16 v[164:167], a[104:107], a[56:59], v[164:167]
    s_add_u32 m0, s30, 49152
    ds_read_b128 a[84:87], v196 offset:24704
    v_cvt_pk_bf16_f32 v175, v186, v187
    v_mfma_f32_16x16x32_bf16 v[164:167], a[108:111], a[60:63], v[164:167]
    ds_read_b128 a[88:91], v195 offset:24832
    v_mfma_f32_16x16x32_bf16 v[164:167], a[112:115], a[64:67], v[164:167]
    ds_read_b128 a[92:95], v196 offset:24832
    v_mfma_f32_16x16x32_bf16 v[164:167], a[116:119], a[68:71], v[164:167]
    s_nop 0
    buffer_load_dwordx4 v201, s[4:7], s21 offen offset:0 nt lds
    v_mfma_f32_16x16x32_bf16 v[236:239], a[216:219], v[172:175], v[236:239]
    ds_read_b128 a[96:99], v195 offset:30720
    v_fma_f32 v180, v160, s25, -v194
    v_mfma_f32_16x16x32_bf16 v[48:51], a[120:123], v[172:175], v[48:51]
    v_fma_f32 v181, v161, s25, -v194
    v_fma_f32 v182, v162, s25, -v194
    v_mfma_f32_16x16x32_bf16 v[52:55], a[124:127], v[172:175], v[52:55]
    ds_read_b128 a[100:103], v196 offset:30720
    v_fma_f32 v183, v163, s25, -v194
    v_mfma_f32_16x16x32_bf16 v[56:59], a[128:131], v[172:175], v[56:59]
    s_nop 0
    buffer_load_dwordx4 v202, s[4:7], s21 offen offset:1024 nt lds
    v_mfma_f32_16x16x32_bf16 v[60:63], a[132:135], v[172:175], v[60:63]
    v_exp_f32 v180, v180
    v_mfma_f32_16x16x32_bf16 v[64:67], a[136:139], v[172:175], v[64:67]
    ds_read_b128 a[104:107], v195 offset:30848
    v_fma_f32 v184, v164, s25, -v194
    v_mfma_f32_16x16x32_bf16 v[68:71], a[140:143], v[172:175], v[68:71]
    v_exp_f32 v181, v181
    v_mfma_f32_16x16x32_bf16 v[72:75], a[144:147], v[172:175], v[72:75]
    s_nop 0
    buffer_load_dwordx4 v203, s[4:7], s21 offen offset:2048 nt lds
    v_mfma_f32_16x16x32_bf16 v[76:79], a[148:151], v[172:175], v[76:79]
    ds_read_b128 a[108:111], v196 offset:30848
    v_fma_f32 v185, v165, s25, -v194
    v_mfma_f32_16x16x32_bf16 v[80:83], a[152:155], v[172:175], v[80:83]
    v_exp_f32 v182, v182
    v_mfma_f32_16x16x32_bf16 v[84:87], a[156:159], v[172:175], v[84:87]
    ds_read_b128 a[112:115], v195 offset:30976
    v_cvt_pk_bf16_f32 v176, v180, v181
    v_mfma_f32_16x16x32_bf16 v[88:91], a[160:163], v[172:175], v[88:91]
    s_add_u32 s20, s20, 1
    v_mfma_f32_16x16x32_bf16 v[92:95], a[164:167], v[172:175], v[92:95]
    s_waitcnt lgkmcnt(2)
    ds_read_b128 a[116:119], v196 offset:30976
    v_fma_f32 v186, v166, s25, -v194
    v_mfma_f32_16x16x32_bf16 v[144:147], a[72:75], a[0:3], 0
    s_bitcmp1_b32 s37, s20
    v_exp_f32 v183, v183
    v_mfma_f32_16x16x32_bf16 v[144:147], a[76:79], a[4:7], v[144:147]
    s_cselect_b32 s18, s54, 0
    v_exp_f32 v184, v184
    v_mfma_f32_16x16x32_bf16 v[144:147], a[80:83], a[8:11], v[144:147]
    s_cselect_b32 s63, 1024, 0
    ds_read_b128 v[228:231], v208 offset:0
    v_fma_f32 v187, v167, s25, -v194
    v_mfma_f32_16x16x32_bf16 v[144:147], a[84:87], a[12:15], v[144:147]
    v_exp_f32 v185, v185
    v_mfma_f32_16x16x32_bf16 v[144:147], a[88:91], a[16:19], v[144:147]
    v_cvt_pk_bf16_f32 v177, v182, v183
    v_mfma_f32_16x16x32_bf16 v[144:147], a[92:95], a[20:23], v[144:147]
    v_exp_f32 v186, v186
    v_mfma_f32_16x16x32_bf16 v[148:151], a[96:99], a[0:3], 0
    v_cvt_pk_bf16_f32 v178, v184, v185
    v_mfma_f32_16x16x32_bf16 v[148:151], a[100:103], a[4:7], v[148:151]
    v_exp_f32 v187, v187
    v_mfma_f32_16x16x32_bf16 v[148:151], a[104:107], a[8:11], v[148:151]
    s_waitcnt lgkmcnt(0)
    v_mfma_f32_16x16x32_bf16 v[148:151], a[108:111], a[12:15], v[148:151]
    v_cvt_pk_bf16_f32 v179, v186, v187
    v_fma_f32 v180, v144, s25, -v192
    v_mfma_f32_16x16x32_bf16 v[148:151], a[112:115], a[16:19], v[148:151]
    s_nop 0
    buffer_store_dwordx4 v[228:231], v209, s[16:19], s53 offen offset:0 nt
    v_mfma_f32_16x16x32_bf16 v[148:151], a[116:119], a[20:23], v[148:151]
    v_mfma_f32_16x16x32_bf16 v[240:243], a[216:219], v[176:179], v[240:243]
    s_add_u32 s53, s53, s63
    v_fma_f32 v181, v145, s25, -v192
    v_fma_f32 v182, v146, s25, -v192
    v_mfma_f32_16x16x32_bf16 v[96:99], a[120:123], v[176:179], v[96:99]
    ds_read_b64_tr_b16 a[120:121], v197 offset:24576
    ds_read_b64_tr_b16 a[122:123], v197 offset:30720
    v_mfma_f32_16x16x32_bf16 v[100:103], a[124:127], v[176:179], v[100:103]
    v_exp_f32 v180, v180
    v_mfma_f32_16x16x32_bf16 v[104:107], a[128:131], v[176:179], v[104:107]
    ds_read_b64_tr_b16 a[124:125], v198 offset:24576
    ds_read_b64_tr_b16 a[126:127], v198 offset:30720
    v_mfma_f32_16x16x32_bf16 v[108:111], a[132:135], v[176:179], v[108:111]
    v_exp_f32 v181, v181
    v_mfma_f32_16x16x32_bf16 v[112:115], a[136:139], v[176:179], v[112:115]
    v_fma_f32 v183, v147, s25, -v192
    v_fma_f32 v184, v148, s25, -v192
    v_mfma_f32_16x16x32_bf16 v[116:119], a[140:143], v[176:179], v[116:119]
    ds_read_b64_tr_b16 a[128:129], v199 offset:24576
    ds_read_b64_tr_b16 a[130:131], v199 offset:30720
    v_mfma_f32_16x16x32_bf16 v[120:123], a[144:147], v[176:179], v[120:123]
    v_exp_f32 v182, v182
    v_mfma_f32_16x16x32_bf16 v[124:127], a[148:151], v[176:179], v[124:127]
    ds_read_b64_tr_b16 a[132:133], v200 offset:24576
    ds_read_b64_tr_b16 a[134:135], v200 offset:30720
    v_mfma_f32_16x16x32_bf16 v[128:131], a[152:155], v[176:179], v[128:131]
    v_exp_f32 v183, v183
    v_mfma_f32_16x16x32_bf16 v[132:135], a[156:159], v[176:179], v[132:135]
    v_fma_f32 v185, v149, s25, -v192
    v_cvt_pk_bf16_f32 v168, v180, v181
    v_mfma_f32_16x16x32_bf16 v[136:139], a[160:163], v[176:179], v[136:139]
    ds_read_b64_tr_b16 a[136:137], v197 offset:24704
    ds_read_b64_tr_b16 a[138:139], v197 offset:30848
    v_mfma_f32_16x16x32_bf16 v[140:143], a[164:167], v[176:179], v[140:143]
    v_exp_f32 v184, v184
L_mid0:
    v_mfma_f32_16x16x32_bf16 v[152:155], a[72:75], a[24:27], 0
    s_add_u32 s21, s21, 12288
    ds_read_b64_tr_b16 a[140:141], v198 offset:24704
    ds_read_b64_tr_b16 a[142:143], v198 offset:30848
    v_mfma_f32_16x16x32_bf16 v[152:155], a[76:79], a[28:31], v[152:155]
    s_cmp_lt_u32 s20, 29
    v_fma_f32 v186, v150, s25, -v192
    v_cvt_pk_bf16_f32 v169, v182, v183
    v_mfma_f32_16x16x32_bf16 v[152:155], a[80:83], a[32:35], v[152:155]
    s_cselect_b32 s10, s49, 0
    v_exp_f32 v185, v185
    v_mfma_f32_16x16x32_bf16 v[152:155], a[84:87], a[36:39], v[152:155]
    s_cmp_lt_u32 s20, 28
    ds_read_b64_tr_b16 a[144:145], v199 offset:24704
    ds_read_b64_tr_b16 a[146:147], v199 offset:30848
    v_mfma_f32_16x16x32_bf16 v[152:155], a[88:91], a[40:43], v[152:155]
    s_cselect_b32 s6, s49, 0
    v_exp_f32 v186, v186
    v_mfma_f32_16x16x32_bf16 v[152:155], a[92:95], a[44:47], v[152:155]
    ds_read_b64_tr_b16 a[148:149], v200 offset:24704
    ds_read_b64_tr_b16 a[150:151], v200 offset:30848
    v_mfma_f32_16x16x32_bf16 v[156:159], a[96:99], a[24:27], 0
    v_fma_f32 v187, v151, s25, -v192
    v_cvt_pk_bf16_f32 v170, v184, v185
    v_mfma_f32_16x16x32_bf16 v[156:159], a[100:103], a[28:31], v[156:159]
    ds_read_b64_tr_b16 a[152:153], v197 offset:24832
    ds_read_b64_tr_b16 a[154:155], v197 offset:30976
    v_mfma_f32_16x16x32_bf16 v[156:159], a[104:107], a[32:35], v[156:159]
    v_exp_f32 v187, v187
    v_mfma_f32_16x16x32_bf16 v[156:159], a[108:111], a[36:39], v[156:159]
    ds_read_b64_tr_b16 a[156:157], v198 offset:24832
    ds_read_b64_tr_b16 a[158:159], v198 offset:30976
    v_mfma_f32_16x16x32_bf16 v[156:159], a[112:115], a[40:43], v[156:159]
    v_add_u32 v208, s63, v208
    v_cvt_pk_bf16_f32 v171, v186, v187
    v_mfma_f32_16x16x32_bf16 v[156:159], a[116:119], a[44:47], v[156:159]
    ds_read_b64_tr_b16 a[160:161], v199 offset:24832
    ds_read_b64_tr_b16 a[162:163], v199 offset:30976
    v_mfma_f32_16x16x32_bf16 v[232:235], a[216:219], v[168:171], v[232:235]
    s_waitcnt lgkmcnt(6)
    v_fma_f32 v180, v152, s25, -v193
    v_fma_f32 v181, v153, s25, -v193
    v_mfma_f32_16x16x32_bf16 v[0:3], a[120:123], v[168:171], v[0:3]
    ds_read_b64_tr_b16 a[164:165], v200 offset:24832
    ds_read_b64_tr_b16 a[166:167], v200 offset:30976
    v_mfma_f32_16x16x32_bf16 v[4:7], a[124:127], v[168:171], v[4:7]
    v_exp_f32 v180, v180
    v_mfma_f32_16x16x32_bf16 v[8:11], a[128:131], v[168:171], v[8:11]
    v_fma_f32 v182, v154, s25, -v193
    v_fma_f32 v183, v155, s25, -v193
    v_mfma_f32_16x16x32_bf16 v[12:15], a[132:135], v[168:171], v[12:15]
    v_exp_f32 v181, v181
    v_mfma_f32_16x16x32_bf16 v[16:19], a[136:139], v[168:171], v[16:19]
    s_add_u32 m0, s30, 24576
    v_exp_f32 v182, v182
    v_mfma_f32_16x16x32_bf16 v[20:23], a[140:143], v[168:171], v[20:23]
    v_fma_f32 v184, v156, s25, -v193
    v_cvt_pk_bf16_f32 v172, v180, v181
    v_mfma_f32_16x16x32_bf16 v[24:27], a[144:147], v[168:171], v[24:27]
    v_exp_f32 v183, v183
    v_mfma_f32_16x16x32_bf16 v[28:31], a[148:151], v[168:171], v[28:31]
    s_waitcnt vmcnt(8) lgkmcnt(0)
    v_fma_f32 v185, v157, s25, -v193
    v_fma_f32 v186, v158, s25, -v193
    v_mfma_f32_16x16x32_bf16 v[32:35], a[152:155], v[168:171], v[32:35]
    s_barrier
    v_mfma_f32_16x16x32_bf16 v[36:39], a[156:159], v[168:171], v[36:39]
    v_mfma_f32_16x16x32_bf16 v[40:43], a[160:163], v[168:171], v[40:43]
    v_exp_f32 v184, v184
    v_mfma_f32_16x16x32_bf16 v[44:47], a[164:167], v[168:171], v[44:47]
    s_nop 0
    buffer_load_dwordx4 v204, s[8:11], s21 offen offset:0 nt lds
    v_mfma_f32_16x16x32_bf16 v[160:163], a[72:75], a[48:51], 0
    v_exp_f32 v185, v185
    v_mfma_f32_16x16x32_bf16 v[160:163], a[76:79], a[52:55], v[160:163]
    ds_read_b128 a[72:75], v195 offset:0
    v_fma_f32 v187, v159, s25, -v193
    v_mfma_f32_16x16x32_bf16 v[160:163], a[80:83], a[56:59], v[160:163]
    v_exp_f32 v186, v186
    v_mfma_f32_16x16x32_bf16 v[160:163], a[84:87], a[60:63], v[160:163]
    s_nop 0
    buffer_load_dwordx4 v205, s[8:11], s21 offen offset:1024 nt lds
    v_mfma_f32_16x16x32_bf16 v[160:163], a[88:91], a[64:67], v[160:163]
    ds_read_b128 a[76:79], v196 offset:0
    v_cvt_pk_bf16_f32 v173, v182, v183
    v_mfma_f32_16x16x32_bf16 v[160:163], a[92:95], a[68:71], v[160:163]
    v_exp_f32 v187, v187
    v_mfma_f32_16x16x32_bf16 v[164:167], a[96:99], a[48:51], 0
    ds_read_b128 a[80:83], v195 offset:128
    v_cvt_pk_bf16_f32 v174, v184, v185
    v_mfma_f32_16x16x32_bf16 v[164:167], a[100:103], a[52:55], v[164:167]
    s_nop 0
    buffer_load_dwordx4 v206, s[8:11], s21 offen offset:2048 nt lds
    v_mfma_f32_16x16x32_bf16 v[164:167], a[104:107], a[56:59], v[164:167]
    s_add_u32 m0, s30, 61440
    ds_read_b128 a[84:87], v196 offset:128
    v_cvt_pk_bf16_f32 v175, v186, v187
    v_mfma_f32_16x16x32_bf16 v[164:167], a[108:111], a[60:63], v[164:167]
    ds_read_b128 a[88:91], v195 offset:256
    v_mfma_f32_16x16x32_bf16 v[164:167], a[112:115], a[64:67], v[164:167]
    ds_read_b128 a[92:95], v196 offset:256
    v_mfma_f32_16x16x32_bf16 v[164:167], a[116:119], a[68:71], v[164:167]
    s_nop 0
    buffer_load_dwordx4 v201, s[4:7], s21 offen offset:0 nt lds
    v_mfma_f32_16x16x32_bf16 v[236:239], a[216:219], v[172:175], v[236:239]
    ds_read_b128 a[96:99], v195 offset:6144
    v_fma_f32 v180, v160, s25, -v194
    v_mfma_f32_16x16x32_bf16 v[48:51], a[120:123], v[172:175], v[48:51]
    v_fma_f32 v181, v161, s25, -v194
    v_fma_f32 v182, v162, s25, -v194
    v_mfma_f32_16x16x32_bf16 v[52:55], a[124:127], v[172:175], v[52:55]
    ds_read_b128 a[100:103], v196 offset:6144
    v_fma_f32 v183, v163, s25, -v194
    v_mfma_f32_16x16x32_bf16 v[56:59], a[128:131], v[172:175], v[56:59]
    s_nop 0
    buffer_load_dwordx4 v202, s[4:7], s21 offen offset:1024 nt lds
    v_mfma_f32_16x16x32_bf16 v[60:63], a[132:135], v[172:175], v[60:63]
    v_exp_f32 v180, v180
    v_mfma_f32_16x16x32_bf16 v[64:67], a[136:139], v[172:175], v[64:67]
    ds_read_b128 a[104:107], v195 offset:6272
    v_fma_f32 v184, v164, s25, -v194
    v_mfma_f32_16x16x32_bf16 v[68:71], a[140:143], v[172:175], v[68:71]
    v_exp_f32 v181, v181
    v_mfma_f32_16x16x32_bf16 v[72:75], a[144:147], v[172:175], v[72:75]
    s_nop 0
    buffer_load_dwordx4 v203, s[4:7], s21 offen offset:2048 nt lds
    v_mfma_f32_16x16x32_bf16 v[76:79], a[148:151], v[172:175], v[76:79]
    ds_read_b128 a[108:111], v196 offset:6272
    v_fma_f32 v185, v165, s25, -v194
    v_mfma_f32_16x16x32_bf16 v[80:83], a[152:155], v[172:175], v[80:83]
    v_exp_f32 v182, v182
    v_mfma_f32_16x16x32_bf16 v[84:87], a[156:159], v[172:175], v[84:87]
    ds_read_b128 a[112:115], v195 offset:6400
    v_cvt_pk_bf16_f32 v176, v180, v181
    v_mfma_f32_16x16x32_bf16 v[88:91], a[160:163], v[172:175], v[88:91]
    s_add_u32 s20, s20, 1
    v_mfma_f32_16x16x32_bf16 v[92:95], a[164:167], v[172:175], v[92:95]
    s_waitcnt lgkmcnt(2)
    ds_read_b128 a[116:119], v196 offset:6400
    v_fma_f32 v186, v166, s25, -v194
    v_mfma_f32_16x16x32_bf16 v[144:147], a[72:75], a[0:3], 0
    s_bitcmp1_b32 s37, s20
    v_exp_f32 v183, v183
    v_mfma_f32_16x16x32_bf16 v[144:147], a[76:79], a[4:7], v[144:147]
    s_cselect_b32 s18, s54, 0
    v_exp_f32 v184, v184
    v_mfma_f32_16x16x32_bf16 v[144:147], a[80:83], a[8:11], v[144:147]
    s_cselect_b32 s63, 1024, 0
    ds_read_b128 v[228:231], v208 offset:0
    v_fma_f32 v187, v167, s25, -v194
    v_mfma_f32_16x16x32_bf16 v[144:147], a[84:87], a[12:15], v[144:147]
    v_exp_f32 v185, v185
    v_mfma_f32_16x16x32_bf16 v[144:147], a[88:91], a[16:19], v[144:147]
    v_cvt_pk_bf16_f32 v177, v182, v183
    v_mfma_f32_16x16x32_bf16 v[144:147], a[92:95], a[20:23], v[144:147]
    v_exp_f32 v186, v186
    v_mfma_f32_16x16x32_bf16 v[148:151], a[96:99], a[0:3], 0
    v_cvt_pk_bf16_f32 v178, v184, v185
    v_mfma_f32_16x16x32_bf16 v[148:151], a[100:103], a[4:7], v[148:151]
    v_exp_f32 v187, v187
    v_mfma_f32_16x16x32_bf16 v[148:151], a[104:107], a[8:11], v[148:151]
    s_waitcnt lgkmcnt(0)
    v_mfma_f32_16x16x32_bf16 v[148:151], a[108:111], a[12:15], v[148:151]
    v_cvt_pk_bf16_f32 v179, v186, v187
    v_fma_f32 v180, v144, s25, -v192
    v_mfma_f32_16x16x32_bf16 v[148:151], a[112:115], a[16:19], v[148:151]
    s_cmp_lg_u32 s20, 30
    buffer_store_dwordx4 v[228:231], v209, s[16:19], s53 offen offset:0 nt
    v_mfma_f32_16x16x32_bf16 v[148:151], a[116:119], a[20:23], v[148:151]
    s_cbranch_scc1 L_lp2_0
    s_branch L_E
.p2align 6
L_lp2_1:
    v_mfma_f32_16x16x32_bf16 v[240:243], a[216:219], v[176:179], v[240:243]
    s_add_u32 s53, s53, s63
    v_fma_f32 v181, v145, s25, -v192
    v_fma_f32 v182, v146, s25, -v192
    v_mfma_f32_16x16x32_bf16 v[96:99], a[120:123], v[176:179], v[96:99]
    ds_read_b64_tr_b16 a[120:121], v197 offset:0
    ds_read_b64_tr_b16 a[122:123], v197 offset:6144
    v_mfma_f32_16x16x32_bf16 v[100:103], a[124:127], v[176:179], v[100:103]
    v_exp_f32 v180, v180
    v_mfma_f32_16x16x32_bf16 v[104:107], a[128:131], v[176:179], v[104:107]
    ds_read_b64_tr_b16 a[124:125], v198 offset:0
    ds_read_b64_tr_b16 a[126:127], v198 offset:6144
    v_mfma_f32_16x16x32_bf16 v[108:111], a[132:135], v[176:179], v[108:111]
    v_exp_f32 v181, v181
    v_mfma_f32_16x16x32_bf16 v[112:115], a[136:139], v[176:179], v[112:115]
    v_fma_f32 v183, v147, s25, -v192
    v_fma_f32 v184, v148, s25, -v192
    v_mfma_f32_16x16x32_bf16 v[116:119], a[140:143], v[176:179], v[116:119]
    ds_read_b64_tr_b16 a[128:129], v199 offset:0
    ds_read_b64_tr_b16 a[130:131], v199 offset:6144
    v_mfma_f32_16x16x32_bf16 v[120:123], a[144:147], v[176:179], v[120:123]
    v_exp_f32 v182, v182
    v_mfma_f32_16x16x32_bf16 v[124:127], a[148:151], v[176:179], v[124:127]
    ds_read_b64_tr_b16 a[132:133], v200 offset:0
    ds_read_b64_tr_b16 a[134:135], v200 offset:6144
    v_mfma_f32_16x16x32_bf16 v[128:131], a[152:155], v[176:179], v[128:131]
    v_exp_f32 v183, v183
    v_mfma_f32_16x16x32_bf16 v[132:135], a[156:159], v[176:179], v[132:135]
    v_fma_f32 v185, v149, s25, -v192
    v_cvt_pk_bf16_f32 v168, v180, v181
    v_mfma_f32_16x16x32_bf16 v[136:139], a[160:163], v[176:179], v[136:139]
    ds_read_b64_tr_b16 a[136:137], v197 offset:128
    ds_read_b64_tr_b16 a[138:139], v197 offset:6272
    v_mfma_f32_16x16x32_bf16 v[140:143], a[164:167], v[176:179], v[140:143]
    v_exp_f32 v184, v184
    v_mfma_f32_16x16x32_bf16 v[152:155], a[72:75], a[24:27], 0
    s_add_u32 s21, s21, 12288
    ds_read_b64_tr_b16 a[140:141], v198 offset:128
    ds_read_b64_tr_b16 a[142:143], v198 offset:6272
    v_mfma_f32_16x16x32_bf16 v[152:155], a[76:79], a[28:31], v[152:155]
    s_cmp_lt_u32 s20, 29
    v_fma_f32 v186, v150, s25, -v192
    v_cvt_pk_bf16_f32 v169, v182, v183
    v_mfma_f32_16x16x32_bf16 v[152:155], a[80:83], a[32:35], v[152:155]
    s_cselect_b32 s10, s49, 0
    v_exp_f32 v185, v185
    v_mfma_f32_16x16x32_bf16 v[152:155], a[84:87], a[36:39], v[152:155]
    s_cmp_lt_u32 s20, 28
    ds_read_b64_tr_b16 a[144:145], v199 offset:128
    ds_read_b64_tr_b16 a[146:147], v199 offset:6272
    v_mfma_f32_16x16x32_bf16 v[152:155], a[88:91], a[40:43], v[152:155]
    s_cselect_b32 s6, s49, 0
    v_exp_f32 v186, v186
    v_mfma_f32_16x16x32_bf16 v[152:155], a[92:95], a[44:47], v[152:155]
    ds_read_b64_tr_b16 a[148:149], v200 offset:128
    ds_read_b64_tr_b16 a[150:151], v200 offset:6272
    v_mfma_f32_16x16x32_bf16 v[156:159], a[96:99], a[24:27], 0
    v_fma_f32 v187, v151, s25, -v192
    v_cvt_pk_bf16_f32 v170, v184, v185
    v_mfma_f32_16x16x32_bf16 v[156:159], a[100:103], a[28:31], v[156:159]
    ds_read_b64_tr_b16 a[152:153], v197 offset:256
    ds_read_b64_tr_b16 a[154:155], v197 offset:6400
    v_mfma_f32_16x16x32_bf16 v[156:159], a[104:107], a[32:35], v[156:159]
    v_exp_f32 v187, v187
    v_mfma_f32_16x16x32_bf16 v[156:159], a[108:111], a[36:39], v[156:159]
    ds_read_b64_tr_b16 a[156:157], v198 offset:256
    ds_read_b64_tr_b16 a[158:159], v198 offset:6400
    v_mfma_f32_16x16x32_bf16 v[156:159], a[112:115], a[40:43], v[156:159]
    v_add_u32 v208, s63, v208
    v_cvt_pk_bf16_f32 v171, v186, v187
    v_mfma_f32_16x16x32_bf16 v[156:159], a[116:119], a[44:47], v[156:159]
    ds_read_b64_tr_b16 a[160:161], v199 offset:256
    ds_read_b64_tr_b16 a[162:163], v199 offset:6400
    v_mfma_f32_16x16x32_bf16 v[232:235], a[216:219], v[168:171], v[232:235]
    s_waitcnt lgkmcnt(6)
    v_fma_f32 v180, v152, s25, -v193
    v_fma_f32 v181, v153, s25, -v193
    v_mfma_f32_16x16x32_bf16 v[0:3], a[120:123], v[168:171], v[0:3]
    ds_read_b64_tr_b16 a[164:165], v200 offset:256
    ds_read_b64_tr_b16 a[166:167], v200 offset:6400
    v_mfma_f32_16x16x32_bf16 v[4:7], a[124:127], v[168:171], v[4:7]
    v_exp_f32 v180, v180
    v_mfma_f32_16x16x32_bf16 v[8:11], a[128:131], v[168:171], v[8:11]
    v_fma_f32 v182, v154, s25, -v193
    v_fma_f32 v183, v155, s25, -v193
    v_mfma_f32_16x16x32_bf16 v[12:15], a[132:135], v[168:171], v[12:15]
    v_exp_f32 v181, v181
    v_mfma_f32_16x16x32_bf16 v[16:19], a[136:139], v[168:171], v[16:19]
    s_waitcnt vmcnt(8) lgkmcnt(0)
    v_exp_f32 v182, v182
    v_mfma_f32_16x16x32_bf16 v[20:23], a[140:143], v[168:171], v[20:23]
    s_barrier
    v_mfma_f32_16x16x32_bf16 v[24:27], a[144:147], v[168:171], v[24:27]
    s_add_u32 m0, s30, 0
    v_mfma_f32_16x16x32_bf16 v[28:31], a[148:151], v[168:171], v[28:31]
    v_fma_f32 v184, v156, s25, -v193
    v_cvt_pk_bf16_f32 v172, v180, v181
    v_mfma_f32_16x16x32_bf16 v[32:35], a[152:155], v[168:171], v[32:35]
    v_exp_f32 v183, v183
    v_mfma_f32_16x16x32_bf16 v[36:39], a[156:159], v[168:171], v[36:39]
    v_fma_f32 v185, v157, s25, -v193
    v_fma_f32 v186, v158, s25, -v193
    v_mfma_f32_16x16x32_bf16 v[40:43], a[160:163], v[168:171], v[40:43]
    v_exp_f32 v184, v184
    v_mfma_f32_16x16x32_bf16 v[44:47], a[164:167], v[168:171], v[44:47]
    s_nop 0
    buffer_load_dwordx4 v204, s[8:11], s21 offen offset:0 nt lds
    v_mfma_f32_16x16x32_bf16 v[160:163], a[72:75], a[48:51], 0
    v_exp_f32 v185, v185
    v_mfma_f32_16x16x32_bf16 v[160:163], a[76:79], a[52:55], v[160:163]
    ds_read_b128 a[72:75], v195 offset:12288
    v_fma_f32 v187, v159, s25, -v193
    v_mfma_f32_16x16x32_bf16 v[160:163], a[80:83], a[56:59], v[160:163]
    v_exp_f32 v186, v186
    v_mfma_f32_16x16x32_bf16 v[160:163], a[84:87], a[60:63], v[160:163]
    s_nop 0
    buffer_load_dwordx4 v205, s[8:11], s21 offen offset:1024 nt lds
    v_mfma_f32_16x16x32_bf16 v[160:163], a[88:91], a[64:67], v[160:163]
    ds_read_b128 a[76:79], v196 offset:12288
    v_cvt_pk_bf16_f32 v173, v182, v183
    v_mfma_f32_16x16x32_bf16 v[160:163], a[92:95], a[68:71], v[160:163]
    v_exp_f32 v187, v187
    v_mfma_f32_16x16x32_bf16 v[164:167], a[96:99], a[48:51], 0
    ds_read_b128 a[80:83], v195 offset:12416
    v_cvt_pk_bf16_f32 v174, v184, v185
    v_mfma_f32_16x16x32_bf16 v[164:167], a[100:103], a[52:55], v[164:167]
    s_nop 0
    buffer_load_dwordx4 v206, s[8:11], s21 offen offset:2048 nt lds
    v_mfma_f32_16x16x32_bf16 v[164:167], a[104:107], a[56:59], v[164:167]
    s_add_u32 m0, s30, 36864
    ds_read_b128 a[84:87], v196 offset:12416
    v_cvt_pk_bf16_f32 v175, v186, v187
    v_mfma_f32_16x16x32_bf16 v[164:167], a[108:111], a[60:63], v[164:167]
    ds_read_b128 a[88:91], v195 offset:12544
    v_mfma_f32_16x16x32_bf16 v[164:167], a[112:115], a[64:67], v[164:167]
    ds_read_b128 a[92:95], v196 offset:12544
    v_mfma_f32_16x16x32_bf16 v[164:167], a[116:119], a[68:71], v[164:167]
    s_nop 0
    buffer_load_dwordx4 v201, s[4:7], s21 offen offset:0 nt lds
    v_mfma_f32_16x16x32_bf16 v[236:239], a[216:219], v[172:175], v[236:239]
    ds_read_b128 a[96:99], v195 offset:18432
    v_fma_f32 v180, v160, s25, -v194
    v_mfma_f32_16x16x32_bf16 v[48:51], a[120:123], v[172:175], v[48:51]
    v_fma_f32 v181, v161, s25, -v194
    v_fma_f32 v182, v162, s25, -v194
    v_mfma_f32_16x16x32_bf16 v[52:55], a[124:127], v[172:175], v[52:55]
    ds_read_b128 a[100:103], v196 offset:18432
    v_fma_f32 v183, v163, s25, -v194
    v_mfma_f32_16x16x32_bf16 v[56:59], a[128:131], v[172:175], v[56:59]
    s_nop 0
    buffer_load_dwordx4 v202, s[4:7], s21 offen offset:1024 nt lds
    v_mfma_f32_16x16x32_bf16 v[60:63], a[132:135], v[172:175], v[60:63]
    v_exp_f32 v180, v180
    v_mfma_f32_16x16x32_bf16 v[64:67], a[136:139], v[172:175], v[64:67]
    ds_read_b128 a[104:107], v195 offset:18560
    v_fma_f32 v184, v164, s25, -v194
    v_mfma_f32_16x16x32_bf16 v[68:71], a[140:143], v[172:175], v[68:71]
    v_exp_f32 v181, v181
    v_mfma_f32_16x16x32_bf16 v[72:75], a[144:147], v[172:175], v[72:75]
    s_nop 0
    buffer_load_dwordx4 v203, s[4:7], s21 offen offset:2048 nt lds
    v_mfma_f32_16x16x32_bf16 v[76:79], a[148:151], v[172:175], v[76:79]
    ds_read_b128 a[108:111], v196 offset:18560
    v_fma_f32 v185, v165, s25, -v194
    v_mfma_f32_16x16x32_bf16 v[80:83], a[152:155], v[172:175], v[80:83]
    v_exp_f32 v182, v182
    v_mfma_f32_16x16x32_bf16 v[84:87], a[156:159], v[172:175], v[84:87]
    ds_read_b128 a[112:115], v195 offset:18688
    v_cvt_pk_bf16_f32 v176, v180, v181
    v_mfma_f32_16x16x32_bf16 v[88:91], a[160:163], v[172:175], v[88:91]
    s_add_u32 s20, s20, 1
    v_mfma_f32_16x16x32_bf16 v[92:95], a[164:167], v[172:175], v[92:95]
    s_waitcnt lgkmcnt(2)
    ds_read_b128 a[116:119], v196 offset:18688
    v_fma_f32 v186, v166, s25, -v194
    v_mfma_f32_16x16x32_bf16 v[144:147], a[72:75], a[0:3], 0
    s_bitcmp1_b32 s37, s20
    v_exp_f32 v183, v183
    v_mfma_f32_16x16x32_bf16 v[144:147], a[76:79], a[4:7], v[144:147]
    s_cselect_b32 s18, s54, 0
    v_exp_f32 v184, v184
    v_mfma_f32_16x16x32_bf16 v[144:147], a[80:83], a[8:11], v[144:147]
    s_cselect_b32 s63, 1024, 0
    ds_read_b128 v[228:231], v208 offset:0
    v_fma_f32 v187, v167, s25, -v194
    v_mfma_f32_16x16x32_bf16 v[144:147], a[84:87], a[12:15], v[144:147]
    v_exp_f32 v185, v185
    v_mfma_f32_16x16x32_bf16 v[144:147], a[88:91], a[16:19], v[144:147]
    v_cvt_pk_bf16_f32 v177, v182, v183
    v_mfma_f32_16x16x32_bf16 v[144:147], a[92:95], a[20:23], v[144:147]
    v_exp_f32 v186, v186
    v_mfma_f32_16x16x32_bf16 v[148:151], a[96:99], a[0:3], 0
    v_cvt_pk_bf16_f32 v178, v184, v185
    v_mfma_f32_16x16x32_bf16 v[148:151], a[100:103], a[4:7], v[148:151]
    v_exp_f32 v187, v187
    v_mfma_f32_16x16x32_bf16 v[148:151], a[104:107], a[8:11], v[148:151]
    s_waitcnt lgkmcnt(0)
    v_mfma_f32_16x16x32_bf16 v[148:151], a[108:111], a[12:15], v[148:151]
    v_cvt_pk_bf16_f32 v179, v186, v187
    v_fma_f32 v180, v144, s25, -v192
    v_mfma_f32_16x16x32_bf16 v[148:151], a[112:115], a[16:19], v[148:151]
    s_nop 0
    buffer_store_dwordx4 v[228:231], v209, s[16:19], s53 offen offset:0 nt
    v_mfma_f32_16x16x32_bf16 v[148:151], a[116:119], a[20:23], v[148:151]
    v_mfma_f32_16x16x32_bf16 v[240:243], a[216:219], v[176:179], v[240:243]
    s_add_u32 s53, s53, s63
    v_fma_f32 v181, v145, s25, -v192
    v_fma_f32 v182, v146, s25, -v192
    v_mfma_f32_16x16x32_bf16 v[96:99], a[120:123], v[176:179], v[96:99]
    ds_read_b64_tr_b16 a[120:121], v197 offset:12288
    ds_read_b64_tr_b16 a[122:123], v197 offset:18432
    v_mfma_f32_16x16x32_bf16 v[100:103], a[124:127], v[176:179], v[100:103]
    v_exp_f32 v180, v180
    v_mfma_f32_16x16x32_bf16 v[104:107], a[128:131], v[176:179], v[104:107]
    ds_read_b64_tr_b16 a[124:125], v198 offset:12288
    ds_read_b64_tr_b16 a[126:127], v198 offset:18432
    v_mfma_f32_16x16x32_bf16 v[108:111], a[132:135], v[176:179], v[108:111]
    v_exp_f32 v181, v181
    v_mfma_f32_16x16x32_bf16 v[112:115], a[136:139], v[176:179], v[112:115]
    v_fma_f32 v183, v147, s25, -v192
    v_fma_f32 v184, v148, s25, -v192
    v_mfma_f32_16x16x32_bf16 v[116:119], a[140:143], v[176:179], v[116:119]
    ds_read_b64_tr_b16 a[128:129], v199 offset:12288
    ds_read_b64_tr_b16 a[130:131], v199 offset:18432
    v_mfma_f32_16x16x32_bf16 v[120:123], a[144:147], v[176:179], v[120:123]
    v_exp_f32 v182, v182
    v_mfma_f32_16x16x32_bf16 v[124:127], a[148:151], v[176:179], v[124:127]
    ds_read_b64_tr_b16 a[132:133], v200 offset:12288
    ds_read_b64_tr_b16 a[134:135], v200 offset:18432
    v_mfma_f32_16x16x32_bf16 v[128:131], a[152:155], v[176:179], v[128:131]
    v_exp_f32 v183, v183
    v_mfma_f32_16x16x32_bf16 v[132:135], a[156:159], v[176:179], v[132:135]
    v_fma_f32 v185, v149, s25, -v192
    v_cvt_pk_bf16_f32 v168, v180, v181
    v_mfma_f32_16x16x32_bf16 v[136:139], a[160:163], v[176:179], v[136:139]
    ds_read_b64_tr_b16 a[136:137], v197 offset:12416
    ds_read_b64_tr_b16 a[138:139], v197 offset:18560
    v_mfma_f32_16x16x32_bf16 v[140:143], a[164:167], v[176:179], v[140:143]
    v_exp_f32 v184, v184
    v_mfma_f32_16x16x32_bf16 v[152:155], a[72:75], a[24:27], 0
    s_add_u32 s21, s21, 12288
    ds_read_b64_tr_b16 a[140:141], v198 offset:12416
    ds_read_b64_tr_b16 a[142:143], v198 offset:18560
    v_mfma_f32_16x16x32_bf16 v[152:155], a[76:79], a[28:31], v[152:155]
    s_cmp_lt_u32 s20, 29
    v_fma_f32 v186, v150, s25, -v192
    v_cvt_pk_bf16_f32 v169, v182, v183
    v_mfma_f32_16x16x32_bf16 v[152:155], a[80:83], a[32:35], v[152:155]
    s_cselect_b32 s10, s49, 0
    v_exp_f32 v185, v185
    v_mfma_f32_16x16x32_bf16 v[152:155], a[84:87], a[36:39], v[152:155]
    s_cmp_lt_u32 s20, 28
    ds_read_b64_tr_b16 a[144:145], v199 offset:12416
    ds_read_b64_tr_b16 a[146:147], v199 offset:18560
    v_mfma_f32_16x16x32_bf16 v[152:155], a[88:91], a[40:43], v[152:155]
    s_cselect_b32 s6, s49, 0
    v_exp_f32 v186, v186
    v_mfma_f32_16x16x32_bf16 v[152:155], a[92:95], a[44:47], v[152:155]
    ds_read_b64_tr_b16 a[148:149], v200 offset:12416
    ds_read_b64_tr_b16 a[150:151], v200 offset:18560
    v_mfma_f32_16x16x32_bf16 v[156:159], a[96:99], a[24:27], 0
    v_fma_f32 v187, v151, s25, -v192
    v_cvt_pk_bf16_f32 v170, v184, v185
    v_mfma_f32_16x16x32_bf16 v[156:159], a[100:103], a[28:31], v[156:159]
    ds_read_b64_tr_b16 a[152:153], v197 offset:12544
    ds_read_b64_tr_b16 a[154:155], v197 offset:18688
    v_mfma_f32_16x16x32_bf16 v[156:159], a[104:107], a[32:35], v[156:159]
    v_exp_f32 v187, v187
    v_mfma_f32_16x16x32_bf16 v[156:159], a[108:111], a[36:39], v[156:159]
    ds_read_b64_tr_b16 a[156:157], v198 offset:12544
    ds_read_b64_tr_b16 a[158:159], v198 offset:18688
    v_mfma_f32_16x16x32_bf16 v[156:159], a[112:115], a[40:43], v[156:159]
    v_add_u32 v208, s63, v208
    v_cvt_pk_bf16_f32 v171, v186, v187
    v_mfma_f32_16x16x32_bf16 v[156:159], a[116:119], a[44:47], v[156:159]
    ds_read_b64_tr_b16 a[160:161], v199 offset:12544
    ds_read_b64_tr_b16 a[162:163], v199 offset:18688
    v_mfma_f32_16x16x32_bf16 v[232:235], a[216:219], v[168:171], v[232:235]
    s_waitcnt lgkmcnt(6)
    v_fma_f32 v180, v152, s25, -v193
    v_fma_f32 v181, v153, s25, -v193
    v_mfma_f32_16x16x32_bf16 v[0:3], a[120:123], v[168:171], v[0:3]
    ds_read_b64_tr_b16 a[164:165], v200 offset:12544
    ds_read_b64_tr_b16 a[166:167], v200 offset:18688
    v_mfma_f32_16x16x32_bf16 v[4:7], a[124:127], v[168:171], v[4:7]
    v_exp_f32 v180, v180
    v_mfma_f32_16x16x32_bf16 v[8:11], a[128:131], v[168:171], v[8:11]
    v_fma_f32 v182, v154, s25, -v193
    v_fma_f32 v183, v155, s25, -v193
    v_mfma_f32_16x16x32_bf16 v[12:15], a[132:135], v[168:171], v[12:15]
    v_exp_f32 v181, v181
    v_mfma_f32_16x16x32_bf16 v[16:19], a[136:139], v[168:171], v[16:19]
    s_waitcnt vmcnt(8) lgkmcnt(0)
    v_exp_f32 v182, v182
    v_mfma_f32_16x16x32_bf16 v[20:23], a[140:143], v[168:171], v[20:23]
    s_barrier
    v_mfma_f32_16x16x32_bf16 v[24:27], a[144:147], v[168:171], v[24:27]
    s_add_u32 m0, s30, 12288
    v_mfma_f32_16x16x32_bf16 v[28:31], a[148:151], v[168:171], v[28:31]
    v_fma_f32 v184, v156, s25, -v193
    v_cvt_pk_bf16_f32 v172, v180, v181
    v_mfma_f32_16x16x32_bf16 v[32:35], a[152:155], v[168:171], v[32:35]
    v_exp_f32 v183, v183
    v_mfma_f32_16x16x32_bf16 v[36:39], a[156:159], v[168:171], v[36:39]
    v_fma_f32 v185, v157, s25, -v193
    v_fma_f32 v186, v158, s25, -v193
    v_mfma_f32_16x16x32_bf16 v[40:43], a[160:163], v[168:171], v[40:43]
    v_exp_f32 v184, v184
    v_mfma_f32_16x16x32_bf16 v[44:47], a[164:167], v[168:171], v[44:47]
    s_nop 0
    buffer_load_dwordx4 v204, s[8:11], s21 offen offset:0 nt lds
    v_mfma_f32_16x16x32_bf16 v[160:163], a[72:75], a[48:51], 0
    v_exp_f32 v185, v185
    v_mfma_f32_16x16x32_bf16 v[160:163], a[76:79], a[52:55], v[160:163]
    ds_read_b128 a[72:75], v195 offset:24576
    v_fma_f32 v187, v159, s25, -v193
    v_mfma_f32_16x16x32_bf16 v[160:163], a[80:83], a[56:59], v[160:163]
    v_exp_f32 v186, v186
    v_mfma_f32_16x16x32_bf16 v[160:163], a[84:87], a[60:63], v[160:163]
    s_nop 0
    buffer_load_dwordx4 v205, s[8:11], s21 offen offset:1024 nt lds
    v_mfma_f32_16x16x32_bf16 v[160:163], a[88:91], a[64:67], v[160:163]
    ds_read_b128 a[76:79], v196 offset:24576
    v_cvt_pk_bf16_f32 v173, v182, v183
    v_mfma_f32_16x16x32_bf16 v[160:163], a[92:95], a[68:71], v[160:163]
    v_exp_f32 v187, v187
    v_mfma_f32_16x16x32_bf16 v[164:167], a[96:99], a[48:51], 0
    ds_read_b128 a[80:83], v195 offset:24704
    v_cvt_pk_bf16_f32 v174, v184, v185
    v_mfma_f32_16x16x32_bf16 v[164:167], a[100:103], a[52:55], v[164:167]
    s_nop 0
    buffer_load_dwordx4 v206, s[8:11], s21 offen offset:2048 nt lds
    v_mfma_f32_16x16x32_bf16 v[164:167], a[104:107], a[56:59], v[164:167]
    s_add_u32 m0, s30, 49152
    ds_read_b128 a[84:87], v196 offset:24704
    v_cvt_pk_bf16_f32 v175, v186, v187
    v_mfma_f32_16x16x32_bf16 v[164:167], a[108:111], a[60:63], v[164:167]
    ds_read_b128 a[88:91], v195 offset:24832
    v_mfma_f32_16x16x32_bf16 v[164:167], a[112:115], a[64:67], v[164:167]
    ds_read_b128 a[92:95], v196 offset:24832
    v_mfma_f32_16x16x32_bf16 v[164:167], a[116:119], a[68:71], v[164:167]
    s_nop 0
    buffer_load_dwordx4 v201, s[4:7], s21 offen offset:0 nt lds
    v_mfma_f32_16x16x32_bf16 v[236:239], a[216:219], v[172:175], v[236:239]
    ds_read_b128 a[96:99], v195 offset:30720
    v_fma_f32 v180, v160, s25, -v194
    v_mfma_f32_16x16x32_bf16 v[48:51], a[120:123], v[172:175], v[48:51]
    v_fma_f32 v181, v161, s25, -v194
    v_fma_f32 v182, v162, s25, -v194
    v_mfma_f32_16x16x32_bf16 v[52:55], a[124:127], v[172:175], v[52:55]
    ds_read_b128 a[100:103], v196 offset:30720
    v_fma_f32 v183, v163, s25, -v194
    v_mfma_f32_16x16x32_bf16 v[56:59], a[128:131], v[172:175], v[56:59]
    s_nop 0
    buffer_load_dwordx4 v202, s[4:7], s21 offen offset:1024 nt lds
    v_mfma_f32_16x16x32_bf16 v[60:63], a[132:135], v[172:175], v[60:63]
    v_exp_f32 v180, v180
    v_mfma_f32_16x16x32_bf16 v[64:67], a[136:139], v[172:175], v[64:67]
    ds_read_b128 a[104:107], v195 offset:30848
    v_fma_f32 v184, v164, s25, -v194
    v_mfma_f32_16x16x32_bf16 v[68:71], a[140:143], v[172:175], v[68:71]
    v_exp_f32 v181, v181
    v_mfma_f32_16x16x32_bf16 v[72:75], a[144:147], v[172:175], v[72:75]
    s_nop 0
    buffer_load_dwordx4 v203, s[4:7], s21 offen offset:2048 nt lds
    v_mfma_f32_16x16x32_bf16 v[76:79], a[148:151], v[172:175], v[76:79]
    ds_read_b128 a[108:111], v196 offset:30848
    v_fma_f32 v185, v165, s25, -v194
    v_mfma_f32_16x16x32_bf16 v[80:83], a[152:155], v[172:175], v[80:83]
    v_exp_f32 v182, v182
    v_mfma_f32_16x16x32_bf16 v[84:87], a[156:159], v[172:175], v[84:87]
    ds_read_b128 a[112:115], v195 offset:30976
    v_cvt_pk_bf16_f32 v176, v180, v181
    v_mfma_f32_16x16x32_bf16 v[88:91], a[160:163], v[172:175], v[88:91]
    s_add_u32 s20, s20, 1
    v_mfma_f32_16x16x32_bf16 v[92:95], a[164:167], v[172:175], v[92:95]
    s_waitcnt lgkmcnt(2)
    ds_read_b128 a[116:119], v196 offset:30976
    v_fma_f32 v186, v166, s25, -v194
    v_mfma_f32_16x16x32_bf16 v[144:147], a[72:75], a[0:3], 0
    s_bitcmp1_b32 s37, s20
    v_exp_f32 v183, v183
    v_mfma_f32_16x16x32_bf16 v[144:147], a[76:79], a[4:7], v[144:147]
    s_cselect_b32 s18, s54, 0
    v_exp_f32 v184, v184
    v_mfma_f32_16x16x32_bf16 v[144:147], a[80:83], a[8:11], v[144:147]
    s_cselect_b32 s63, 1024, 0
    ds_read_b128 v[228:231], v208 offset:0
    v_fma_f32 v187, v167, s25, -v194
    v_mfma_f32_16x16x32_bf16 v[144:147], a[84:87], a[12:15], v[144:147]
    v_exp_f32 v185, v185
    v_mfma_f32_16x16x32_bf16 v[144:147], a[88:91], a[16:19], v[144:147]
    v_cvt_pk_bf16_f32 v177, v182, v183
    v_mfma_f32_16x16x32_bf16 v[144:147], a[92:95], a[20:23], v[144:147]
    v_exp_f32 v186, v186
    v_mfma_f32_16x16x32_bf16 v[148:151], a[96:99], a[0:3], 0
    v_cvt_pk_bf16_f32 v178, v184, v185
    v_mfma_f32_16x16x32_bf16 v[148:151], a[100:103], a[4:7], v[148:151]
    v_exp_f32 v187, v187
    v_mfma_f32_16x16x32_bf16 v[148:151], a[104:107], a[8:11], v[148:151]
    s_waitcnt lgkmcnt(0)
    v_mfma_f32_16x16x32_bf16 v[148:151], a[108:111], a[12:15], v[148:151]
    v_cvt_pk_bf16_f32 v179, v186, v187
    v_fma_f32 v180, v144, s25, -v192
    v_mfma_f32_16x16x32_bf16 v[148:151], a[112:115], a[16:19], v[148:151]
    s_nop 0
    buffer_store_dwordx4 v[228:231], v209, s[16:19], s53 offen offset:0 nt
    v_mfma_f32_16x16x32_bf16 v[148:151], a[116:119], a[20:23], v[148:151]
    v_mfma_f32_16x16x32_bf16 v[240:243], a[216:219], v[176:179], v[240:243]
    s_add_u32 s53, s53, s63
    v_fma_f32 v181, v145, s25, -v192
    v_fma_f32 v182, v146, s25, -v192
    v_mfma_f32_16x16x32_bf16 v[96:99], a[120:123], v[176:179], v[96:99]
    ds_read_b64_tr_b16 a[120:121], v197 offset:24576
    ds_read_b64_tr_b16 a[122:123], v197 offset:30720
    v_mfma_f32_16x16x32_bf16 v[100:103], a[124:127], v[176:179], v[100:103]
    v_exp_f32 v180, v180
    v_mfma_f32_16x16x32_bf16 v[104:107], a[128:131], v[176:179], v[104:107]
    ds_read_b64_tr_b16 a[124:125], v198 offset:24576
    ds_read_b64_tr_b16 a[126:127], v198 offset:30720
    v_mfma_f32_16x16x32_bf16 v[108:111], a[132:135], v[176:179], v[108:111]
    v_exp_f32 v181, v181
    v_mfma_f32_16x16x32_bf16 v[112:115], a[136:139], v[176:179], v[112:115]
    v_fma_f32 v183, v147, s25, -v192
    v_fma_f32 v184, v148, s25, -v192
    v_mfma_f32_16x16x32_bf16 v[116:119], a[140:143], v[176:179], v[116:119]
    ds_read_b64_tr_b16 a[128:129], v199 offset:24576
    ds_read_b64_tr_b16 a[130:131], v199 offset:30720
    v_mfma_f32_16x16x32_bf16 v[120:123], a[144:147], v[176:179], v[120:123]
    v_exp_f32 v182, v182
    v_mfma_f32_16x16x32_bf16 v[124:127], a[148:151], v[176:179], v[124:127]
    ds_read_b64_tr_b16 a[132:133], v200 offset:24576
    ds_read_b64_tr_b16 a[134:135], v200 offset:30720
    v_mfma_f32_16x16x32_bf16 v[128:131], a[152:155], v[176:179], v[128:131]
    v_exp_f32 v183, v183
    v_mfma_f32_16x16x32_bf16 v[132:135], a[156:159], v[176:179], v[132:135]
    v_fma_f32 v185, v149, s25, -v192
    v_cvt_pk_bf16_f32 v168, v180, v181
    v_mfma_f32_16x16x32_bf16 v[136:139], a[160:163], v[176:179], v[136:139]
    ds_read_b64_tr_b16 a[136:137], v197 offset:24704
    ds_read_b64_tr_b16 a[138:139], v197 offset:30848
    v_mfma_f32_16x16x32_bf16 v[140:143], a[164:167], v[176:179], v[140:143]
    v_exp_f32 v184, v184
L_mid1:
    v_mfma_f32_16x16x32_bf16 v[152:155], a[72:75], a[24:27], 0
    s_add_u32 s21, s21, 12288
    ds_read_b64_tr_b16 a[140:141], v198 offset:24704
    ds_read_b64_tr_b16 a[142:143], v198 offset:30848
    v_mfma_f32_16x16x32_bf16 v[152:155], a[76:79], a[28:31], v[152:155]
    s_cmp_lt_u32 s20, 29
    v_fma_f32 v186, v150, s25, -v192
    v_cvt_pk_bf16_f32 v169, v182, v183
    v_mfma_f32_16x16x32_bf16 v[152:155], a[80:83], a[32:35], v[152:155]
    s_cselect_b32 s10, s49, 0
    v_exp_f32 v185, v185
    v_mfma_f32_16x16x32_bf16 v[152:155], a[84:87], a[36:39], v[152:155]
    s_cmp_lt_u32 s20, 28
    ds_read_b64_tr_b16 a[144:145], v199 offset:24704
    ds_read_b64_tr_b16 a[146:147], v199 offset:30848
    v_mfma_f32_16x16x32_bf16 v[152:155], a[88:91], a[40:43], v[152:155]
    s_cselect_b32 s6, s49, 0
    v_exp_f32 v186, v186
    v_mfma_f32_16x16x32_bf16 v[152:155], a[92:95], a[44:47], v[152:155]
    ds_read_b64_tr_b16 a[148:149], v200 offset:24704
    ds_read_b64_tr_b16 a[150:151], v200 offset:30848
    v_mfma_f32_16x16x32_bf16 v[156:159], a[96:99], a[24:27], 0
    v_fma_f32 v187, v151, s25, -v192
    v_cvt_pk_bf16_f32 v170, v184, v185
    v_mfma_f32_16x16x32_bf16 v[156:159], a[100:103], a[28:31], v[156:159]
    ds_read_b64_tr_b16 a[152:153], v197 offset:24832
    ds_read_b64_tr_b16 a[154:155], v197 offset:30976
    v_mfma_f32_16x16x32_bf16 v[156:159], a[104:107], a[32:35], v[156:159]
    v_exp_f32 v187, v187
    v_mfma_f32_16x16x32_bf16 v[156:159], a[108:111], a[36:39], v[156:159]
    ds_read_b64_tr_b16 a[156:157], v198 offset:24832
    ds_read_b64_tr_b16 a[158:159], v198 offset:30976
    v_mfma_f32_16x16x32_bf16 v[156:159], a[112:115], a[40:43], v[156:159]
    v_add_u32 v208, s63, v208
    v_cvt_pk_bf16_f32 v171, v186, v187
    v_mfma_f32_16x16x32_bf16 v[156:159], a[116:119], a[44:47], v[156:159]
    ds_read_b64_tr_b16 a[160:161], v199 offset:24832
    ds_read_b64_tr_b16 a[162:163], v199 offset:30976
    v_mfma_f32_16x16x32_bf16 v[232:235], a[216:219], v[168:171], v[232:235]
    s_waitcnt lgkmcnt(6)
    v_fma_f32 v180, v152, s25, -v193
    v_fma_f32 v181, v153, s25, -v193
    v_mfma_f32_16x16x32_bf16 v[0:3], a[120:123], v[168:171], v[0:3]
    ds_read_b64_tr_b16 a[164:165], v200 offset:24832
    ds_read_b64_tr_b16 a[166:167], v200 offset:30976
    v_mfma_f32_16x16x32_bf16 v[4:7], a[124:127], v[168:171], v[4:7]
    v_exp_f32 v180, v180
    v_mfma_f32_16x16x32_bf16 v[8:11], a[128:131], v[168:171], v[8:11]
    v_fma_f32 v182, v154, s25, -v193
    v_fma_f32 v183, v155, s25, -v193
    v_mfma_f32_16x16x32_bf16 v[12:15], a[132:135], v[168:171], v[12:15]
    v_exp_f32 v181, v181
    v_mfma_f32_16x16x32_bf16 v[16:19], a[136:139], v[168:171], v[16:19]
    s_waitcnt vmcnt(8) lgkmcnt(0)
    v_exp_f32 v182, v182
    v_mfma_f32_16x16x32_bf16 v[20:23], a[140:143], v[168:171], v[20:23]
    s_barrier
    v_mfma_f32_16x16x32_bf16 v[24:27], a[144:147], v[168:171], v[24:27]
    s_add_u32 m0, s30, 24576
    v_mfma_f32_16x16x32_bf16 v[28:31], a[148:151], v[168:171], v[28:31]
    v_fma_f32 v184, v156, s25, -v193
    v_cvt_pk_bf16_f32 v172, v180, v181
    v_mfma_f32_16x16x32_bf16 v[32:35], a[152:155], v[168:171], v[32:35]
    v_exp_f32 v183, v183
    v_mfma_f32_16x16x32_bf16 v[36:39], a[156:159], v[168:171], v[36:39]
    v_fma_f32 v185, v157, s25, -v193
    v_fma_f32 v186, v158, s25, -v193
    v_mfma_f32_16x16x32_bf16 v[40:43], a[160:163], v[168:171], v[40:43]
    v_exp_f32 v184, v184
    v_mfma_f32_16x16x32_bf16 v[44:47], a[164:167], v[168:171], v[44:47]
    s_nop 0
    buffer_load_dwordx4 v204, s[8:11], s21 offen offset:0 nt lds
    v_mfma_f32_16x16x32_bf16 v[160:163], a[72:75], a[48:51], 0
    v_exp_f32 v185, v185
    v_mfma_f32_16x16x32_bf16 v[160:163], a[76:79], a[52:55], v[160:163]
    ds_read_b128 a[72:75], v195 offset:0
    v_fma_f32 v187, v159, s25, -v193
    v_mfma_f32_16x16x32_bf16 v[160:163], a[80:83], a[56:59], v[160:163]
    v_exp_f32 v186, v186
    v_mfma_f32_16x16x32_bf16 v[160:163], a[84:87], a[60:63], v[160:163]
    s_nop 0
    buffer_load_dwordx4 v205, s[8:11], s21 offen offset:1024 nt lds
    v_mfma_f32_16x16x32_bf16 v[160:163], a[88:91], a[64:67], v[160:163]
    ds_read_b128 a[76:79], v196 offset:0
    v_cvt_pk_bf16_f32 v173, v182, v183
    v_mfma_f32_16x16x32_bf16 v[160:163], a[92:95], a[68:71], v[160:163]
    v_exp_f32 v187, v187
    v_mfma_f32_16x16x32_bf16 v[164:167], a[96:99], a[48:51], 0
    ds_read_b128 a[80:83], v195 offset:128
    v_cvt_pk_bf16_f32 v174, v184, v185
    v_mfma_f32_16x16x32_bf16 v[164:167], a[100:103], a[52:55], v[164:167]
    s_nop 0
    buffer_load_dwordx4 v206, s[8:11], s21 offen offset:2048 nt lds
    v_mfma_f32_16x16x32_bf16 v[164:167], a[104:107], a[56:59], v[164:167]
    s_add_u32 m0, s30, 61440
    ds_read_b128 a[84:87], v196 offset:128
    v_cvt_pk_bf16_f32 v175, v186, v187
    v_mfma_f32_16x16x32_bf16 v[164:167], a[108:111], a[60:63], v[164:167]
    ds_read_b128 a[88:91], v195 offset:256
    v_mfma_f32_16x16x32_bf16 v[164:167], a[112:115], a[64:67], v[164:167]
    ds_read_b128 a[92:95], v196 offset:256
    v_mfma_f32_16x16x32_bf16 v[164:167], a[116:119], a[68:71], v[164:167]
    s_nop 0
    buffer_load_dwordx4 v201, s[4:7], s21 offen offset:0 nt lds
    v_mfma_f32_16x16x32_bf16 v[236:239], a[216:219], v[172:175], v[236:239]
    ds_read_b128 a[96:99], v195 offset:6144
    v_fma_f32 v180, v160, s25, -v194
    v_mfma_f32_16x16x32_bf16 v[48:51], a[120:123], v[172:175], v[48:51]
    v_fma_f32 v181, v161, s25, -v194
    v_fma_f32 v182, v162, s25, -v194
    v_mfma_f32_16x16x32_bf16 v[52:55], a[124:127], v[172:175], v[52:55]
    ds_read_b128 a[100:103], v196 offset:6144
    v_fma_f32 v183, v163, s25, -v194
    v_mfma_f32_16x16x32_bf16 v[56:59], a[128:131], v[172:175], v[56:59]
    s_nop 0
    buffer_load_dwordx4 v202, s[4:7], s21 offen offset:1024 nt lds
    v_mfma_f32_16x16x32_bf16 v[60:63], a[132:135], v[172:175], v[60:63]
    v_exp_f32 v180, v180
    v_mfma_f32_16x16x32_bf16 v[64:67], a[136:139], v[172:175], v[64:67]
    ds_read_b128 a[104:107], v195 offset:6272
    v_fma_f32 v184, v164, s25, -v194
    v_mfma_f32_16x16x32_bf16 v[68:71], a[140:143], v[172:175], v[68:71]
    v_exp_f32 v181, v181
    v_mfma_f32_16x16x32_bf16 v[72:75], a[144:147], v[172:175], v[72:75]
    s_nop 0
    buffer_load_dwordx4 v203, s[4:7], s21 offen offset:2048 nt lds
    v_mfma_f32_16x16x32_bf16 v[76:79], a[148:151], v[172:175], v[76:79]
    ds_read_b128 a[108:111], v196 offset:6272
    v_fma_f32 v185, v165, s25, -v194
    v_mfma_f32_16x16x32_bf16 v[80:83], a[152:155], v[172:175], v[80:83]
    v_exp_f32 v182, v182
    v_mfma_f32_16x16x32_bf16 v[84:87], a[156:159], v[172:175], v[84:87]
    ds_read_b128 a[112:115], v195 offset:6400
    v_cvt_pk_bf16_f32 v176, v180, v181
    v_mfma_f32_16x16x32_bf16 v[88:91], a[160:163], v[172:175], v[88:91]
    s_add_u32 s20, s20, 1
    v_mfma_f32_16x16x32_bf16 v[92:95], a[164:167], v[172:175], v[92:95]
    s_waitcnt lgkmcnt(2)
    ds_read_b128 a[116:119], v196 offset:6400
    v_fma_f32 v186, v166, s25, -v194
    v_mfma_f32_16x16x32_bf16 v[144:147], a[72:75], a[0:3], 0
    s_bitcmp1_b32 s37, s20
    v_exp_f32 v183, v183
    v_mfma_f32_16x16x32_bf16 v[144:147], a[76:79], a[4:7], v[144:147]
    s_cselect_b32 s18, s54, 0
    v_exp_f32 v184, v184
    v_mfma_f32_16x16x32_bf16 v[144:147], a[80:83], a[8:11], v[144:147]
    s_cselect_b32 s63, 1024, 0
    ds_read_b128 v[228:231], v208 offset:0
    v_fma_f32 v187, v167, s25, -v194
    v_mfma_f32_16x16x32_bf16 v[144:147], a[84:87], a[12:15], v[144:147]
    v_exp_f32 v185, v185
    v_mfma_f32_16x16x32_bf16 v[144:147], a[88:91], a[16:19], v[144:147]
    v_cvt_pk_bf16_f32 v177, v182, v183
    v_mfma_f32_16x16x32_bf16 v[144:147], a[92:95], a[20:23], v[144:147]
    v_exp_f32 v186, v186
    v_mfma_f32_16x16x32_bf16 v[148:151], a[96:99], a[0:3], 0
    v_cvt_pk_bf16_f32 v178, v184, v185
    v_mfma_f32_16x16x32_bf16 v[148:151], a[100:103], a[4:7], v[148:151]
    v_exp_f32 v187, v187
    v_mfma_f32_16x16x32_bf16 v[148:151], a[104:107], a[8:11], v[148:151]
    s_waitcnt lgkmcnt(0)
    v_mfma_f32_16x16x32_bf16 v[148:151], a[108:111], a[12:15], v[148:151]
    v_cvt_pk_bf16_f32 v179, v186, v187
    v_fma_f32 v180, v144, s25, -v192
    v_mfma_f32_16x16x32_bf16 v[148:151], a[112:115], a[16:19], v[148:151]
    s_cmp_lg_u32 s20, 30
    buffer_store_dwordx4 v[228:231], v209, s[16:19], s53 offen offset:0 nt
    v_mfma_f32_16x16x32_bf16 v[148:151], a[116:119], a[20:23], v[148:151]
    s_cbranch_scc1 L_lp2_1
L_E:
    v_mfma_f32_16x16x32_bf16 v[240:243], a[216:219], v[176:179], v[240:243]
    s_add_u32 s53, s53, s63
    ds_read_b128 a[168:171], v248 offset:0
    ds_read_b128 a[172:175], v249 offset:0
    v_fma_f32 v181, v145, s25, -v192
    v_exp_f32 v180, v180
    v_add_u32 v208, s63, v208
    v_mfma_f32_16x16x32_bf16 v[96:99], a[120:123], v[176:179], v[96:99]
    s_add_u32 s27, s53, 4096
    ds_read_b128 a[176:179], v248 offset:128
    ds_read_b128 a[180:183], v249 offset:128
    v_mfma_f32_16x16x32_bf16 v[100:103], a[124:127], v[176:179], v[100:103]
    s_mov_b32 s18, s54
    ds_read_b128 a[184:187], v248 offset:256
    ds_read_b128 a[188:191], v249 offset:256
    v_exp_f32 v181, v181
    v_mfma_f32_16x16x32_bf16 v[104:107], a[128:131], v[176:179], v[104:107]
    ds_read_b128 a[192:195], v248 offset:6144
    ds_read_b128 a[196:199], v249 offset:6144
    v_mfma_f32_16x16x32_bf16 v[108:111], a[132:135], v[176:179], v[108:111]
    ds_read_b128 a[200:203], v248 offset:6272
    ds_read_b128 a[204:207], v249 offset:6272
    v_fma_f32 v182, v146, s25, -v192
    v_fma_f32 v183, v147, s25, -v192
    v_mfma_f32_16x16x32_bf16 v[112:115], a[136:139], v[176:179], v[112:115]
    ds_read_b128 a[208:211], v248 offset:6400
    ds_read_b128 a[212:215], v249 offset:6400
    v_exp_f32 v182, v182
    v_mfma_f32_16x16x32_bf16 v[116:119], a[140:143], v[176:179], v[116:119]
    ds_read_b64_tr_b16 a[120:121], v197 offset:0
    ds_read_b64_tr_b16 a[122:123], v197 offset:6144
    v_mfma_f32_16x16x32_bf16 v[120:123], a[144:147], v[176:179], v[120:123]
    ds_read_b64_tr_b16 a[124:125], v198 offset:0
    ds_read_b64_tr_b16 a[126:127], v198 offset:6144
    v_exp_f32 v183, v183
    v_mfma_f32_16x16x32_bf16 v[124:127], a[148:151], v[176:179], v[124:127]
    ds_read_b64_tr_b16 a[128:129], v199 offset:0
    ds_read_b64_tr_b16 a[130:131], v199 offset:6144
    v_cvt_pk_bf16_f32 v168, v180, v181
    v_mfma_f32_16x16x32_bf16 v[128:131], a[152:155], v[176:179], v[128:131]
    ds_read_b64_tr_b16 a[132:133], v200 offset:0
    ds_read_b64_tr_b16 a[134:135], v200 offset:6144
    v_fma_f32 v184, v148, s25, -v192
    v_mfma_f32_16x16x32_bf16 v[132:135], a[156:159], v[176:179], v[132:135]
    ds_read_b64_tr_b16 a[136:137], v197 offset:128
    ds_read_b64_tr_b16 a[138:139], v197 offset:6272
    v_fma_f32 v185, v149, s25, -v192
    v_mfma_f32_16x16x32_bf16 v[136:139], a[160:163], v[176:179], v[136:139]
    ds_read_b64_tr_b16 a[140:141], v198 offset:128
    ds_read_b64_tr_b16 a[142:143], v198 offset:6272
    v_exp_f32 v184, v184
    v_mfma_f32_16x16x32_bf16 v[140:143], a[164:167], v[176:179], v[140:143]
    s_waitcnt lgkmcnt(10)
    ds_read_b64_tr_b16 a[144:145], v199 offset:128
    ds_read_b64_tr_b16 a[146:147], v199 offset:6272
    v_mfma_f32_16x16x32_bf16 v[152:155], a[168:171], a[0:3], 0
    ds_read_b64_tr_b16 a[148:149], v200 offset:128
    ds_read_b64_tr_b16 a[150:151], v200 offset:6272
    v_cvt_pk_bf16_f32 v169, v182, v183
    v_exp_f32 v185, v185
    v_mfma_f32_16x16x32_bf16 v[152:155], a[172:175], a[4:7], v[152:155]
    ds_read_b64_tr_b16 a[152:153], v197 offset:256
    ds_read_b64_tr_b16 a[154:155], v197 offset:6400
    v_mfma_f32_16x16x32_bf16 v[152:155], a[176:179], a[8:11], v[152:155]
    ds_read_b64_tr_b16 a[156:157], v198 offset:256
    ds_read_b64_tr_b16 a[158:159], v198 offset:6400
    v_fma_f32 v186, v150, s25, -v192
    v_mfma_f32_16x16x32_bf16 v[152:155], a[180:183], a[12:15], v[152:155]
    ds_read_b64_tr_b16 a[160:161], v199 offset:256
    ds_read_b64_tr_b16 a[162:163], v199 offset:6400
    v_fma_f32 v187, v151, s25, -v192
    v_mfma_f32_16x16x32_bf16 v[152:155], a[184:187], a[16:19], v[152:155]
    ds_read_b64_tr_b16 a[164:165], v200 offset:256
    ds_read_b64_tr_b16 a[166:167], v200 offset:6400
    v_exp_f32 v186, v186
    v_mfma_f32_16x16x32_bf16 v[152:155], a[188:191], a[20:23], v[152:155]
    v_cvt_pk_bf16_f32 v170, v184, v185
    v_mfma_f32_16x16x32_bf16 v[156:159], a[192:195], a[0:3], 0
    v_exp_f32 v187, v187
    v_mfma_f32_16x16x32_bf16 v[156:159], a[196:199], a[4:7], v[156:159]
    v_mfma_f32_16x16x32_bf16 v[156:159], a[200:203], a[8:11], v[156:159]
    s_waitcnt vmcnt(8) lgkmcnt(0)
    v_cvt_pk_bf16_f32 v171, v186, v187
    v_mfma_f32_16x16x32_bf16 v[156:159], a[204:207], a[12:15], v[156:159]
    s_barrier
    v_mfma_f32_16x16x32_bf16 v[156:159], a[208:211], a[16:19], v[156:159]
    v_mfma_f32_16x16x32_bf16 v[156:159], a[212:215], a[20:23], v[156:159]
    v_mfma_f32_16x16x32_bf16 v[232:235], a[216:219], v[168:171], v[232:235]
    v_fma_f32 v180, v152, s25, -v192
    v_fma_f32 v181, v153, s25, -v192
    v_mfma_f32_16x16x32_bf16 v[0:3], a[120:123], v[168:171], v[0:3]
    ds_read_b64_tr_b16 a[120:121], v197 offset:12288
    ds_read_b64_tr_b16 a[122:123], v197 offset:18432
    v_exp_f32 v180, v180
    v_mfma_f32_16x16x32_bf16 v[4:7], a[124:127], v[168:171], v[4:7]
    ds_read_b64_tr_b16 a[124:125], v198 offset:12288
    ds_read_b64_tr_b16 a[126:127], v198 offset:18432
    v_mfma_f32_16x16x32_bf16 v[8:11], a[128:131], v[168:171], v[8:11]
    ds_read_b64_tr_b16 a[128:129], v199 offset:12288
    ds_read_b64_tr_b16 a[130:131], v199 offset:18432
    v_exp_f32 v181, v181
    v_mfma_f32_16x16x32_bf16 v[12:15], a[132:135], v[168:171], v[12:15]
    ds_read_b64_tr_b16 a[132:133], v200 offset:12288
    ds_read_b64_tr_b16 a[134:135], v200 offset:18432
    v_fma_f32 v182, v154, s25, -v192
    v_mfma_f32_16x16x32_bf16 v[16:19], a[136:139], v[168:171], v[16:19]
    ds_read_b64_tr_b16 a[136:137], v197 offset:12416
    ds_read_b64_tr_b16 a[138:139], v197 offset:18560
    v_fma_f32 v183, v155, s25, -v192
    v_mfma_f32_16x16x32_bf16 v[20:23], a[140:143], v[168:171], v[20:23]
    ds_read_b64_tr_b16 a[140:141], v198 offset:12416
    ds_read_b64_tr_b16 a[142:143], v198 offset:18560
    v_exp_f32 v182, v182
    v_mfma_f32_16x16x32_bf16 v[24:27], a[144:147], v[168:171], v[24:27]
    ds_read_b64_tr_b16 a[144:145], v199 offset:12416
    ds_read_b64_tr_b16 a[146:147], v199 offset:18560
    v_exp_f32 v183, v183
    v_mfma_f32_16x16x32_bf16 v[28:31], a[148:151], v[168:171], v[28:31]
    ds_read_b64_tr_b16 a[148:149], v200 offset:12416
    ds_read_b64_tr_b16 a[150:151], v200 offset:18560
    v_mfma_f32_16x16x32_bf16 v[32:35], a[152:155], v[168:171], v[32:35]
    ds_read_b64_tr_b16 a[152:153], v197 offset:12544
    ds_read_b64_tr_b16 a[154:155], v197 offset:18688
    v_cvt_pk_bf16_f32 v172, v180, v181
    v_mfma_f32_16x16x32_bf16 v[36:39], a[156:159], v[168:171], v[36:39]
    ds_read_b64_tr_b16 a[156:157], v198 offset:12544
    ds_read_b64_tr_b16 a[158:159], v198 offset:18688
    v_fma_f32 v184, v156, s25, -v192
    v_mfma_f32_16x16x32_bf16 v[40:43], a[160:163], v[168:171], v[40:43]
    ds_read_b64_tr_b16 a[160:161], v199 offset:12544
    ds_read_b64_tr_b16 a[162:163], v199 offset:18688
    v_fma_f32 v185, v157, s25, -v192
    v_exp_f32 v184, v184
    v_mfma_f32_16x16x32_bf16 v[44:47], a[164:167], v[168:171], v[44:47]
    ds_read_b64_tr_b16 a[164:165], v200 offset:12544
    ds_read_b64_tr_b16 a[166:167], v200 offset:18688
    v_mfma_f32_16x16x32_bf16 v[160:163], a[168:171], a[24:27], 0
    ds_read_b128 a[220:223], v208 offset:0
    v_cvt_pk_bf16_f32 v173, v182, v183
    v_mfma_f32_16x16x32_bf16 v[160:163], a[172:175], a[28:31], v[160:163]
    v_exp_f32 v185, v185
    v_mfma_f32_16x16x32_bf16 v[160:163], a[176:179], a[32:35], v[160:163]
    v_fma_f32 v186, v158, s25, -v192
    v_mfma_f32_16x16x32_bf16 v[160:163], a[180:183], a[36:39], v[160:163]
    v_fma_f32 v187, v159, s25, -v192
    v_mfma_f32_16x16x32_bf16 v[160:163], a[184:187], a[40:43], v[160:163]
    v_exp_f32 v186, v186
    v_mfma_f32_16x16x32_bf16 v[160:163], a[188:191], a[44:47], v[160:163]
    v_cvt_pk_bf16_f32 v174, v184, v185
    v_mfma_f32_16x16x32_bf16 v[164:167], a[192:195], a[24:27], 0
    v_exp_f32 v187, v187
    v_mfma_f32_16x16x32_bf16 v[164:167], a[196:199], a[28:31], v[164:167]
    v_mfma_f32_16x16x32_bf16 v[164:167], a[200:203], a[32:35], v[164:167]
    s_waitcnt lgkmcnt(0)
    buffer_store_dwordx4 a[220:223], v209, s[16:19], s53 offen offset:0 nt
    v_cvt_pk_bf16_f32 v175, v186, v187
    v_mfma_f32_16x16x32_bf16 v[164:167], a[204:207], a[36:39], v[164:167]
    v_mfma_f32_16x16x32_bf16 v[164:167], a[208:211], a[40:43], v[164:167]
    v_add_u32 v208, s55, v207
    v_mfma_f32_16x16x32_bf16 v[164:167], a[212:215], a[44:47], v[164:167]
    v_mfma_f32_16x16x32_bf16 v[232:235], a[216:219], v[172:175], v[232:235]
    v_fma_f32 v180, v160, s25, -v193
    v_fma_f32 v181, v161, s25, -v193
    v_mfma_f32_16x16x32_bf16 v[0:3], a[120:123], v[172:175], v[0:3]
    v_exp_f32 v180, v180
    v_mfma_f32_16x16x32_bf16 v[4:7], a[124:127], v[172:175], v[4:7]
    v_mfma_f32_16x16x32_bf16 v[8:11], a[128:131], v[172:175], v[8:11]
    v_exp_f32 v181, v181
    v_mfma_f32_16x16x32_bf16 v[12:15], a[132:135], v[172:175], v[12:15]
    v_fma_f32 v182, v162, s25, -v193
    v_mfma_f32_16x16x32_bf16 v[16:19], a[136:139], v[172:175], v[16:19]
    v_fma_f32 v183, v163, s25, -v193
    v_mfma_f32_16x16x32_bf16 v[20:23], a[140:143], v[172:175], v[20:23]
    v_exp_f32 v182, v182
    v_max_u32 v188, v188, v232
    v_rcp_f32 v232, v232
    v_mfma_f32_16x16x32_bf16 v[24:27], a[144:147], v[172:175], v[24:27]
    v_exp_f32 v183, v183
    v_mfma_f32_16x16x32_bf16 v[28:31], a[148:151], v[172:175], v[28:31]
    v_pk_mul_f32 v[0:1], v[0:1], v[232:233] op_sel_hi:[1,0]
    v_pk_mul_f32 v[2:3], v[2:3], v[232:233] op_sel_hi:[1,0]
    v_pk_mul_f32 v[4:5], v[4:5], v[232:233] op_sel_hi:[1,0]
    v_pk_mul_f32 v[6:7], v[6:7], v[232:233] op_sel_hi:[1,0]
    v_pk_mul_f32 v[8:9], v[8:9], v[232:233] op_sel_hi:[1,0]
    v_pk_mul_f32 v[10:11], v[10:11], v[232:233] op_sel_hi:[1,0]
    v_pk_mul_f32 v[12:13], v[12:13], v[232:233] op_sel_hi:[1,0]
    v_pk_mul_f32 v[14:15], v[14:15], v[232:233] op_sel_hi:[1,0]
    v_mfma_f32_16x16x32_bf16 v[32:35], a[152:155], v[172:175], v[32:35]
    v_cvt_pk_bf16_f32 v176, v180, v181
    v_mfma_f32_16x16x32_bf16 v[36:39], a[156:159], v[172:175], v[36:39]
    v_fma_f32 v184, v164, s25, -v193
    v_cvt_pk_bf16_f32 v0, v0, v1
    v_cvt_pk_bf16_f32 v1, v2, v3
    v_mfma_f32_16x16x32_bf16 v[40:43], a[160:163], v[172:175], v[40:43]
    ds_write_b64 v216, v[0:1] offset:0
    v_fma_f32 v185, v165, s25, -v193
    v_exp_f32 v184, v184
    v_cvt_pk_bf16_f32 v4, v4, v5
    v_cvt_pk_bf16_f32 v5, v6, v7
    v_mfma_f32_16x16x32_bf16 v[44:47], a[164:167], v[172:175], v[44:47]
    ds_write_b64 v217, v[4:5] offset:0
    v_cvt_pk_bf16_f32 v8, v8, v9
    v_mfma_f32_16x16x32_bf16 v[144:147], a[72:75], a[24:27], 0
    v_cvt_pk_bf16_f32 v177, v182, v183
    v_cvt_pk_bf16_f32 v9, v10, v11
    v_mfma_f32_16x16x32_bf16 v[144:147], a[76:79], a[28:31], v[144:147]
    ds_write_b64 v218, v[8:9] offset:0
    v_exp_f32 v185, v185
    v_cvt_pk_bf16_f32 v12, v12, v13
    v_cvt_pk_bf16_f32 v13, v14, v15
    v_mfma_f32_16x16x32_bf16 v[144:147], a[80:83], a[32:35], v[144:147]
    ds_write_b64 v219, v[12:13] offset:0
    v_fma_f32 v186, v166, s25, -v193
    v_pk_mul_f32 v[16:17], v[16:17], v[232:233] op_sel_hi:[1,0]
    v_pk_mul_f32 v[18:19], v[18:19], v[232:233] op_sel_hi:[1,0]
    v_pk_mul_f32 v[20:21], v[20:21], v[232:233] op_sel_hi:[1,0]
    v_pk_mul_f32 v[22:23], v[22:23], v[232:233] op_sel_hi:[1,0]
    v_pk_mul_f32 v[24:25], v[24:25], v[232:233] op_sel_hi:[1,0]
    v_pk_mul_f32 v[26:27], v[26:27], v[232:233] op_sel_hi:[1,0]
    v_pk_mul_f32 v[28:29], v[28:29], v[232:233] op_sel_hi:[1,0]
    v_pk_mul_f32 v[30:31], v[30:31], v[232:233] op_sel_hi:[1,0]
    v_mfma_f32_16x16x32_bf16 v[144:147], a[84:87], a[36:39], v[144:147]
    v_fma_f32 v187, v167, s25, -v193
    v_mfma_f32_16x16x32_bf16 v[144:147], a[88:91], a[40:43], v[144:147]
    v_exp_f32 v186, v186
    v_cvt_pk_bf16_f32 v16, v16, v17
    v_mfma_f32_16x16x32_bf16 v[144:147], a[92:95], a[44:47], v[144:147]
    v_cvt_pk_bf16_f32 v178, v184, v185
    v_cvt_pk_bf16_f32 v17, v18, v19
    v_mfma_f32_16x16x32_bf16 v[148:151], a[96:99], a[24:27], 0
    ds_write_b64 v220, v[16:17] offset:0
    v_exp_f32 v187, v187
    v_cvt_pk_bf16_f32 v20, v20, v21
    v_cvt_pk_bf16_f32 v21, v22, v23
    v_mfma_f32_16x16x32_bf16 v[148:151], a[100:103], a[28:31], v[148:151]
    ds_write_b64 v221, v[20:21] offset:0
    v_cvt_pk_bf16_f32 v24, v24, v25
    v_cvt_pk_bf16_f32 v25, v26, v27
    v_mfma_f32_16x16x32_bf16 v[148:151], a[104:107], a[32:35], v[148:151]
    ds_write_b64 v222, v[24:25] offset:0
    v_cvt_pk_bf16_f32 v179, v186, v187
    v_cvt_pk_bf16_f32 v28, v28, v29
    v_mfma_f32_16x16x32_bf16 v[148:151], a[108:111], a[36:39], v[148:151]
    v_cvt_pk_bf16_f32 v29, v30, v31
    v_mfma_f32_16x16x32_bf16 v[148:151], a[112:115], a[40:43], v[148:151]
    ds_write_b64 v223, v[28:29] offset:0
    v_pk_mul_f32 v[32:33], v[32:33], v[232:233] op_sel_hi:[1,0]
    v_pk_mul_f32 v[34:35], v[34:35], v[232:233] op_sel_hi:[1,0]
    v_pk_mul_f32 v[36:37], v[36:37], v[232:233] op_sel_hi:[1,0]
    v_pk_mul_f32 v[38:39], v[38:39], v[232:233] op_sel_hi:[1,0]
    v_pk_mul_f32 v[40:41], v[40:41], v[232:233] op_sel_hi:[1,0]
    v_pk_mul_f32 v[42:43], v[42:43], v[232:233] op_sel_hi:[1,0]
    v_pk_mul_f32 v[44:45], v[44:45], v[232:233] op_sel_hi:[1,0]
    v_pk_mul_f32 v[46:47], v[46:47], v[232:233] op_sel_hi:[1,0]
    v_mfma_f32_16x16x32_bf16 v[148:151], a[116:119], a[44:47], v[148:151]
    v_mfma_f32_16x16x32_bf16 v[236:239], a[216:219], v[176:179], v[236:239]
    v_fma_f32 v180, v144, s25, -v193
    v_fma_f32 v181, v145, s25, -v193
    v_cvt_pk_bf16_f32 v32, v32, v33
    v_cvt_pk_bf16_f32 v33, v34, v35
    v_mfma_f32_16x16x32_bf16 v[48:51], a[120:123], v[176:179], v[48:51]
    ds_read_b64_tr_b16 a[120:121], v197 offset:0
    ds_read_b64_tr_b16 a[122:123], v197 offset:6144
    ds_write_b64 v224, v[32:33] offset:0
    v_exp_f32 v180, v180
    v_cvt_pk_bf16_f32 v36, v36, v37
    v_mfma_f32_16x16x32_bf16 v[52:55], a[124:127], v[176:179], v[52:55]
    ds_read_b64_tr_b16 a[124:125], v198 offset:0
    ds_read_b64_tr_b16 a[126:127], v198 offset:6144
    v_cvt_pk_bf16_f32 v37, v38, v39
    v_mfma_f32_16x16x32_bf16 v[56:59], a[128:131], v[176:179], v[56:59]
    ds_read_b64_tr_b16 a[128:129], v199 offset:0
    ds_read_b64_tr_b16 a[130:131], v199 offset:6144
    ds_write_b64 v225, v[36:37] offset:0
    v_exp_f32 v181, v181
    v_cvt_pk_bf16_f32 v40, v40, v41
    v_cvt_pk_bf16_f32 v41, v42, v43
    v_mfma_f32_16x16x32_bf16 v[60:63], a[132:135], v[176:179], v[60:63]
    ds_read_b64_tr_b16 a[132:133], v200 offset:0
    ds_read_b64_tr_b16 a[134:135], v200 offset:6144
    ds_write_b64 v226, v[40:41] offset:0
    v_fma_f32 v182, v146, s25, -v193
    v_cvt_pk_bf16_f32 v44, v44, v45
    v_cvt_pk_bf16_f32 v45, v46, v47
    v_mfma_f32_16x16x32_bf16 v[64:67], a[136:139], v[176:179], v[64:67]
    ds_read_b64_tr_b16 a[136:137], v197 offset:128
    ds_read_b64_tr_b16 a[138:139], v197 offset:6272
    ds_write_b64 v227, v[44:45] offset:0
    v_fma_f32 v183, v147, s25, -v193
    v_mfma_f32_16x16x32_bf16 v[68:71], a[140:143], v[176:179], v[68:71]
    ds_read_b64_tr_b16 a[140:141], v198 offset:128
    ds_read_b64_tr_b16 a[142:143], v198 offset:6272
    v_exp_f32 v182, v182
    v_mfma_f32_16x16x32_bf16 v[72:75], a[144:147], v[176:179], v[72:75]
    ds_read_b64_tr_b16 a[144:145], v199 offset:128
    ds_read_b64_tr_b16 a[146:147], v199 offset:6272
    ds_read_b128 v[0:3], v208 offset:0
    ds_read_b128 v[4:7], v208 offset:1024
    v_exp_f32 v183, v183
    s_add_u32 s27, s45, 0
    s_add_u32 s28, s45, 3072
    v_mfma_f32_16x16x32_bf16 v[76:79], a[148:151], v[176:179], v[76:79]
    ds_read_b64_tr_b16 a[148:149], v200 offset:128
    ds_read_b64_tr_b16 a[150:151], v200 offset:6272
    ds_read_b128 v[8:11], v208 offset:2048
    ds_read_b128 v[12:15], v208 offset:3072
    v_mfma_f32_16x16x32_bf16 v[80:83], a[152:155], v[176:179], v[80:83]
    ds_read_b64_tr_b16 a[152:153], v197 offset:256
    ds_read_b64_tr_b16 a[154:155], v197 offset:6400
    ds_read_b128 v[16:19], v208 offset:4096
    ds_read_b128 v[20:23], v208 offset:5120
    v_cvt_pk_bf16_f32 v168, v180, v181
    v_mfma_f32_16x16x32_bf16 v[84:87], a[156:159], v[176:179], v[84:87]
    ds_read_b64_tr_b16 a[156:157], v198 offset:256
    ds_read_b64_tr_b16 a[158:159], v198 offset:6400
    v_fma_f32 v184, v148, s25, -v193
    v_mfma_f32_16x16x32_bf16 v[88:91], a[160:163], v[176:179], v[88:91]
    ds_read_b64_tr_b16 a[160:161], v199 offset:256
    ds_read_b64_tr_b16 a[162:163], v199 offset:6400
    v_fma_f32 v185, v149, s25, -v193
    v_exp_f32 v184, v184
    v_mfma_f32_16x16x32_bf16 v[92:95], a[164:167], v[176:179], v[92:95]
    ds_read_b64_tr_b16 a[164:165], v200 offset:256
    ds_read_b64_tr_b16 a[166:167], v200 offset:6400
    v_mfma_f32_16x16x32_bf16 v[152:155], a[72:75], a[48:51], 0
    v_cvt_pk_bf16_f32 v169, v182, v183
    v_mfma_f32_16x16x32_bf16 v[152:155], a[76:79], a[52:55], v[152:155]
    v_exp_f32 v185, v185
    v_mfma_f32_16x16x32_bf16 v[152:155], a[80:83], a[56:59], v[152:155]
    s_waitcnt lgkmcnt(6)
    buffer_store_dwordx4 v[0:3], v209, s[16:19], s27 offen offset:0 nt
    v_fma_f32 v186, v150, s25, -v193
    v_mfma_f32_16x16x32_bf16 v[152:155], a[84:87], a[60:63], v[152:155]
    v_fma_f32 v187, v151, s25, -v193
    v_mfma_f32_16x16x32_bf16 v[152:155], a[88:91], a[64:67], v[152:155]
    v_exp_f32 v186, v186
    v_mfma_f32_16x16x32_bf16 v[152:155], a[92:95], a[68:71], v[152:155]
    v_cvt_pk_bf16_f32 v170, v184, v185
    v_mfma_f32_16x16x32_bf16 v[156:159], a[96:99], a[48:51], 0
    s_nop 0
    buffer_store_dwordx4 v[4:7], v209, s[16:19], s27 offen offset:1024 nt
    v_exp_f32 v187, v187
    v_mfma_f32_16x16x32_bf16 v[156:159], a[100:103], a[52:55], v[156:159]
    v_mfma_f32_16x16x32_bf16 v[156:159], a[104:107], a[56:59], v[156:159]
    v_cvt_pk_bf16_f32 v171, v186, v187
    v_mfma_f32_16x16x32_bf16 v[156:159], a[108:111], a[60:63], v[156:159]
    v_mfma_f32_16x16x32_bf16 v[156:159], a[112:115], a[64:67], v[156:159]
    s_nop 0
    buffer_store_dwordx4 v[8:11], v209, s[16:19], s27 offen offset:2048 nt
    v_mfma_f32_16x16x32_bf16 v[156:159], a[116:119], a[68:71], v[156:159]
    v_mfma_f32_16x16x32_bf16 v[236:239], a[216:219], v[168:171], v[236:239]
    v_fma_f32 v180, v152, s25, -v194
    v_fma_f32 v181, v153, s25, -v194
    v_mfma_f32_16x16x32_bf16 v[48:51], a[120:123], v[168:171], v[48:51]
    v_exp_f32 v180, v180
    v_mfma_f32_16x16x32_bf16 v[52:55], a[124:127], v[168:171], v[52:55]
    s_nop 0
    buffer_store_dwordx4 v[12:15], v209, s[16:19], s28 offen offset:0 nt
    v_mfma_f32_16x16x32_bf16 v[56:59], a[128:131], v[168:171], v[56:59]
    v_exp_f32 v181, v181
    v_mfma_f32_16x16x32_bf16 v[60:63], a[132:135], v[168:171], v[60:63]
    v_fma_f32 v182, v154, s25, -v194
    v_mfma_f32_16x16x32_bf16 v[64:67], a[136:139], v[168:171], v[64:67]
    v_fma_f32 v183, v155, s25, -v194
    v_mfma_f32_16x16x32_bf16 v[68:71], a[140:143], v[168:171], v[68:71]
    s_nop 0
    buffer_store_dwordx4 v[16:19], v209, s[16:19], s28 offen offset:1024 nt
    v_exp_f32 v182, v182
    v_max_u32 v188, v188, v236
    v_rcp_f32 v236, v236
    v_mfma_f32_16x16x32_bf16 v[72:75], a[144:147], v[168:171], v[72:75]
    v_exp_f32 v183, v183
    v_mfma_f32_16x16x32_bf16 v[76:79], a[148:151], v[168:171], v[76:79]
    v_pk_mul_f32 v[48:49], v[48:49], v[236:237] op_sel_hi:[1,0]
    v_pk_mul_f32 v[50:51], v[50:51], v[236:237] op_sel_hi:[1,0]
    v_pk_mul_f32 v[52:53], v[52:53], v[236:237] op_sel_hi:[1,0]
    v_pk_mul_f32 v[54:55], v[54:55], v[236:237] op_sel_hi:[1,0]
    v_pk_mul_f32 v[56:57], v[56:57], v[236:237] op_sel_hi:[1,0]
    v_pk_mul_f32 v[58:59], v[58:59], v[236:237] op_sel_hi:[1,0]
    v_pk_mul_f32 v[60:61], v[60:61], v[236:237] op_sel_hi:[1,0]
    v_pk_mul_f32 v[62:63], v[62:63], v[236:237] op_sel_hi:[1,0]
    v_mfma_f32_16x16x32_bf16 v[80:83], a[152:155], v[168:171], v[80:83]
    s_waitcnt lgkmcnt(0)
    v_cvt_pk_bf16_f32 v172, v180, v181
    v_mfma_f32_16x16x32_bf16 v[84:87], a[156:159], v[168:171], v[84:87]
    s_nop 0
    buffer_store_dwordx4 v[20:23], v209, s[16:19], s28 offen offset:2048 nt
    v_fma_f32 v184, v156, s25, -v194
    v_cvt_pk_bf16_f32 v48, v48, v49
    v_cvt_pk_bf16_f32 v49, v50, v51
    v_mfma_f32_16x16x32_bf16 v[88:91], a[160:163], v[168:171], v[88:91]
    ds_write_b64 v216, v[48:49] offset:6144
    v_fma_f32 v185, v157, s25, -v194
    v_exp_f32 v184, v184
    v_cvt_pk_bf16_f32 v52, v52, v53
    v_cvt_pk_bf16_f32 v53, v54, v55
    v_mfma_f32_16x16x32_bf16 v[92:95], a[164:167], v[168:171], v[92:95]
    ds_write_b64 v217, v[52:53] offset:6144
    v_cvt_pk_bf16_f32 v56, v56, v57
    v_cvt_pk_bf16_f32 v57, v58, v59
    v_mfma_f32_16x16x32_bf16 v[160:163], a[168:171], a[48:51], 0
    ds_write_b64 v218, v[56:57] offset:6144
    v_cvt_pk_bf16_f32 v173, v182, v183
    v_cvt_pk_bf16_f32 v60, v60, v61
    v_mfma_f32_16x16x32_bf16 v[160:163], a[172:175], a[52:55], v[160:163]
    v_exp_f32 v185, v185
    v_cvt_pk_bf16_f32 v61, v62, v63
    v_mfma_f32_16x16x32_bf16 v[160:163], a[176:179], a[56:59], v[160:163]
    ds_write_b64 v219, v[60:61] offset:6144
    v_fma_f32 v186, v158, s25, -v194
    v_pk_mul_f32 v[64:65], v[64:65], v[236:237] op_sel_hi:[1,0]
    v_pk_mul_f32 v[66:67], v[66:67], v[236:237] op_sel_hi:[1,0]
    v_pk_mul_f32 v[68:69], v[68:69], v[236:237] op_sel_hi:[1,0]
    v_pk_mul_f32 v[70:71], v[70:71], v[236:237] op_sel_hi:[1,0]
    v_pk_mul_f32 v[72:73], v[72:73], v[236:237] op_sel_hi:[1,0]
    v_pk_mul_f32 v[74:75], v[74:75], v[236:237] op_sel_hi:[1,0]
    v_pk_mul_f32 v[76:77], v[76:77], v[236:237] op_sel_hi:[1,0]
    v_pk_mul_f32 v[78:79], v[78:79], v[236:237] op_sel_hi:[1,0]
    v_mfma_f32_16x16x32_bf16 v[160:163], a[180:183], a[60:63], v[160:163]
    v_fma_f32 v187, v159, s25, -v194
    v_mfma_f32_16x16x32_bf16 v[160:163], a[184:187], a[64:67], v[160:163]
    v_exp_f32 v186, v186
    v_cvt_pk_bf16_f32 v64, v64, v65
    v_cvt_pk_bf16_f32 v65, v66, v67
    v_mfma_f32_16x16x32_bf16 v[160:163], a[188:191], a[68:71], v[160:163]
    ds_write_b64 v220, v[64:65] offset:6144
    v_cvt_pk_bf16_f32 v174, v184, v185
    v_cvt_pk_bf16_f32 v68, v68, v69
    v_cvt_pk_bf16_f32 v69, v70, v71
    v_mfma_f32_16x16x32_bf16 v[164:167], a[192:195], a[48:51], 0
    ds_write_b64 v221, v[68:69] offset:6144
    v_exp_f32 v187, v187
    v_cvt_pk_bf16_f32 v72, v72, v73
    v_cvt_pk_bf16_f32 v73, v74, v75
    v_mfma_f32_16x16x32_bf16 v[164:167], a[196:199], a[52:55], v[164:167]
    ds_write_b64 v222, v[72:73] offset:6144
    v_cvt_pk_bf16_f32 v76, v76, v77
    v_mfma_f32_16x16x32_bf16 v[164:167], a[200:203], a[56:59], v[164:167]
    v_cvt_pk_bf16_f32 v175, v186, v187
    v_cvt_pk_bf16_f32 v77, v78, v79
    v_mfma_f32_16x16x32_bf16 v[164:167], a[204:207], a[60:63], v[164:167]
    ds_write_b64 v223, v[76:77] offset:6144
    v_pk_mul_f32 v[80:81], v[80:81], v[236:237] op_sel_hi:[1,0]
    v_pk_mul_f32 v[82:83], v[82:83], v[236:237] op_sel_hi:[1,0]
    v_pk_mul_f32 v[84:85], v[84:85], v[236:237] op_sel_hi:[1,0]
    v_pk_mul_f32 v[86:87], v[86:87], v[236:237] op_sel_hi:[1,0]
    v_pk_mul_f32 v[88:89], v[88:89], v[236:237] op_sel_hi:[1,0]
    v_pk_mul_f32 v[90:91], v[90:91], v[236:237] op_sel_hi:[1,0]
    v_pk_mul_f32 v[92:93], v[92:93], v[236:237] op_sel_hi:[1,0]
    v_pk_mul_f32 v[94:95], v[94:95], v[236:237] op_sel_hi:[1,0]
    v_mfma_f32_16x16x32_bf16 v[164:167], a[208:211], a[64:67], v[164:167]
    v_mfma_f32_16x16x32_bf16 v[164:167], a[212:215], a[68:71], v[164:167]
    v_cvt_pk_bf16_f32 v80, v80, v81
    v_cvt_pk_bf16_f32 v81, v82, v83
    v_mfma_f32_16x16x32_bf16 v[240:243], a[216:219], v[172:175], v[240:243]
    ds_write_b64 v224, v[80:81] offset:6144
    v_fma_f32 v180, v160, s25, -v194
    v_fma_f32 v181, v161, s25, -v194
    v_exp_f32 v180, v180
    v_cvt_pk_bf16_f32 v84, v84, v85
    v_cvt_pk_bf16_f32 v85, v86, v87
    v_mfma_f32_16x16x32_bf16 v[96:99], a[120:123], v[172:175], v[96:99]
    ds_read_b64_tr_b16 a[120:121], v197 offset:12288
    ds_read_b64_tr_b16 a[122:123], v197 offset:18432
    ds_write_b64 v225, v[84:85] offset:6144
    v_exp_f32 v181, v181
    v_cvt_pk_bf16_f32 v88, v88, v89
    v_cvt_pk_bf16_f32 v89, v90, v91
    v_mfma_f32_16x16x32_bf16 v[100:103], a[124:127], v[172:175], v[100:103]
    ds_read_b64_tr_b16 a[124:125], v198 offset:12288
    ds_read_b64_tr_b16 a[126:127], v198 offset:18432
    ds_write_b64 v226, v[88:89] offset:6144
    v_fma_f32 v182, v162, s25, -v194
    v_fma_f32 v183, v163, s25, -v194
    v_exp_f32 v182, v182
    v_cvt_pk_bf16_f32 v92, v92, v93
    v_mfma_f32_16x16x32_bf16 v[104:107], a[128:131], v[172:175], v[104:107]
    ds_read_b64_tr_b16 a[128:129], v199 offset:12288
    ds_read_b64_tr_b16 a[130:131], v199 offset:18432
    v_exp_f32 v183, v183
    v_cvt_pk_bf16_f32 v93, v94, v95
    v_mfma_f32_16x16x32_bf16 v[108:111], a[132:135], v[172:175], v[108:111]
    ds_read_b64_tr_b16 a[132:133], v200 offset:12288
    ds_read_b64_tr_b16 a[134:135], v200 offset:18432
    ds_write_b64 v227, v[92:93] offset:6144
    v_cvt_pk_bf16_f32 v176, v180, v181
    v_fma_f32 v184, v164, s25, -v194
    v_mfma_f32_16x16x32_bf16 v[112:115], a[136:139], v[172:175], v[112:115]
    ds_read_b64_tr_b16 a[136:137], v197 offset:12416
    ds_read_b64_tr_b16 a[138:139], v197 offset:18560
    ds_read_b128 v[48:51], v208 offset:6144
    ds_read_b128 v[52:55], v208 offset:7168
    v_fma_f32 v185, v165, s25, -v194
    v_exp_f32 v184, v184
    s_add_u32 s27, s45, 6144
    s_add_u32 s28, s45, 9216
    v_mfma_f32_16x16x32_bf16 v[116:119], a[140:143], v[172:175], v[116:119]
    ds_read_b64_tr_b16 a[140:141], v198 offset:12416
    ds_read_b64_tr_b16 a[142:143], v198 offset:18560
    ds_read_b128 v[56:59], v208 offset:8192
    ds_read_b128 v[60:63], v208 offset:9216
    v_cvt_pk_bf16_f32 v177, v182, v183
    v_exp_f32 v185, v185
    v_mfma_f32_16x16x32_bf16 v[120:123], a[144:147], v[172:175], v[120:123]
    ds_read_b64_tr_b16 a[144:145], v199 offset:12416
    ds_read_b64_tr_b16 a[146:147], v199 offset:18560
    ds_read_b128 v[64:67], v208 offset:10240
    ds_read_b128 v[68:71], v208 offset:11264
    v_fma_f32 v186, v166, s25, -v194
    v_fma_f32 v187, v167, s25, -v194
    v_exp_f32 v186, v186
    v_mfma_f32_16x16x32_bf16 v[124:127], a[148:151], v[172:175], v[124:127]
    ds_read_b64_tr_b16 a[148:149], v200 offset:12416
    ds_read_b64_tr_b16 a[150:151], v200 offset:18560
    v_cvt_pk_bf16_f32 v178, v184, v185
    v_exp_f32 v187, v187
    v_mfma_f32_16x16x32_bf16 v[128:131], a[152:155], v[172:175], v[128:131]
    ds_read_b64_tr_b16 a[152:153], v197 offset:12544
    ds_read_b64_tr_b16 a[154:155], v197 offset:18688
    v_cvt_pk_bf16_f32 v179, v186, v187
    v_mfma_f32_16x16x32_bf16 v[132:135], a[156:159], v[172:175], v[132:135]
    ds_read_b64_tr_b16 a[156:157], v198 offset:12544
    ds_read_b64_tr_b16 a[158:159], v198 offset:18688
    v_mfma_f32_16x16x32_bf16 v[136:139], a[160:163], v[172:175], v[136:139]
    ds_read_b64_tr_b16 a[160:161], v199 offset:12544
    ds_read_b64_tr_b16 a[162:163], v199 offset:18688
    v_mfma_f32_16x16x32_bf16 v[140:143], a[164:167], v[172:175], v[140:143]
    ds_read_b64_tr_b16 a[164:165], v200 offset:12544
    ds_read_b64_tr_b16 a[166:167], v200 offset:18688
    v_mfma_f32_16x16x32_bf16 v[240:243], a[216:219], v[176:179], v[240:243]
    s_waitcnt lgkmcnt(10)
    v_mfma_f32_16x16x32_bf16 v[96:99], a[120:123], v[176:179], v[96:99]
    s_nop 0
    buffer_store_dwordx4 v[48:51], v209, s[16:19], s27 offen offset:0 nt
    v_mfma_f32_16x16x32_bf16 v[100:103], a[124:127], v[176:179], v[100:103]
    s_nop 2
    v_max_u32 v188, v188, v240
    v_rcp_f32 v240, v240
    v_mfma_f32_16x16x32_bf16 v[104:107], a[128:131], v[176:179], v[104:107]
    s_nop 0
    buffer_store_dwordx4 v[52:55], v209, s[16:19], s27 offen offset:1024 nt
    v_mul_f32 v96, v96, v240
    v_mul_f32 v97, v97, v240
    v_mul_f32 v98, v98, v240
    v_mul_f32 v99, v99, v240
    v_cvt_pk_bf16_f32 v96, v96, v97
    v_cvt_pk_bf16_f32 v97, v98, v99
    v_mfma_f32_16x16x32_bf16 v[108:111], a[132:135], v[176:179], v[108:111]
    ds_write_b64 v216, v[96:97] offset:12288
    v_mul_f32 v100, v100, v240
    v_mul_f32 v101, v101, v240
    v_mul_f32 v102, v102, v240
    v_mul_f32 v103, v103, v240
    v_cvt_pk_bf16_f32 v100, v100, v101
    v_cvt_pk_bf16_f32 v101, v102, v103
    v_mfma_f32_16x16x32_bf16 v[112:115], a[136:139], v[176:179], v[112:115]
    s_nop 0
    buffer_store_dwordx4 v[56:59], v209, s[16:19], s27 offen offset:2048 nt
    ds_write_b64 v217, v[100:101] offset:12288
    v_mul_f32 v104, v104, v240
    v_mul_f32 v105, v105, v240
    v_mul_f32 v106, v106, v240
    v_mul_f32 v107, v107, v240
    v_cvt_pk_bf16_f32 v104, v104, v105
    v_cvt_pk_bf16_f32 v105, v106, v107
    v_mfma_f32_16x16x32_bf16 v[116:119], a[140:143], v[176:179], v[116:119]
    ds_write_b64 v218, v[104:105] offset:12288
    v_mul_f32 v108, v108, v240
    v_mul_f32 v109, v109, v240
    v_mul_f32 v110, v110, v240
    v_mul_f32 v111, v111, v240
    v_cvt_pk_bf16_f32 v108, v108, v109
    v_cvt_pk_bf16_f32 v109, v110, v111
    v_mfma_f32_16x16x32_bf16 v[120:123], a[144:147], v[176:179], v[120:123]
    s_waitcnt lgkmcnt(3)
    buffer_store_dwordx4 v[60:63], v209, s[16:19], s28 offen offset:0 nt
    ds_write_b64 v219, v[108:109] offset:12288
    v_mul_f32 v112, v112, v240
    v_mul_f32 v113, v113, v240
    v_mul_f32 v114, v114, v240
    v_mul_f32 v115, v115, v240
    v_cvt_pk_bf16_f32 v112, v112, v113
    v_cvt_pk_bf16_f32 v113, v114, v115
    v_mfma_f32_16x16x32_bf16 v[124:127], a[148:151], v[176:179], v[124:127]
    ds_write_b64 v220, v[112:113] offset:12288
    v_mul_f32 v116, v116, v240
    v_mul_f32 v117, v117, v240
    v_mul_f32 v118, v118, v240
    v_mul_f32 v119, v119, v240
    v_cvt_pk_bf16_f32 v116, v116, v117
    v_cvt_pk_bf16_f32 v117, v118, v119
    v_mfma_f32_16x16x32_bf16 v[128:131], a[152:155], v[176:179], v[128:131]
    s_nop 0
    buffer_store_dwordx4 v[64:67], v209, s[16:19], s28 offen offset:1024 nt
    ds_write_b64 v221, v[116:117] offset:12288
    v_mul_f32 v120, v120, v240
    v_mul_f32 v121, v121, v240
    v_mul_f32 v122, v122, v240
    v_mul_f32 v123, v123, v240
    v_cvt_pk_bf16_f32 v120, v120, v121
    v_cvt_pk_bf16_f32 v121, v122, v123
    v_mfma_f32_16x16x32_bf16 v[132:135], a[156:159], v[176:179], v[132:135]
    ds_write_b64 v222, v[120:121] offset:12288
    v_mul_f32 v124, v124, v240
    v_mul_f32 v125, v125, v240
    v_mul_f32 v126, v126, v240
    v_mul_f32 v127, v127, v240
    v_cvt_pk_bf16_f32 v124, v124, v125
    v_cvt_pk_bf16_f32 v125, v126, v127
    v_mfma_f32_16x16x32_bf16 v[136:139], a[160:163], v[176:179], v[136:139]
    s_nop 0
    buffer_store_dwordx4 v[68:71], v209, s[16:19], s28 offen offset:2048 nt
    ds_write_b64 v223, v[124:125] offset:12288
    v_mul_f32 v128, v128, v240
    v_mul_f32 v129, v129, v240
    v_mul_f32 v130, v130, v240
    v_mul_f32 v131, v131, v240
    v_cvt_pk_bf16_f32 v128, v128, v129
    v_cvt_pk_bf16_f32 v129, v130, v131
    v_mfma_f32_16x16x32_bf16 v[140:143], a[164:167], v[176:179], v[140:143]
    ds_write_b64 v224, v[128:129] offset:12288
    v_mul_f32 v132, v132, v240
    v_mul_f32 v133, v133, v240
    v_mul_f32 v134, v134, v240
    v_mul_f32 v135, v135, v240
    v_cvt_pk_bf16_f32 v132, v132, v133
    v_cvt_pk_bf16_f32 v133, v134, v135
    ds_write_b64 v225, v[132:133] offset:12288
    v_pk_mul_f32 v[136:137], v[136:137], v[240:241] op_sel_hi:[1,0]
    v_pk_mul_f32 v[138:139], v[138:139], v[240:241] op_sel_hi:[1,0]
    v_cvt_pk_bf16_f32 v136, v136, v137
    v_cvt_pk_bf16_f32 v137, v138, v139
    ds_write_b64 v226, v[136:137] offset:12288
    v_pk_mul_f32 v[140:141], v[140:141], v[240:241] op_sel_hi:[1,0]
    v_pk_mul_f32 v[142:143], v[142:143], v[240:241] op_sel_hi:[1,0]
    v_cvt_pk_bf16_f32 v140, v140, v141
    v_cvt_pk_bf16_f32 v141, v142, v143
    ds_write_b64 v227, v[140:141] offset:12288
    ds_read_b128 v[96:99], v208 offset:12288
    ds_read_b128 v[100:103], v208 offset:13312
    ds_read_b128 v[104:107], v208 offset:14336
    ds_read_b128 v[108:111], v208 offset:15360
    ds_read_b128 v[112:115], v208 offset:16384
    ds_read_b128 v[116:119], v208 offset:17408
    s_add_u32 s27, s45, 12288
    s_add_u32 s28, s45, 15360
    s_waitcnt lgkmcnt(5)
    buffer_store_dwordx4 v[96:99], v209, s[16:19], s27 offen offset:0 nt
    s_waitcnt lgkmcnt(4)
    buffer_store_dwordx4 v[100:103], v209, s[16:19], s27 offen offset:1024 nt
    s_waitcnt lgkmcnt(3)
    buffer_store_dwordx4 v[104:107], v209, s[16:19], s27 offen offset:2048 nt
    s_waitcnt lgkmcnt(2)
    buffer_store_dwordx4 v[108:111], v209, s[16:19], s28 offen offset:0 nt
    s_waitcnt lgkmcnt(1)
    buffer_store_dwordx4 v[112:115], v209, s[16:19], s28 offen offset:1024 nt
    s_waitcnt lgkmcnt(0)
    buffer_store_dwordx4 v[116:119], v209, s[16:19], s28 offen offset:2048 nt
    v_cmp_le_u32 vcc, 0x47800000, v188
    s_lshl_b32 s34, s3, 2
    s_add_u32 s34, s34, 147456
    v_mov_b32 v180, s34
    s_cmp_lg_u64 vcc, 0
    s_cselect_b32 s35, 1, 0
    v_mov_b32 v181, s35
    ds_write_b32 v180, v181
    v_mov_b32 v182, 147456
    s_waitcnt lgkmcnt(0)
    s_barrier
    ds_read_b128 v[184:187], v182
    s_waitcnt lgkmcnt(0)
    v_or3_b32 v184, v184, v185, v186
    v_or_b32 v184, v184, v187
    v_cmp_ne_u32 vcc, 0, v184
    s_nop 4
    s_cbranch_vccnz L_redo
L_end:
    s_endpgm
L_redo:
    s_waitcnt vmcnt(0)
    s_barrier
    v_mbcnt_lo_u32_b32 v0, -1, 0
    v_mbcnt_hi_u32_b32 v0, -1, v0
    s_lshl_b32 s34, s3, 6
    v_add_u32 v0, s34, v0
    s_cmp_ge_u32 s2, 256
    s_cbranch_scc1 Z_end
    s_load_dwordx4 s[36:39], s[0:1], 0
    s_load_dwordx4 s[40:43], s[0:1], 16
    s_getpc_b64 s[60:61]
Z_pc:
    s_bfe_u32 s34, s2, 0x50003
    s_lshl_b32 s34, s34, 11
    v_lshrrev_b32 v189, 4, v0
    v_lshlrev_b32 v189, 7, v189
    v_add_u32 v189, s34, v189
    v_min_u32 v189, Z_end-Z_pc, v189
    global_load_dword a255, v189, s[60:61]
    v_readfirstlane_b32 s3, v0
    v_and_b32 v184, 63, v0
    s_lshr_b32 s3, s3, 6
    s_mul_i32 s30, s3, 3072
    s_and_b32 s34, s2, 7
    s_lshr_b32 s35, s2, 4
    s_lshl_b32 s35, s35, 3
    s_add_u32 s34, s34, s35
    s_bfe_u32 s35, s2, 0x10003
    s_mul_i32 s31, s34, 196608
    s_mul_i32 s44, s34, 147456
    s_mul_i32 s35, s35, 73728
    s_add_u32 s44, s44, s35
    s_mul_i32 s55, s3, 18432
    s_add_u32 s44, s44, s55
    s_add_u32 s45, s44, 18874368
    s_add_u32 s55, s55, 73728
    s_mul_i32 s34, s3, 192
    v_add_u32 v180, s34, v184
    s_lshl_b32 s34, s3, 2
    v_add_u32 v181, 0, v184
    v_mul_u32_u24 v181, 2731, v181
    v_lshrrev_b32 v181, 16, v181
    v_and_b32 v182, 6, v181
    v_xor_b32 v182, v182, v180
    v_lshlrev_b32 v204, 4, v182
    v_lshrrev_b32 v181, 1, v181
    v_add_u32 v181, s34, v181
    v_and_b32 v181, 7, v181
    v_xor_b32 v181, v181, v180
    v_lshlrev_b32 v201, 4, v181
    v_add_u32 v181, 64, v184
    v_mul_u32_u24 v181, 2731, v181
    v_lshrrev_b32 v181, 16, v181
    v_and_b32 v182, 6, v181
    v_xor_b32 v182, v182, v180
    v_lshlrev_b32 v205, 4, v182
    v_lshrrev_b32 v181, 1, v181
    v_add_u32 v181, s34, v181
    v_and_b32 v181, 7, v181
    v_xor_b32 v181, v181, v180
    v_lshlrev_b32 v202, 4, v181
    v_add_u32 v181, 128, v184
    v_mul_u32_u24 v181, 2731, v181
    v_lshrrev_b32 v181, 16, v181
    v_and_b32 v182, 6, v181
    v_xor_b32 v182, v182, v180
    v_lshlrev_b32 v206, 4, v182
    v_lshrrev_b32 v181, 1, v181
    v_add_u32 v181, s34, v181
    v_and_b32 v181, 7, v181
    v_xor_b32 v181, v181, v180
    v_lshlrev_b32 v203, 4, v181
    v_lshrrev_b32 v181, 3, v184
    v_xor_b32 v181, v181, v184
    v_lshlrev_b32 v207, 4, v181
    s_mov_b32 s49, 0x3000000
    s_mov_b32 s54, 0x2400000
    s_mov_b32 s6, s49
    s_mov_b32 s7, 0x20000
    s_mov_b32 s10, s49
    s_mov_b32 s11, 0x20000
    s_mov_b32 s14, s54
    s_mov_b32 s15, 0x20000
    s_mov_b32 s18, 0
    s_mov_b32 s19, 0x20000
    s_add_u32 m0, s30, 36864
    s_waitcnt lgkmcnt(0)
    s_mov_b32 s4, s38
    s_mov_b32 s5, s39
    s_mov_b32 s12, s36
    s_mov_b32 s13, s37
    buffer_load_dwordx4 v201, s[4:7], s31 offen offset:0 nt lds
    buffer_load_dwordx4 v202, s[4:7], s31 offen offset:1024 nt lds
    buffer_load_dwordx4 v203, s[4:7], s31 offen offset:2048 nt lds
    s_mov_b32 s8, s40
    s_mov_b32 s9, s41
    s_mov_b32 s16, s42
    s_mov_b32 s17, s43
    s_add_u32 m0, s55, 0
    s_add_u32 s27, s44, 0
    buffer_load_dwordx4 v207, s[12:15], s27 offen offset:0 nt lds
    buffer_load_dwordx4 v207, s[12:15], s27 offen offset:1024 nt lds
    buffer_load_dwordx4 v207, s[12:15], s27 offen offset:2048 nt lds
    s_add_u32 m0, s55, 3072
    s_add_u32 s27, s44, 3072
    buffer_load_dwordx4 v207, s[12:15], s27 offen offset:0 nt lds
    buffer_load_dwordx4 v207, s[12:15], s27 offen offset:1024 nt lds
    buffer_load_dwordx4 v207, s[12:15], s27 offen offset:2048 nt lds
    s_mov_b32 s36, 0x7f80
    s_mov_b32 s33, 0xfe00
    s_mov_b32 s37, 0x7ffe0000
    s_mov_b32 s20, 2
    s_mov_b32 s25, 0x3dd53b95
    s_mov_b32 s26, 0x40004000
    s_mov_b32 s32, 24981504
    s_mov_b32 s47, 15
    s_mov_b32 s53, s44
    s_mov_b32 s50, 0
    s_add_u32 s51, s45, 0
    s_add_u32 s52, s55, 0
    v_lshlrev_b32 v209, 4, v184
    v_add_u32 v208, s55, v207
    v_and_b32 v180, 15, v184
    v_lshrrev_b32 v181, 4, v184
    v_mul_u32_u24 v182, 384, v180
    v_lshrrev_b32 v183, 1, v180
    v_xor_b32 v183, v183, v181
    v_lshl_add_u32 v183, v183, 4, v182
    v_add_u32 v195, 36864, v183
    v_xor_b32 v196, 64, v195
    v_add_u32 v248, 148480, v183
    v_xor_b32 v249, 64, v248
    v_add_u32 v182, s55, v182
    v_mul_u32_u24 v185, 3, v180
    v_lshrrev_b32 v186, 1, v181
    v_and_b32 v187, 1, v181
    v_lshl_add_u32 v187, v187, 3, v182
    v_add_u32 v183, 0, v185
    v_and_b32 v183, 7, v183
    v_xor_b32 v180, v183, v181
    v_lshl_add_u32 v210, v180, 4, v182
    v_xor_b32 v211, 64, v210
    v_xor_b32 v180, v183, v186
    v_lshl_add_u32 v216, v180, 4, v187
    v_xor_b32 v217, 32, v216
    v_xor_b32 v218, 64, v216
    v_xor_b32 v219, 96, v216
    v_add_u32 v183, 1, v185
    v_and_b32 v183, 7, v183
    v_xor_b32 v180, v183, v181
    v_lshl_add_u32 v212, v180, 4, v182
    v_add_u32 v212, 128, v212
    v_xor_b32 v213, 64, v212
    v_xor_b32 v180, v183, v186
    v_lshl_add_u32 v220, v180, 4, v187
    v_add_u32 v220, 128, v220
    v_xor_b32 v221, 32, v220
    v_xor_b32 v222, 64, v220
    v_xor_b32 v223, 96, v220
    v_add_u32 v183, 2, v185
    v_and_b32 v183, 7, v183
    v_xor_b32 v180, v183, v181
    v_lshl_add_u32 v214, v180, 4, v182
    v_add_u32 v214, 256, v214
    v_xor_b32 v215, 64, v214
    v_xor_b32 v180, v183, v186
    v_lshl_add_u32 v224, v180, 4, v187
    v_add_u32 v224, 256, v224
    v_xor_b32 v225, 32, v224
    v_xor_b32 v226, 64, v224
    v_xor_b32 v227, 96, v224
    v_lshrrev_b32 v180, 2, v184
    v_mul_u32_u24 v182, 384, v180
    v_bfe_u32 v183, v180, 1, 2
    v_lshl_add_u32 v182, v183, 5, v182
    v_and_b32 v183, 3, v184
    v_lshl_add_u32 v197, v183, 3, v182
    v_xor_b32 v198, 32, v197
    v_xor_b32 v199, 64, v197
    v_xor_b32 v200, 96, v197
    v_add_u32 v250, 148480, v197
    v_add_u32 v251, 148480, v198
    v_add_u32 v252, 148480, v199
    v_add_u32 v253, 148480, v200
    v_mov_b32 v188, 0
    v_mov_b32 v180, 0x3f803f80
    v_accvgpr_write_b32 a216, v180
    v_accvgpr_write_b32 a217, v180
    v_accvgpr_write_b32 a218, v180
    v_accvgpr_write_b32 a219, v180
    s_add_u32 m0, s30, 49152
    s_add_u32 s21, s31, 12288
    buffer_load_dwordx4 v201, s[4:7], s21 offen offset:0 nt lds
    buffer_load_dwordx4 v202, s[4:7], s21 offen offset:1024 nt lds
    buffer_load_dwordx4 v203, s[4:7], s21 offen offset:2048 nt lds
    s_add_u32 m0, s30, 0
    s_add_u32 s21, s31, 0
    buffer_load_dwordx4 v204, s[8:11], s21 offen offset:0 nt lds
    buffer_load_dwordx4 v205, s[8:11], s21 offen offset:1024 nt lds
    buffer_load_dwordx4 v206, s[8:11], s21 offen offset:2048 nt lds
    s_add_u32 m0, s30, 148480
    s_add_u32 s21, s31, 12288
    buffer_load_dwordx4 v204, s[8:11], s21 offen offset:0 nt lds
    buffer_load_dwordx4 v205, s[8:11], s21 offen offset:1024 nt lds
    buffer_load_dwordx4 v206, s[8:11], s21 offen offset:2048 nt lds
    s_add_u32 m0, s55, 6144
    s_add_u32 s27, s44, 6144
    buffer_load_dwordx4 v207, s[12:15], s27 offen offset:0 nt lds
    buffer_load_dwordx4 v207, s[12:15], s27 offen offset:1024 nt lds
    s_waitcnt vmcnt(17)
    s_barrier
    ds_read_b128 a[72:75], v195 offset:0
    ds_read_b128 a[76:79], v196 offset:0
    ds_read_b128 a[80:83], v195 offset:128
    ds_read_b128 a[84:87], v196 offset:128
    ds_read_b128 a[88:91], v195 offset:256
    ds_read_b128 a[92:95], v196 offset:256
    ds_read_b128 a[96:99], v195 offset:6144
    ds_read_b128 a[100:103], v196 offset:6144
    ds_read_b128 a[104:107], v195 offset:6272
    ds_read_b128 a[108:111], v196 offset:6272
    ds_read_b128 a[112:115], v195 offset:6400
    ds_read_b128 a[116:119], v196 offset:6400
    s_waitcnt vmcnt(11)
    ds_read_b128 a[0:3], v210 offset:0
    ds_read_b128 a[4:7], v211 offset:0
    ds_read_b128 a[8:11], v212 offset:0
    ds_read_b128 a[12:15], v213 offset:0
    ds_read_b128 a[16:19], v214 offset:0
    ds_read_b128 a[20:23], v215 offset:0
    s_waitcnt lgkmcnt(0)
    v_mfma_f32_16x16x32_bf16 v[144:147], a[72:75], a[0:3], 0
    v_mfma_f32_16x16x32_bf16 v[144:147], a[76:79], a[4:7], v[144:147]
    v_mfma_f32_16x16x32_bf16 v[144:147], a[80:83], a[8:11], v[144:147]
    v_mfma_f32_16x16x32_bf16 v[144:147], a[84:87], a[12:15], v[144:147]
    v_mfma_f32_16x16x32_bf16 v[144:147], a[88:91], a[16:19], v[144:147]
    v_mfma_f32_16x16x32_bf16 v[144:147], a[92:95], a[20:23], v[144:147]
    v_mfma_f32_16x16x32_bf16 v[148:151], a[96:99], a[0:3], 0
    v_mfma_f32_16x16x32_bf16 v[148:151], a[100:103], a[4:7], v[148:151]
    v_mfma_f32_16x16x32_bf16 v[148:151], a[104:107], a[8:11], v[148:151]
    v_mfma_f32_16x16x32_bf16 v[148:151], a[108:111], a[12:15], v[148:151]
    v_mfma_f32_16x16x32_bf16 v[148:151], a[112:115], a[16:19], v[148:151]
    v_mfma_f32_16x16x32_bf16 v[148:151], a[116:119], a[20:23], v[148:151]
    s_add_u32 m0, s55, 6144
    s_add_u32 s27, s44, 6144
    buffer_load_dwordx4 v207, s[12:15], s27 offen offset:2048 nt lds
    s_add_u32 m0, s55, 9216
    s_add_u32 s27, s44, 9216
    buffer_load_dwordx4 v207, s[12:15], s27 offen offset:0 nt lds
    buffer_load_dwordx4 v207, s[12:15], s27 offen offset:1024 nt lds
    buffer_load_dwordx4 v207, s[12:15], s27 offen offset:2048 nt lds
    s_waitcnt vmcnt(9)
    s_barrier
    ds_read_b128 a[168:171], v195 offset:12288
    ds_read_b128 a[172:175], v196 offset:12288
    ds_read_b128 a[176:179], v195 offset:12416
    ds_read_b128 a[180:183], v196 offset:12416
    ds_read_b128 a[184:187], v195 offset:12544
    ds_read_b128 a[188:191], v196 offset:12544
    ds_read_b128 a[192:195], v195 offset:18432
    ds_read_b128 a[196:199], v196 offset:18432
    ds_read_b128 a[200:203], v195 offset:18560
    ds_read_b128 a[204:207], v196 offset:18560
    ds_read_b128 a[208:211], v195 offset:18688
    ds_read_b128 a[212:215], v196 offset:18688
    ds_read_b64_tr_b16 a[120:121], v197 offset:0
    ds_read_b64_tr_b16 a[122:123], v197 offset:6144
    ds_read_b64_tr_b16 a[124:125], v198 offset:0
    ds_read_b64_tr_b16 a[126:127], v198 offset:6144
    ds_read_b64_tr_b16 a[128:129], v199 offset:0
    ds_read_b64_tr_b16 a[130:131], v199 offset:6144
    ds_read_b64_tr_b16 a[132:133], v200 offset:0
    ds_read_b64_tr_b16 a[134:135], v200 offset:6144
    ds_read_b64_tr_b16 a[136:137], v197 offset:128
    ds_read_b64_tr_b16 a[138:139], v197 offset:6272
    ds_read_b64_tr_b16 a[140:141], v198 offset:128
    ds_read_b64_tr_b16 a[142:143], v198 offset:6272
    ds_read_b64_tr_b16 a[144:145], v199 offset:128
    ds_read_b64_tr_b16 a[146:147], v199 offset:6272
    ds_read_b64_tr_b16 a[148:149], v200 offset:128
    ds_read_b64_tr_b16 a[150:151], v200 offset:6272
    ds_read_b64_tr_b16 a[152:153], v197 offset:256
    ds_read_b64_tr_b16 a[154:155], v197 offset:6400
    ds_read_b64_tr_b16 a[156:157], v198 offset:256
    ds_read_b64_tr_b16 a[158:159], v198 offset:6400
    ds_read_b64_tr_b16 a[160:161], v199 offset:256
    ds_read_b64_tr_b16 a[162:163], v199 offset:6400
    ds_read_b64_tr_b16 a[164:165], v200 offset:256
    ds_read_b64_tr_b16 a[166:167], v200 offset:6400
    s_waitcnt lgkmcnt(14)
    v_mfma_f32_16x16x32_bf16 v[152:155], a[168:171], a[0:3], 0
    v_mfma_f32_16x16x32_bf16 v[152:155], a[172:175], a[4:7], v[152:155]
    v_mfma_f32_16x16x32_bf16 v[152:155], a[176:179], a[8:11], v[152:155]
    v_mfma_f32_16x16x32_bf16 v[152:155], a[180:183], a[12:15], v[152:155]
    v_mfma_f32_16x16x32_bf16 v[152:155], a[184:187], a[16:19], v[152:155]
    v_mfma_f32_16x16x32_bf16 v[152:155], a[188:191], a[20:23], v[152:155]
    v_mfma_f32_16x16x32_bf16 v[156:159], a[192:195], a[0:3], 0
    v_mfma_f32_16x16x32_bf16 v[156:159], a[196:199], a[4:7], v[156:159]
    v_mfma_f32_16x16x32_bf16 v[156:159], a[200:203], a[8:11], v[156:159]
    v_mfma_f32_16x16x32_bf16 v[156:159], a[204:207], a[12:15], v[156:159]
    v_mfma_f32_16x16x32_bf16 v[156:159], a[208:211], a[16:19], v[156:159]
    v_mfma_f32_16x16x32_bf16 v[156:159], a[212:215], a[20:23], v[156:159]
    s_add_u32 m0, s55, 12288
    s_add_u32 s27, s44, 12288
    buffer_load_dwordx4 v207, s[12:15], s27 offen offset:0 nt lds
    buffer_load_dwordx4 v207, s[12:15], s27 offen offset:1024 nt lds
    buffer_load_dwordx4 v207, s[12:15], s27 offen offset:2048 nt lds
    v_max3_f32 v244, v144, v145, v146
    v_max3_f32 v244, v244, v147, v148
    v_max3_f32 v244, v244, v149, v150
    v_max3_f32 v244, v244, v151, v152
    v_max3_f32 v244, v244, v153, v154
    v_max3_f32 v244, v244, v155, v156
    v_max3_f32 v244, v244, v157, v158
    v_max_f32 v244, v244, v159
    v_mov_b32 v245, v244
    s_nop 1
    v_permlane32_swap_b32 v244, v245
    v_max_f32 v244, v244, v245
    v_mov_b32 v245, v244
    s_nop 1
    v_permlane16_swap_b32 v244, v245
    v_max_f32 v244, v244, v245
    v_mul_f32 v192, s25, v244
    v_add_f32 v192, 0x41100000, v192
    v_fma_f32 v180, v144, s25, -v192
    v_fma_f32 v181, v145, s25, -v192
    v_exp_f32 v180, v180
    v_exp_f32 v181, v181
    v_fma_f32 v182, v146, s25, -v192
    v_fma_f32 v183, v147, s25, -v192
    v_exp_f32 v182, v182
    v_exp_f32 v183, v183
    v_cvt_pk_bf16_f32 v168, v180, v181
    v_fma_f32 v184, v148, s25, -v192
    v_fma_f32 v185, v149, s25, -v192
    v_exp_f32 v184, v184
    v_cvt_pk_bf16_f32 v169, v182, v183
    v_exp_f32 v185, v185
    v_fma_f32 v186, v150, s25, -v192
    v_fma_f32 v187, v151, s25, -v192
    v_exp_f32 v186, v186
    v_cvt_pk_bf16_f32 v170, v184, v185
    v_exp_f32 v187, v187
    s_nop 0
    v_cvt_pk_bf16_f32 v171, v186, v187
    s_waitcnt vmcnt(9) lgkmcnt(0)
    s_barrier
    v_mfma_f32_16x16x32_bf16 v[232:235], a[216:219], v[168:171], 0
    v_fma_f32 v180, v152, s25, -v192
    v_fma_f32 v181, v153, s25, -v192
    v_exp_f32 v180, v180
    v_mfma_f32_16x16x32_bf16 v[0:3], a[120:123], v[168:171], 0
    ds_read_b64_tr_b16 a[120:121], v250 offset:0
    ds_read_b64_tr_b16 a[122:123], v250 offset:6144
    v_exp_f32 v181, v181
    v_mfma_f32_16x16x32_bf16 v[4:7], a[124:127], v[168:171], 0
    ds_read_b64_tr_b16 a[124:125], v251 offset:0
    ds_read_b64_tr_b16 a[126:127], v251 offset:6144
    v_fma_f32 v182, v154, s25, -v192
    v_mfma_f32_16x16x32_bf16 v[8:11], a[128:131], v[168:171], 0
    ds_read_b64_tr_b16 a[128:129], v252 offset:0
    ds_read_b64_tr_b16 a[130:131], v252 offset:6144
    v_fma_f32 v183, v155, s25, -v192
    v_exp_f32 v182, v182
    v_mfma_f32_16x16x32_bf16 v[12:15], a[132:135], v[168:171], 0
    ds_read_b64_tr_b16 a[132:133], v253 offset:0
    ds_read_b64_tr_b16 a[134:135], v253 offset:6144
    v_exp_f32 v183, v183
    v_mfma_f32_16x16x32_bf16 v[16:19], a[136:139], v[168:171], 0
    ds_read_b64_tr_b16 a[136:137], v250 offset:128
    ds_read_b64_tr_b16 a[138:139], v250 offset:6272
    v_cvt_pk_bf16_f32 v172, v180, v181
    v_mfma_f32_16x16x32_bf16 v[20:23], a[140:143], v[168:171], 0
    ds_read_b64_tr_b16 a[140:141], v251 offset:128
    ds_read_b64_tr_b16 a[142:143], v251 offset:6272
    v_fma_f32 v184, v156, s25, -v192
    v_fma_f32 v185, v157, s25, -v192
    v_exp_f32 v184, v184
    v_mfma_f32_16x16x32_bf16 v[24:27], a[144:147], v[168:171], 0
    ds_read_b64_tr_b16 a[144:145], v252 offset:128
    ds_read_b64_tr_b16 a[146:147], v252 offset:6272
    v_cvt_pk_bf16_f32 v173, v182, v183
    v_mfma_f32_16x16x32_bf16 v[28:31], a[148:151], v[168:171], 0
    ds_read_b64_tr_b16 a[148:149], v253 offset:128
    ds_read_b64_tr_b16 a[150:151], v253 offset:6272
    v_exp_f32 v185, v185
    v_mfma_f32_16x16x32_bf16 v[32:35], a[152:155], v[168:171], 0
    ds_read_b64_tr_b16 a[152:153], v250 offset:256
    ds_read_b64_tr_b16 a[154:155], v250 offset:6400
    v_fma_f32 v186, v158, s25, -v192
    v_fma_f32 v187, v159, s25, -v192
    v_mfma_f32_16x16x32_bf16 v[36:39], a[156:159], v[168:171], 0
    ds_read_b64_tr_b16 a[156:157], v251 offset:256
    ds_read_b64_tr_b16 a[158:159], v251 offset:6400
    v_exp_f32 v186, v186
    v_mfma_f32_16x16x32_bf16 v[40:43], a[160:163], v[168:171], 0
    ds_read_b64_tr_b16 a[160:161], v252 offset:256
    ds_read_b64_tr_b16 a[162:163], v252 offset:6400
    v_cvt_pk_bf16_f32 v174, v184, v185
    v_exp_f32 v187, v187
    v_mfma_f32_16x16x32_bf16 v[44:47], a[164:167], v[168:171], 0
    ds_read_b64_tr_b16 a[164:165], v253 offset:256
    ds_read_b64_tr_b16 a[166:167], v253 offset:6400
    v_cvt_pk_bf16_f32 v175, v186, v187
    s_nop 1
    v_mfma_f32_16x16x32_bf16 v[232:235], a[216:219], v[172:175], v[232:235]
    s_waitcnt lgkmcnt(10)
    v_mfma_f32_16x16x32_bf16 v[0:3], a[120:123], v[172:175], v[0:3]
    v_mfma_f32_16x16x32_bf16 v[4:7], a[124:127], v[172:175], v[4:7]
    v_mfma_f32_16x16x32_bf16 v[8:11], a[128:131], v[172:175], v[8:11]
    v_mfma_f32_16x16x32_bf16 v[12:15], a[132:135], v[172:175], v[12:15]
    v_mfma_f32_16x16x32_bf16 v[16:19], a[136:139], v[172:175], v[16:19]
    v_mfma_f32_16x16x32_bf16 v[20:23], a[140:143], v[172:175], v[20:23]
    v_mfma_f32_16x16x32_bf16 v[24:27], a[144:147], v[172:175], v[24:27]
    s_waitcnt lgkmcnt(0)
    v_mfma_f32_16x16x32_bf16 v[28:31], a[148:151], v[172:175], v[28:31]
    v_mfma_f32_16x16x32_bf16 v[32:35], a[152:155], v[172:175], v[32:35]
    v_mfma_f32_16x16x32_bf16 v[36:39], a[156:159], v[172:175], v[36:39]
    v_mfma_f32_16x16x32_bf16 v[40:43], a[160:163], v[172:175], v[40:43]
    v_mfma_f32_16x16x32_bf16 v[44:47], a[164:167], v[172:175], v[44:47]
    s_add_u32 m0, s55, 15360
    s_add_u32 s27, s44, 15360
    buffer_load_dwordx4 v207, s[12:15], s27 offen offset:0 nt lds
    buffer_load_dwordx4 v207, s[12:15], s27 offen offset:1024 nt lds
    buffer_load_dwordx4 v207, s[12:15], s27 offen offset:2048 nt lds
    s_add_u32 m0, s30, 61440
    s_add_u32 s21, s31, 24576
    buffer_load_dwordx4 v201, s[4:7], s21 offen offset:0 nt lds
    buffer_load_dwordx4 v202, s[4:7], s21 offen offset:1024 nt lds
    buffer_load_dwordx4 v203, s[4:7], s21 offen offset:2048 nt lds
    s_waitcnt vmcnt(9)
    ds_read_b128 a[24:27], v210 offset:6144
    ds_read_b128 a[28:31], v211 offset:6144
    ds_read_b128 a[32:35], v212 offset:6144
    ds_read_b128 a[36:39], v213 offset:6144
    ds_read_b128 a[40:43], v214 offset:6144
    ds_read_b128 a[44:47], v215 offset:6144
    s_waitcnt lgkmcnt(5)
    v_mfma_f32_16x16x32_bf16 v[152:155], a[168:171], a[24:27], 0
    s_waitcnt lgkmcnt(4)
    v_mfma_f32_16x16x32_bf16 v[152:155], a[172:175], a[28:31], v[152:155]
    s_waitcnt lgkmcnt(3)
    v_mfma_f32_16x16x32_bf16 v[152:155], a[176:179], a[32:35], v[152:155]
    s_waitcnt lgkmcnt(2)
    v_mfma_f32_16x16x32_bf16 v[152:155], a[180:183], a[36:39], v[152:155]
    s_waitcnt lgkmcnt(1)
    v_mfma_f32_16x16x32_bf16 v[152:155], a[184:187], a[40:43], v[152:155]
    s_waitcnt lgkmcnt(0)
    v_mfma_f32_16x16x32_bf16 v[152:155], a[188:191], a[44:47], v[152:155]
    v_mfma_f32_16x16x32_bf16 v[156:159], a[192:195], a[24:27], 0
    v_mfma_f32_16x16x32_bf16 v[156:159], a[196:199], a[28:31], v[156:159]
    v_mfma_f32_16x16x32_bf16 v[156:159], a[200:203], a[32:35], v[156:159]
    v_mfma_f32_16x16x32_bf16 v[156:159], a[204:207], a[36:39], v[156:159]
    v_mfma_f32_16x16x32_bf16 v[156:159], a[208:211], a[40:43], v[156:159]
    v_mfma_f32_16x16x32_bf16 v[156:159], a[212:215], a[44:47], v[156:159]
    v_mfma_f32_16x16x32_bf16 v[144:147], a[72:75], a[24:27], 0
    v_mfma_f32_16x16x32_bf16 v[144:147], a[76:79], a[28:31], v[144:147]
    v_mfma_f32_16x16x32_bf16 v[144:147], a[80:83], a[32:35], v[144:147]
    v_mfma_f32_16x16x32_bf16 v[144:147], a[84:87], a[36:39], v[144:147]
    v_mfma_f32_16x16x32_bf16 v[144:147], a[88:91], a[40:43], v[144:147]
    v_mfma_f32_16x16x32_bf16 v[144:147], a[92:95], a[44:47], v[144:147]
    v_mfma_f32_16x16x32_bf16 v[148:151], a[96:99], a[24:27], 0
    v_mfma_f32_16x16x32_bf16 v[148:151], a[100:103], a[28:31], v[148:151]
    v_mfma_f32_16x16x32_bf16 v[148:151], a[104:107], a[32:35], v[148:151]
    v_mfma_f32_16x16x32_bf16 v[148:151], a[108:111], a[36:39], v[148:151]
    v_mfma_f32_16x16x32_bf16 v[148:151], a[112:115], a[40:43], v[148:151]
    v_mfma_f32_16x16x32_bf16 v[148:151], a[116:119], a[44:47], v[148:151]
    s_nop 1
    v_max3_f32 v244, v144, v145, v146
    s_nop 4
    v_max3_f32 v244, v244, v147, v148
    v_max3_f32 v244, v244, v149, v150
    v_max3_f32 v244, v244, v151, v152
    v_max3_f32 v244, v244, v153, v154
    v_max3_f32 v244, v244, v155, v156
    v_max3_f32 v244, v244, v157, v158
    v_max_f32 v244, v244, v159
    v_mov_b32 v245, v244
    s_nop 1
    v_permlane32_swap_b32 v244, v245
    v_max_f32 v244, v244, v245
    v_mov_b32 v245, v244
    s_nop 1
    v_permlane16_swap_b32 v244, v245
    v_max_f32 v244, v244, v245
    v_mul_f32 v193, s25, v244
    v_add_f32 v193, 0x41100000, v193
    v_fma_f32 v180, v152, s25, -v193
    v_fma_f32 v181, v153, s25, -v193
    v_exp_f32 v180, v180
    v_exp_f32 v181, v181
    v_fma_f32 v182, v154, s25, -v193
    v_fma_f32 v183, v155, s25, -v193
    v_exp_f32 v182, v182
    v_exp_f32 v183, v183
    v_cvt_pk_bf16_f32 v172, v180, v181
    v_fma_f32 v184, v156, s25, -v193
    v_fma_f32 v185, v157, s25, -v193
    v_exp_f32 v184, v184
    v_cvt_pk_bf16_f32 v173, v182, v183
    v_exp_f32 v185, v185
    v_fma_f32 v186, v158, s25, -v193
    v_fma_f32 v187, v159, s25, -v193
    v_exp_f32 v186, v186
    v_cvt_pk_bf16_f32 v174, v184, v185
    v_exp_f32 v187, v187
    s_nop 0
    v_cvt_pk_bf16_f32 v175, v186, v187
    s_nop 1
    v_mfma_f32_16x16x32_bf16 v[236:239], a[216:219], v[172:175], 0
    v_fma_f32 v180, v144, s25, -v193
    v_fma_f32 v181, v145, s25, -v193
    v_exp_f32 v180, v180
    v_mfma_f32_16x16x32_bf16 v[48:51], a[120:123], v[172:175], 0
    ds_read_b64_tr_b16 a[120:121], v197 offset:0
    ds_read_b64_tr_b16 a[122:123], v197 offset:6144
    v_exp_f32 v181, v181
    v_mfma_f32_16x16x32_bf16 v[52:55], a[124:127], v[172:175], 0
    ds_read_b64_tr_b16 a[124:125], v198 offset:0
    ds_read_b64_tr_b16 a[126:127], v198 offset:6144
    v_fma_f32 v182, v146, s25, -v193
    v_mfma_f32_16x16x32_bf16 v[56:59], a[128:131], v[172:175], 0
    ds_read_b64_tr_b16 a[128:129], v199 offset:0
    ds_read_b64_tr_b16 a[130:131], v199 offset:6144
    v_fma_f32 v183, v147, s25, -v193
    v_exp_f32 v182, v182
    v_mfma_f32_16x16x32_bf16 v[60:63], a[132:135], v[172:175], 0
    ds_read_b64_tr_b16 a[132:133], v200 offset:0
    ds_read_b64_tr_b16 a[134:135], v200 offset:6144
    v_exp_f32 v183, v183
    v_mfma_f32_16x16x32_bf16 v[64:67], a[136:139], v[172:175], 0
    ds_read_b64_tr_b16 a[136:137], v197 offset:128
    ds_read_b64_tr_b16 a[138:139], v197 offset:6272
    v_cvt_pk_bf16_f32 v168, v180, v181
    v_mfma_f32_16x16x32_bf16 v[68:71], a[140:143], v[172:175], 0
    ds_read_b64_tr_b16 a[140:141], v198 offset:128
    ds_read_b64_tr_b16 a[142:143], v198 offset:6272
    v_fma_f32 v184, v148, s25, -v193
    v_fma_f32 v185, v149, s25, -v193
    v_exp_f32 v184, v184
    v_mfma_f32_16x16x32_bf16 v[72:75], a[144:147], v[172:175], 0
    ds_read_b64_tr_b16 a[144:145], v199 offset:128
    ds_read_b64_tr_b16 a[146:147], v199 offset:6272
    v_cvt_pk_bf16_f32 v169, v182, v183
    v_mfma_f32_16x16x32_bf16 v[76:79], a[148:151], v[172:175], 0
    ds_read_b64_tr_b16 a[148:149], v200 offset:128
    ds_read_b64_tr_b16 a[150:151], v200 offset:6272
    v_exp_f32 v185, v185
    v_mfma_f32_16x16x32_bf16 v[80:83], a[152:155], v[172:175], 0
    ds_read_b64_tr_b16 a[152:153], v197 offset:256
    ds_read_b64_tr_b16 a[154:155], v197 offset:6400
    v_fma_f32 v186, v150, s25, -v193
    v_fma_f32 v187, v151, s25, -v193
    v_mfma_f32_16x16x32_bf16 v[84:87], a[156:159], v[172:175], 0
    ds_read_b64_tr_b16 a[156:157], v198 offset:256
    ds_read_b64_tr_b16 a[158:159], v198 offset:6400
    v_exp_f32 v186, v186
    v_mfma_f32_16x16x32_bf16 v[88:91], a[160:163], v[172:175], 0
    ds_read_b64_tr_b16 a[160:161], v199 offset:256
    ds_read_b64_tr_b16 a[162:163], v199 offset:6400
    v_cvt_pk_bf16_f32 v170, v184, v185
    v_exp_f32 v187, v187
    v_mfma_f32_16x16x32_bf16 v[92:95], a[164:167], v[172:175], 0
    ds_read_b64_tr_b16 a[164:165], v200 offset:256
    ds_read_b64_tr_b16 a[166:167], v200 offset:6400
    v_cvt_pk_bf16_f32 v171, v186, v187
    s_nop 1
    v_mfma_f32_16x16x32_bf16 v[236:239], a[216:219], v[168:171], v[236:239]
    s_waitcnt lgkmcnt(10)
    v_mfma_f32_16x16x32_bf16 v[48:51], a[120:123], v[168:171], v[48:51]
    v_mfma_f32_16x16x32_bf16 v[52:55], a[124:127], v[168:171], v[52:55]
    v_mfma_f32_16x16x32_bf16 v[56:59], a[128:131], v[168:171], v[56:59]
    v_mfma_f32_16x16x32_bf16 v[60:63], a[132:135], v[168:171], v[60:63]
    v_mfma_f32_16x16x32_bf16 v[64:67], a[136:139], v[168:171], v[64:67]
    v_mfma_f32_16x16x32_bf16 v[68:71], a[140:143], v[168:171], v[68:71]
    v_mfma_f32_16x16x32_bf16 v[72:75], a[144:147], v[168:171], v[72:75]
    s_waitcnt lgkmcnt(0)
    v_mfma_f32_16x16x32_bf16 v[76:79], a[148:151], v[168:171], v[76:79]
    v_mfma_f32_16x16x32_bf16 v[80:83], a[152:155], v[168:171], v[80:83]
    v_mfma_f32_16x16x32_bf16 v[84:87], a[156:159], v[168:171], v[84:87]
    v_mfma_f32_16x16x32_bf16 v[88:91], a[160:163], v[168:171], v[88:91]
    v_mfma_f32_16x16x32_bf16 v[92:95], a[164:167], v[168:171], v[92:95]
    s_add_u32 m0, s30, 24576
    s_add_u32 s21, s31, 24576
    buffer_load_dwordx4 v204, s[8:11], s21 offen offset:0 nt lds
    buffer_load_dwordx4 v205, s[8:11], s21 offen offset:1024 nt lds
    buffer_load_dwordx4 v206, s[8:11], s21 offen offset:2048 nt lds
    s_add_u32 m0, s30, 36864
    s_add_u32 s21, s31, 36864
    buffer_load_dwordx4 v201, s[4:7], s21 offen offset:0 nt lds
    buffer_load_dwordx4 v202, s[4:7], s21 offen offset:1024 nt lds
    buffer_load_dwordx4 v203, s[4:7], s21 offen offset:2048 nt lds
    s_waitcnt lgkmcnt(0)
    s_barrier
    s_add_u32 m0, s30, 0
    s_add_u32 s21, s31, 36864
    buffer_load_dwordx4 v204, s[8:11], s21 offen offset:0 nt lds
    buffer_load_dwordx4 v205, s[8:11], s21 offen offset:1024 nt lds
    buffer_load_dwordx4 v206, s[8:11], s21 offen offset:2048 nt lds
    s_waitcnt vmcnt(12)
    ds_read_b128 a[48:51], v210 offset:12288
    ds_read_b128 a[52:55], v211 offset:12288
    ds_read_b128 a[56:59], v212 offset:12288
    ds_read_b128 a[60:63], v213 offset:12288
    ds_read_b128 a[64:67], v214 offset:12288
    ds_read_b128 a[68:71], v215 offset:12288
    s_waitcnt lgkmcnt(5)
    v_mfma_f32_16x16x32_bf16 v[144:147], a[72:75], a[48:51], 0
    s_waitcnt lgkmcnt(4)
    v_mfma_f32_16x16x32_bf16 v[144:147], a[76:79], a[52:55], v[144:147]
    s_waitcnt lgkmcnt(3)
    v_mfma_f32_16x16x32_bf16 v[144:147], a[80:83], a[56:59], v[144:147]
    s_waitcnt lgkmcnt(2)
    v_mfma_f32_16x16x32_bf16 v[144:147], a[84:87], a[60:63], v[144:147]
    s_waitcnt lgkmcnt(1)
    v_mfma_f32_16x16x32_bf16 v[144:147], a[88:91], a[64:67], v[144:147]
    s_waitcnt lgkmcnt(0)
    v_mfma_f32_16x16x32_bf16 v[144:147], a[92:95], a[68:71], v[144:147]
    v_mfma_f32_16x16x32_bf16 v[148:151], a[96:99], a[48:51], 0
    v_mfma_f32_16x16x32_bf16 v[148:151], a[100:103], a[52:55], v[148:151]
    v_mfma_f32_16x16x32_bf16 v[148:151], a[104:107], a[56:59], v[148:151]
    v_mfma_f32_16x16x32_bf16 v[148:151], a[108:111], a[60:63], v[148:151]
    s_waitcnt vmcnt(9) lgkmcnt(0)
    v_mfma_f32_16x16x32_bf16 v[148:151], a[112:115], a[64:67], v[148:151]
    s_barrier
    v_mfma_f32_16x16x32_bf16 v[148:151], a[116:119], a[68:71], v[148:151]
    v_mfma_f32_16x16x32_bf16 v[160:163], a[168:171], a[48:51], 0
    ds_read_b128 a[72:75], v195 offset:24576
    v_mfma_f32_16x16x32_bf16 v[160:163], a[172:175], a[52:55], v[160:163]
    ds_read_b128 a[76:79], v196 offset:24576
    v_max3_f32 v244, v144, v145, v146
    s_nop 2
    v_max3_f32 v244, v244, v147, v148
    v_max3_f32 v244, v244, v149, v150
    v_max_f32 v244, v244, v151
    v_mfma_f32_16x16x32_bf16 v[160:163], a[176:179], a[56:59], v[160:163]
    ds_read_b128 a[80:83], v195 offset:24704
    v_mov_b32 v245, v244
    s_nop 1
    v_permlane32_swap_b32 v244, v245
    v_max_f32 v244, v244, v245
    v_mfma_f32_16x16x32_bf16 v[160:163], a[180:183], a[60:63], v[160:163]
    ds_read_b128 a[84:87], v196 offset:24704
    v_mov_b32 v245, v244
    s_nop 1
    v_permlane16_swap_b32 v244, v245
    v_max_f32 v244, v244, v245
    v_mfma_f32_16x16x32_bf16 v[160:163], a[184:187], a[64:67], v[160:163]
    ds_read_b128 a[88:91], v195 offset:24832
    v_mul_f32 v194, s25, v244
    v_add_f32 v194, 0x41100000, v194
    v_fma_f32 v180, v144, s25, -v194
    v_fma_f32 v181, v145, s25, -v194
    v_mfma_f32_16x16x32_bf16 v[160:163], a[188:191], a[68:71], v[160:163]
    ds_read_b128 a[92:95], v196 offset:24832
    v_exp_f32 v180, v180
    v_exp_f32 v181, v181
    v_mfma_f32_16x16x32_bf16 v[164:167], a[192:195], a[48:51], 0
    ds_read_b128 a[96:99], v195 offset:30720
    v_fma_f32 v182, v146, s25, -v194
    v_fma_f32 v183, v147, s25, -v194
    v_exp_f32 v182, v182
    v_mfma_f32_16x16x32_bf16 v[164:167], a[196:199], a[52:55], v[164:167]
    ds_read_b128 a[100:103], v196 offset:30720
    v_exp_f32 v183, v183
    v_cvt_pk_bf16_f32 v168, v180, v181
    v_mfma_f32_16x16x32_bf16 v[164:167], a[200:203], a[56:59], v[164:167]
    ds_read_b128 a[104:107], v195 offset:30848
    v_fma_f32 v184, v148, s25, -v194
    v_fma_f32 v185, v149, s25, -v194
    v_exp_f32 v184, v184
    v_mfma_f32_16x16x32_bf16 v[164:167], a[204:207], a[60:63], v[164:167]
    ds_read_b128 a[108:111], v196 offset:30848
    v_cvt_pk_bf16_f32 v169, v182, v183
    v_exp_f32 v185, v185
    v_fma_f32 v186, v150, s25, -v194
    v_mfma_f32_16x16x32_bf16 v[164:167], a[208:211], a[64:67], v[164:167]
    ds_read_b128 a[112:115], v195 offset:30976
    v_fma_f32 v187, v151, s25, -v194
    v_exp_f32 v186, v186
    v_cvt_pk_bf16_f32 v170, v184, v185
    v_mfma_f32_16x16x32_bf16 v[164:167], a[212:215], a[68:71], v[164:167]
    ds_read_b128 a[116:119], v196 offset:30976
    v_exp_f32 v187, v187
    s_nop 0
    v_cvt_pk_bf16_f32 v171, v186, v187
    s_nop 1
    v_mfma_f32_16x16x32_bf16 v[240:243], a[216:219], v[168:171], 0
    v_fma_f32 v180, v160, s25, -v194
    v_mfma_f32_16x16x32_bf16 v[96:99], a[120:123], v[168:171], 0
    ds_read_b64_tr_b16 a[120:121], v250 offset:0
    ds_read_b64_tr_b16 a[122:123], v250 offset:6144
    v_fma_f32 v181, v161, s25, -v194
    v_mfma_f32_16x16x32_bf16 v[100:103], a[124:127], v[168:171], 0
    ds_read_b64_tr_b16 a[124:125], v251 offset:0
    ds_read_b64_tr_b16 a[126:127], v251 offset:6144
    v_exp_f32 v180, v180
    v_mfma_f32_16x16x32_bf16 v[104:107], a[128:131], v[168:171], 0
    ds_read_b64_tr_b16 a[128:129], v252 offset:0
    ds_read_b64_tr_b16 a[130:131], v252 offset:6144
    v_mfma_f32_16x16x32_bf16 v[108:111], a[132:135], v[168:171], 0
    ds_read_b64_tr_b16 a[132:133], v253 offset:0
    ds_read_b64_tr_b16 a[134:135], v253 offset:6144
    v_fma_f32 v182, v162, s25, -v194
    v_mfma_f32_16x16x32_bf16 v[112:115], a[136:139], v[168:171], 0
    ds_read_b64_tr_b16 a[136:137], v250 offset:128
    ds_read_b64_tr_b16 a[138:139], v250 offset:6272
    v_exp_f32 v181, v181
    v_mfma_f32_16x16x32_bf16 v[116:119], a[140:143], v[168:171], 0
    ds_read_b64_tr_b16 a[140:141], v251 offset:128
    ds_read_b64_tr_b16 a[142:143], v251 offset:6272
    v_fma_f32 v183, v163, s25, -v194
    v_mfma_f32_16x16x32_bf16 v[120:123], a[144:147], v[168:171], 0
    ds_read_b64_tr_b16 a[144:145], v252 offset:128
    ds_read_b64_tr_b16 a[146:147], v252 offset:6272
    v_mfma_f32_16x16x32_bf16 v[124:127], a[148:151], v[168:171], 0
    ds_read_b64_tr_b16 a[148:149], v253 offset:128
    ds_read_b64_tr_b16 a[150:151], v253 offset:6272
    v_exp_f32 v182, v182
    v_mfma_f32_16x16x32_bf16 v[128:131], a[152:155], v[168:171], 0
    ds_read_b64_tr_b16 a[152:153], v250 offset:256
    ds_read_b64_tr_b16 a[154:155], v250 offset:6400
    v_fma_f32 v184, v164, s25, -v194
    v_mfma_f32_16x16x32_bf16 v[132:135], a[156:159], v[168:171], 0
    ds_read_b64_tr_b16 a[156:157], v251 offset:256
    ds_read_b64_tr_b16 a[158:159], v251 offset:6400
    v_exp_f32 v183, v183
    v_mfma_f32_16x16x32_bf16 v[136:139], a[160:163], v[168:171], 0
    ds_read_b64_tr_b16 a[160:161], v252 offset:256
    ds_read_b64_tr_b16 a[162:163], v252 offset:6400
    v_mfma_f32_16x16x32_bf16 v[140:143], a[164:167], v[168:171], 0
    s_waitcnt lgkmcnt(10)
    ds_read_b64_tr_b16 a[164:165], v253 offset:256
    ds_read_b64_tr_b16 a[166:167], v253 offset:6400
    v_mfma_f32_16x16x32_bf16 v[144:147], a[72:75], a[0:3], 0
    v_fma_f32 v185, v165, s25, -v194
    v_cvt_pk_bf16_f32 v176, v180, v181
    v_mfma_f32_16x16x32_bf16 v[144:147], a[76:79], a[4:7], v[144:147]
    v_exp_f32 v184, v184
    v_mfma_f32_16x16x32_bf16 v[144:147], a[80:83], a[8:11], v[144:147]
    v_fma_f32 v186, v166, s25, -v194
    v_mfma_f32_16x16x32_bf16 v[144:147], a[84:87], a[12:15], v[144:147]
    v_exp_f32 v185, v185
    v_mfma_f32_16x16x32_bf16 v[144:147], a[88:91], a[16:19], v[144:147]
    v_fma_f32 v187, v167, s25, -v194
    v_cvt_pk_bf16_f32 v177, v182, v183
    v_mfma_f32_16x16x32_bf16 v[144:147], a[92:95], a[20:23], v[144:147]
    v_exp_f32 v186, v186
    v_mfma_f32_16x16x32_bf16 v[148:151], a[96:99], a[0:3], 0
    v_exp_f32 v187, v187
    v_mfma_f32_16x16x32_bf16 v[148:151], a[100:103], a[4:7], v[148:151]
    s_waitcnt vmcnt(6) lgkmcnt(0)
    v_cvt_pk_bf16_f32 v178, v184, v185
    v_or3_b32 v188, v176, v177, v178
    v_mfma_f32_16x16x32_bf16 v[148:151], a[104:107], a[8:11], v[148:151]
    s_barrier
    v_cvt_pk_bf16_f32 v179, v186, v187
    v_bitop3_b32 v188, v188, v179, s26 bitop3:0xa8
    v_mfma_f32_16x16x32_bf16 v[148:151], a[108:111], a[12:15], v[148:151]
    v_cmp_ne_u32 vcc, 0, v188
    v_mfma_f32_16x16x32_bf16 v[148:151], a[112:115], a[16:19], v[148:151]
    v_mfma_f32_16x16x32_bf16 v[148:151], a[116:119], a[20:23], v[148:151]
    s_cbranch_vccnz Z_rare_s22
Z_back_s22:
    v_fma_f32 v180, v144, s25, -v192
    v_mfma_f32_16x16x32_bf16 v[240:243], a[216:219], v[176:179], v[240:243]
    v_fma_f32 v181, v145, s25, -v192
    v_fma_f32 v182, v146, s25, -v192
    s_add_u32 m0, s30, 12288
    s_add_u32 s21, s31, 49152
    v_mfma_f32_16x16x32_bf16 v[96:99], a[120:123], v[176:179], v[96:99]
    ds_read_b64_tr_b16 a[120:121], v197 offset:24576
    ds_read_b64_tr_b16 a[122:123], v197 offset:30720
    buffer_load_dwordx4 v204, s[8:11], s21 offen offset:0 nt lds
    v_mfma_f32_16x16x32_bf16 v[100:103], a[124:127], v[176:179], v[100:103]
    v_exp_f32 v180, v180
    v_mfma_f32_16x16x32_bf16 v[104:107], a[128:131], v[176:179], v[104:107]
    s_nop 0
    buffer_load_dwordx4 v205, s[8:11], s21 offen offset:1024 nt lds
    v_exp_f32 v181, v181
    v_mfma_f32_16x16x32_bf16 v[108:111], a[132:135], v[176:179], v[108:111]
    ds_read_b64_tr_b16 a[124:125], v198 offset:24576
    ds_read_b64_tr_b16 a[126:127], v198 offset:30720
    v_mfma_f32_16x16x32_bf16 v[112:115], a[136:139], v[176:179], v[112:115]
    s_nop 0
    buffer_load_dwordx4 v206, s[8:11], s21 offen offset:2048 nt lds
    v_fma_f32 v183, v147, s25, -v192
    v_fma_f32 v184, v148, s25, -v192
    v_mfma_f32_16x16x32_bf16 v[116:119], a[140:143], v[176:179], v[116:119]
    v_exp_f32 v182, v182
    s_add_u32 m0, s30, 49152
    s_add_u32 s21, s31, 49152
    v_mfma_f32_16x16x32_bf16 v[120:123], a[144:147], v[176:179], v[120:123]
    ds_read_b64_tr_b16 a[128:129], v199 offset:24576
    ds_read_b64_tr_b16 a[130:131], v199 offset:30720
    buffer_load_dwordx4 v201, s[4:7], s21 offen offset:0 nt lds
    v_mfma_f32_16x16x32_bf16 v[124:127], a[148:151], v[176:179], v[124:127]
    v_exp_f32 v183, v183
    v_mfma_f32_16x16x32_bf16 v[128:131], a[152:155], v[176:179], v[128:131]
    s_nop 0
    buffer_load_dwordx4 v202, s[4:7], s21 offen offset:1024 nt lds
    v_fma_f32 v185, v149, s25, -v192
    v_cvt_pk_bf16_f32 v168, v180, v181
    v_mfma_f32_16x16x32_bf16 v[132:135], a[156:159], v[176:179], v[132:135]
    ds_read_b64_tr_b16 a[132:133], v200 offset:24576
    ds_read_b64_tr_b16 a[134:135], v200 offset:30720
    v_mfma_f32_16x16x32_bf16 v[136:139], a[160:163], v[176:179], v[136:139]
    s_nop 0
    buffer_load_dwordx4 v203, s[4:7], s21 offen offset:2048 nt lds
    v_exp_f32 v184, v184
    v_mfma_f32_16x16x32_bf16 v[140:143], a[164:167], v[176:179], v[140:143]
    v_fma_f32 v186, v150, s25, -v192
    v_cvt_pk_bf16_f32 v169, v182, v183
    s_mov_b32 s14, 0
    s_mov_b32 m0, 147456
    v_mfma_f32_16x16x32_bf16 v[152:155], a[72:75], a[24:27], 0
    ds_read_b64_tr_b16 a[136:137], v197 offset:24704
    ds_read_b64_tr_b16 a[138:139], v197 offset:30848
    buffer_load_dwordx4 v207, s[12:15], s45 offen offset:0 nt lds
    v_mfma_f32_16x16x32_bf16 v[152:155], a[76:79], a[28:31], v[152:155]
    v_exp_f32 v185, v185
    v_mfma_f32_16x16x32_bf16 v[152:155], a[80:83], a[32:35], v[152:155]
    s_nop 0
    buffer_load_dwordx4 v207, s[12:15], s45 offen offset:0 nt lds
    v_exp_f32 v186, v186
    v_mfma_f32_16x16x32_bf16 v[152:155], a[84:87], a[36:39], v[152:155]
    ds_read_b64_tr_b16 a[140:141], v198 offset:24704
    ds_read_b64_tr_b16 a[142:143], v198 offset:30848
    v_mfma_f32_16x16x32_bf16 v[152:155], a[88:91], a[40:43], v[152:155]
    s_nop 0
    buffer_load_dwordx4 v207, s[12:15], s45 offen offset:0 nt lds
    v_fma_f32 v187, v151, s25, -v192
    v_cvt_pk_bf16_f32 v170, v184, v185
    v_mfma_f32_16x16x32_bf16 v[152:155], a[92:95], a[44:47], v[152:155]
    v_exp_f32 v187, v187
    s_mov_b32 s14, 0
    s_mov_b32 m0, 147456
    v_mfma_f32_16x16x32_bf16 v[156:159], a[96:99], a[24:27], 0
    ds_read_b64_tr_b16 a[144:145], v199 offset:24704
    ds_read_b64_tr_b16 a[146:147], v199 offset:30848
    buffer_load_dwordx4 v207, s[12:15], s45 offen offset:0 nt lds
    v_mfma_f32_16x16x32_bf16 v[156:159], a[100:103], a[28:31], v[156:159]
    v_or3_b32 v188, v168, v169, v170
    v_cvt_pk_bf16_f32 v171, v186, v187
    v_mfma_f32_16x16x32_bf16 v[156:159], a[104:107], a[32:35], v[156:159]
    ds_read_b64_tr_b16 a[148:149], v200 offset:24704
    ds_read_b64_tr_b16 a[150:151], v200 offset:30848
    v_mfma_f32_16x16x32_bf16 v[156:159], a[108:111], a[36:39], v[156:159]
    v_bitop3_b32 v188, v188, v171, s26 bitop3:0xa8
    v_cmp_ne_u32 vcc, 0, v188
    v_mfma_f32_16x16x32_bf16 v[156:159], a[112:115], a[40:43], v[156:159]
    ds_read_b64_tr_b16 a[152:153], v197 offset:24832
    ds_read_b64_tr_b16 a[154:155], v197 offset:30976
    v_mfma_f32_16x16x32_bf16 v[156:159], a[116:119], a[44:47], v[156:159]
    s_cbranch_vccnz Z_rare_s20
Z_back_s20:
    s_add_u32 s21, s31, 61440
    s_waitcnt lgkmcnt(4)
    s_branch Z_g0_0
.p2align 6
Z_loop0:
    v_mfma_f32_16x16x32_bf16 v[236:239], a[216:219], v[172:175], v[236:239]
    ds_read_b128 a[92:95], v196 offset:12544
    v_fma_f32 v180, v160, s25, -v194
    v_mfma_f32_16x16x32_bf16 v[48:51], a[120:123], v[172:175], v[48:51]
    ds_read_b128 a[96:99], v195 offset:18432
    v_fma_f32 v181, v161, s25, -v194
    v_mfma_f32_16x16x32_bf16 v[52:55], a[124:127], v[172:175], v[52:55]
    v_exp_f32 v180, v180
    v_mfma_f32_16x16x32_bf16 v[56:59], a[128:131], v[172:175], v[56:59]
    s_add_u32 s51, s51, s50
    buffer_load_dwordx4 v202, s[4:7], s21 offen offset:1024 nt lds
    v_mfma_f32_16x16x32_bf16 v[60:63], a[132:135], v[172:175], v[60:63]
    s_add_u32 s52, s52, s50
    ds_read_b128 a[100:103], v196 offset:18432
    v_fma_f32 v182, v162, s25, -v194
    v_mfma_f32_16x16x32_bf16 v[64:67], a[136:139], v[172:175], v[64:67]
    s_bitcmp1_b32 s36, s20
    v_exp_f32 v181, v181
    v_mfma_f32_16x16x32_bf16 v[68:71], a[140:143], v[172:175], v[68:71]
    s_cselect_b32 s14, s54, 0
    ds_read_b128 a[104:107], v195 offset:18560
    v_fma_f32 v183, v163, s25, -v194
    v_mfma_f32_16x16x32_bf16 v[72:75], a[144:147], v[172:175], v[72:75]
    s_cselect_b32 s50, 1024, 0
    buffer_load_dwordx4 v203, s[4:7], s21 offen offset:2048 nt lds
    v_mfma_f32_16x16x32_bf16 v[76:79], a[148:151], v[172:175], v[76:79]
    s_cselect_b32 m0, s52, 147456
    v_exp_f32 v182, v182
    v_mfma_f32_16x16x32_bf16 v[80:83], a[152:155], v[172:175], v[80:83]
    ds_read_b128 a[108:111], v196 offset:18560
    v_fma_f32 v184, v164, s25, -v194
    v_mfma_f32_16x16x32_bf16 v[84:87], a[156:159], v[172:175], v[84:87]
    v_exp_f32 v183, v183
    v_mfma_f32_16x16x32_bf16 v[88:91], a[160:163], v[172:175], v[88:91]
    s_add_u32 s20, s20, 1
    buffer_load_dwordx4 v207, s[12:15], s51 offen offset:0 nt lds
    v_mfma_f32_16x16x32_bf16 v[92:95], a[164:167], v[172:175], v[92:95]
    s_waitcnt lgkmcnt(1)
    ds_read_b128 a[112:115], v195 offset:18688
    ds_read_b128 a[116:119], v196 offset:18688
    v_mfma_f32_16x16x32_bf16 v[144:147], a[72:75], a[0:3], 0
    s_add_u32 s51, s51, s50
    v_fma_f32 v185, v165, s25, -v194
    v_cvt_pk_bf16_f32 v176, v180, v181
    v_mfma_f32_16x16x32_bf16 v[144:147], a[76:79], a[4:7], v[144:147]
    s_add_u32 s52, s52, s50
    v_exp_f32 v184, v184
    v_mfma_f32_16x16x32_bf16 v[144:147], a[80:83], a[8:11], v[144:147]
    s_bitcmp1_b32 s33, s20
    v_fma_f32 v186, v166, s25, -v194
    v_mfma_f32_16x16x32_bf16 v[144:147], a[84:87], a[12:15], v[144:147]
    s_cselect_b32 s14, s54, 0
    v_exp_f32 v185, v185
    v_mfma_f32_16x16x32_bf16 v[144:147], a[88:91], a[16:19], v[144:147]
    s_cselect_b32 s50, 1024, 0
    v_fma_f32 v187, v167, s25, -v194
    v_cvt_pk_bf16_f32 v177, v182, v183
    v_mfma_f32_16x16x32_bf16 v[144:147], a[92:95], a[20:23], v[144:147]
    s_cselect_b32 m0, s52, 147456
    v_exp_f32 v186, v186
    v_mfma_f32_16x16x32_bf16 v[148:151], a[96:99], a[0:3], 0
    v_exp_f32 v187, v187
    v_mfma_f32_16x16x32_bf16 v[148:151], a[100:103], a[4:7], v[148:151]
    v_cvt_pk_bf16_f32 v178, v184, v185
    v_or3_b32 v188, v176, v177, v178
    v_mfma_f32_16x16x32_bf16 v[148:151], a[104:107], a[8:11], v[148:151]
    s_waitcnt lgkmcnt(0)
    v_cvt_pk_bf16_f32 v179, v186, v187
    v_bitop3_b32 v188, v188, v179, s26 bitop3:0xa8
    v_mfma_f32_16x16x32_bf16 v[148:151], a[108:111], a[12:15], v[148:151]
    v_cmp_ne_u32 vcc, 0, v188
    v_mfma_f32_16x16x32_bf16 v[148:151], a[112:115], a[16:19], v[148:151]
    s_nop 0
    buffer_load_dwordx4 v207, s[12:15], s51 offen offset:0 nt lds
    v_mfma_f32_16x16x32_bf16 v[148:151], a[116:119], a[20:23], v[148:151]
    s_cbranch_vccnz Z_rare_l0b2
Z_back_l0b2:
    v_fma_f32 v180, v144, s25, -v192
    v_mfma_f32_16x16x32_bf16 v[240:243], a[216:219], v[176:179], v[240:243]
    v_fma_f32 v181, v145, s25, -v192
    v_fma_f32 v182, v146, s25, -v192
    v_mfma_f32_16x16x32_bf16 v[96:99], a[120:123], v[176:179], v[96:99]
    ds_read_b64_tr_b16 a[120:121], v197 offset:12288
    ds_read_b64_tr_b16 a[122:123], v197 offset:18432
    v_mfma_f32_16x16x32_bf16 v[100:103], a[124:127], v[176:179], v[100:103]
    v_exp_f32 v180, v180
    v_mfma_f32_16x16x32_bf16 v[104:107], a[128:131], v[176:179], v[104:107]
    v_exp_f32 v181, v181
    v_mfma_f32_16x16x32_bf16 v[108:111], a[132:135], v[176:179], v[108:111]
    ds_read_b64_tr_b16 a[124:125], v198 offset:12288
    ds_read_b64_tr_b16 a[126:127], v198 offset:18432
    v_mfma_f32_16x16x32_bf16 v[112:115], a[136:139], v[176:179], v[112:115]
    v_fma_f32 v183, v147, s25, -v192
    v_fma_f32 v184, v148, s25, -v192
    v_mfma_f32_16x16x32_bf16 v[116:119], a[140:143], v[176:179], v[116:119]
    v_exp_f32 v182, v182
    v_mfma_f32_16x16x32_bf16 v[120:123], a[144:147], v[176:179], v[120:123]
    ds_read_b64_tr_b16 a[128:129], v199 offset:12288
    ds_read_b64_tr_b16 a[130:131], v199 offset:18432
    v_mfma_f32_16x16x32_bf16 v[124:127], a[148:151], v[176:179], v[124:127]
    v_exp_f32 v183, v183
    v_mfma_f32_16x16x32_bf16 v[128:131], a[152:155], v[176:179], v[128:131]
    v_fma_f32 v185, v149, s25, -v192
    v_cvt_pk_bf16_f32 v168, v180, v181
    v_mfma_f32_16x16x32_bf16 v[132:135], a[156:159], v[176:179], v[132:135]
    ds_read_b64_tr_b16 a[132:133], v200 offset:12288
    ds_read_b64_tr_b16 a[134:135], v200 offset:18432
    v_mfma_f32_16x16x32_bf16 v[136:139], a[160:163], v[176:179], v[136:139]
    v_exp_f32 v184, v184
    v_mfma_f32_16x16x32_bf16 v[140:143], a[164:167], v[176:179], v[140:143]
    v_fma_f32 v186, v150, s25, -v192
    v_cvt_pk_bf16_f32 v169, v182, v183
    v_mfma_f32_16x16x32_bf16 v[152:155], a[72:75], a[24:27], 0
    s_cmp_eq_u32 s20, 13
    ds_read_b64_tr_b16 a[136:137], v197 offset:12416
    ds_read_b64_tr_b16 a[138:139], v197 offset:18560
    v_mfma_f32_16x16x32_bf16 v[152:155], a[76:79], a[28:31], v[152:155]
    s_cselect_b32 s34, s32, 12288
    v_exp_f32 v185, v185
    v_mfma_f32_16x16x32_bf16 v[152:155], a[80:83], a[32:35], v[152:155]
    s_add_u32 s21, s21, s34
    v_exp_f32 v186, v186
    v_mfma_f32_16x16x32_bf16 v[152:155], a[84:87], a[36:39], v[152:155]
    ds_read_b64_tr_b16 a[140:141], v198 offset:12416
    ds_read_b64_tr_b16 a[142:143], v198 offset:18560
    v_mfma_f32_16x16x32_bf16 v[152:155], a[88:91], a[40:43], v[152:155]
    v_fma_f32 v187, v151, s25, -v192
    v_cvt_pk_bf16_f32 v170, v184, v185
    v_mfma_f32_16x16x32_bf16 v[152:155], a[92:95], a[44:47], v[152:155]
    v_exp_f32 v187, v187
    v_mfma_f32_16x16x32_bf16 v[156:159], a[96:99], a[24:27], 0
    ds_read_b64_tr_b16 a[144:145], v199 offset:12416
    ds_read_b64_tr_b16 a[146:147], v199 offset:18560
    v_mfma_f32_16x16x32_bf16 v[156:159], a[100:103], a[28:31], v[156:159]
    v_or3_b32 v188, v168, v169, v170
    v_cvt_pk_bf16_f32 v171, v186, v187
    v_mfma_f32_16x16x32_bf16 v[156:159], a[104:107], a[32:35], v[156:159]
    ds_read_b64_tr_b16 a[148:149], v200 offset:12416
    ds_read_b64_tr_b16 a[150:151], v200 offset:18560
    v_mfma_f32_16x16x32_bf16 v[156:159], a[108:111], a[36:39], v[156:159]
    v_bitop3_b32 v188, v188, v171, s26 bitop3:0xa8
    v_cmp_ne_u32 vcc, 0, v188
    v_mfma_f32_16x16x32_bf16 v[156:159], a[112:115], a[40:43], v[156:159]
    ds_read_b64_tr_b16 a[152:153], v197 offset:12544
    ds_read_b64_tr_b16 a[154:155], v197 offset:18688
    v_mfma_f32_16x16x32_bf16 v[156:159], a[116:119], a[44:47], v[156:159]
    s_cbranch_vccnz Z_rare_l0b0
Z_back_l0b0:
    v_mfma_f32_16x16x32_bf16 v[232:235], a[216:219], v[168:171], v[232:235]
    s_waitcnt lgkmcnt(4)
    ds_read_b64_tr_b16 a[156:157], v198 offset:12544
    ds_read_b64_tr_b16 a[158:159], v198 offset:18688
    v_mfma_f32_16x16x32_bf16 v[0:3], a[120:123], v[168:171], v[0:3]
    v_fma_f32 v180, v152, s25, -v193
    v_fma_f32 v181, v153, s25, -v193
    v_mfma_f32_16x16x32_bf16 v[4:7], a[124:127], v[168:171], v[4:7]
    ds_read_b64_tr_b16 a[160:161], v199 offset:12544
    ds_read_b64_tr_b16 a[162:163], v199 offset:18688
    v_mfma_f32_16x16x32_bf16 v[8:11], a[128:131], v[168:171], v[8:11]
    v_exp_f32 v180, v180
    v_mfma_f32_16x16x32_bf16 v[12:15], a[132:135], v[168:171], v[12:15]
    ds_read_b64_tr_b16 a[164:165], v200 offset:12544
    ds_read_b64_tr_b16 a[166:167], v200 offset:18688
    v_mfma_f32_16x16x32_bf16 v[16:19], a[136:139], v[168:171], v[16:19]
    s_add_u32 m0, s30, 12288
    v_fma_f32 v182, v154, s25, -v193
    v_fma_f32 v183, v155, s25, -v193
    v_mfma_f32_16x16x32_bf16 v[20:23], a[140:143], v[168:171], v[20:23]
    v_exp_f32 v181, v181
    v_mfma_f32_16x16x32_bf16 v[24:27], a[144:147], v[168:171], v[24:27]
    s_waitcnt lgkmcnt(4)
    v_exp_f32 v182, v182
    v_mfma_f32_16x16x32_bf16 v[28:31], a[148:151], v[168:171], v[28:31]
    v_fma_f32 v184, v156, s25, -v193
    v_cvt_pk_bf16_f32 v172, v180, v181
    v_mfma_f32_16x16x32_bf16 v[32:35], a[152:155], v[168:171], v[32:35]
    s_waitcnt vmcnt(10) lgkmcnt(0)
    v_exp_f32 v183, v183
    v_mfma_f32_16x16x32_bf16 v[36:39], a[156:159], v[168:171], v[36:39]
    s_barrier
    v_fma_f32 v185, v157, s25, -v193
    v_fma_f32 v186, v158, s25, -v193
    v_mfma_f32_16x16x32_bf16 v[40:43], a[160:163], v[168:171], v[40:43]
    v_exp_f32 v184, v184
    v_mfma_f32_16x16x32_bf16 v[44:47], a[164:167], v[168:171], v[44:47]
    s_nop 0
    buffer_load_dwordx4 v204, s[8:11], s21 offen offset:0 nt lds
    v_mfma_f32_16x16x32_bf16 v[160:163], a[72:75], a[48:51], 0
    v_exp_f32 v185, v185
    v_mfma_f32_16x16x32_bf16 v[160:163], a[76:79], a[52:55], v[160:163]
    ds_read_b128 a[72:75], v195 offset:24576
    v_fma_f32 v187, v159, s25, -v193
    v_mfma_f32_16x16x32_bf16 v[160:163], a[80:83], a[56:59], v[160:163]
    v_exp_f32 v186, v186
    v_mfma_f32_16x16x32_bf16 v[160:163], a[84:87], a[60:63], v[160:163]
    s_nop 0
    buffer_load_dwordx4 v205, s[8:11], s21 offen offset:1024 nt lds
    v_mfma_f32_16x16x32_bf16 v[160:163], a[88:91], a[64:67], v[160:163]
    v_exp_f32 v187, v187
    v_mfma_f32_16x16x32_bf16 v[160:163], a[92:95], a[68:71], v[160:163]
    ds_read_b128 a[76:79], v196 offset:24576
    v_cvt_pk_bf16_f32 v173, v182, v183
    v_mfma_f32_16x16x32_bf16 v[164:167], a[96:99], a[48:51], 0
    ds_read_b128 a[80:83], v195 offset:24704
    v_cvt_pk_bf16_f32 v174, v184, v185
    v_mfma_f32_16x16x32_bf16 v[164:167], a[100:103], a[52:55], v[164:167]
    s_nop 0
    buffer_load_dwordx4 v206, s[8:11], s21 offen offset:2048 nt lds
    v_mfma_f32_16x16x32_bf16 v[164:167], a[104:107], a[56:59], v[164:167]
    s_add_u32 m0, s30, 49152
    v_or3_b32 v188, v172, v173, v174
    v_cvt_pk_bf16_f32 v175, v186, v187
    v_mfma_f32_16x16x32_bf16 v[164:167], a[108:111], a[60:63], v[164:167]
    v_bitop3_b32 v188, v188, v175, s26 bitop3:0xa8
    v_cmp_ne_u32 vcc, 0, v188
    v_mfma_f32_16x16x32_bf16 v[164:167], a[112:115], a[64:67], v[164:167]
    ds_read_b128 a[84:87], v196 offset:24704
    ds_read_b128 a[88:91], v195 offset:24832
    v_mfma_f32_16x16x32_bf16 v[164:167], a[116:119], a[68:71], v[164:167]
    s_cbranch_vccnz Z_rare_l0b1
Z_back_l0b1:
    buffer_load_dwordx4 v201, s[4:7], s21 offen offset:0 nt lds
    v_mfma_f32_16x16x32_bf16 v[236:239], a[216:219], v[172:175], v[236:239]
    ds_read_b128 a[92:95], v196 offset:24832
    v_fma_f32 v180, v160, s25, -v194
    v_mfma_f32_16x16x32_bf16 v[48:51], a[120:123], v[172:175], v[48:51]
    ds_read_b128 a[96:99], v195 offset:30720
    v_fma_f32 v181, v161, s25, -v194
    v_mfma_f32_16x16x32_bf16 v[52:55], a[124:127], v[172:175], v[52:55]
    v_exp_f32 v180, v180
    v_mfma_f32_16x16x32_bf16 v[56:59], a[128:131], v[172:175], v[56:59]
    s_add_u32 s51, s51, s50
    buffer_load_dwordx4 v202, s[4:7], s21 offen offset:1024 nt lds
    v_mfma_f32_16x16x32_bf16 v[60:63], a[132:135], v[172:175], v[60:63]
    s_add_u32 s52, s52, s50
    ds_read_b128 a[100:103], v196 offset:30720
    v_fma_f32 v182, v162, s25, -v194
    v_mfma_f32_16x16x32_bf16 v[64:67], a[136:139], v[172:175], v[64:67]
    s_bitcmp1_b32 s36, s20
    v_exp_f32 v181, v181
    v_mfma_f32_16x16x32_bf16 v[68:71], a[140:143], v[172:175], v[68:71]
    s_cselect_b32 s14, s54, 0
    ds_read_b128 a[104:107], v195 offset:30848
    v_fma_f32 v183, v163, s25, -v194
    v_mfma_f32_16x16x32_bf16 v[72:75], a[144:147], v[172:175], v[72:75]
    s_cselect_b32 s50, 1024, 0
    buffer_load_dwordx4 v203, s[4:7], s21 offen offset:2048 nt lds
    v_mfma_f32_16x16x32_bf16 v[76:79], a[148:151], v[172:175], v[76:79]
    s_cselect_b32 m0, s52, 147456
    v_exp_f32 v182, v182
    v_mfma_f32_16x16x32_bf16 v[80:83], a[152:155], v[172:175], v[80:83]
    ds_read_b128 a[108:111], v196 offset:30848
    v_fma_f32 v184, v164, s25, -v194
    v_mfma_f32_16x16x32_bf16 v[84:87], a[156:159], v[172:175], v[84:87]
    v_exp_f32 v183, v183
    v_mfma_f32_16x16x32_bf16 v[88:91], a[160:163], v[172:175], v[88:91]
    s_add_u32 s20, s20, 1
    buffer_load_dwordx4 v207, s[12:15], s51 offen offset:0 nt lds
    v_mfma_f32_16x16x32_bf16 v[92:95], a[164:167], v[172:175], v[92:95]
    s_waitcnt lgkmcnt(1)
    ds_read_b128 a[112:115], v195 offset:30976
    ds_read_b128 a[116:119], v196 offset:30976
    v_mfma_f32_16x16x32_bf16 v[144:147], a[72:75], a[0:3], 0
    s_add_u32 s51, s51, s50
    v_fma_f32 v185, v165, s25, -v194
    v_cvt_pk_bf16_f32 v176, v180, v181
    v_mfma_f32_16x16x32_bf16 v[144:147], a[76:79], a[4:7], v[144:147]
    s_add_u32 s52, s52, s50
    v_exp_f32 v184, v184
    v_mfma_f32_16x16x32_bf16 v[144:147], a[80:83], a[8:11], v[144:147]
    s_bitcmp1_b32 s33, s20
    v_fma_f32 v186, v166, s25, -v194
    v_mfma_f32_16x16x32_bf16 v[144:147], a[84:87], a[12:15], v[144:147]
    s_cselect_b32 s14, s54, 0
    v_exp_f32 v185, v185
    v_mfma_f32_16x16x32_bf16 v[144:147], a[88:91], a[16:19], v[144:147]
    s_cselect_b32 s50, 1024, 0
    v_fma_f32 v187, v167, s25, -v194
    v_cvt_pk_bf16_f32 v177, v182, v183
    v_mfma_f32_16x16x32_bf16 v[144:147], a[92:95], a[20:23], v[144:147]
    s_cselect_b32 m0, s52, 147456
    v_exp_f32 v186, v186
    v_mfma_f32_16x16x32_bf16 v[148:151], a[96:99], a[0:3], 0
    v_exp_f32 v187, v187
    v_mfma_f32_16x16x32_bf16 v[148:151], a[100:103], a[4:7], v[148:151]
    v_cvt_pk_bf16_f32 v178, v184, v185
    v_or3_b32 v188, v176, v177, v178
    v_mfma_f32_16x16x32_bf16 v[148:151], a[104:107], a[8:11], v[148:151]
    s_waitcnt lgkmcnt(0)
    v_cvt_pk_bf16_f32 v179, v186, v187
    v_bitop3_b32 v188, v188, v179, s26 bitop3:0xa8
    v_mfma_f32_16x16x32_bf16 v[148:151], a[108:111], a[12:15], v[148:151]
    v_cmp_ne_u32 vcc, 0, v188
    v_mfma_f32_16x16x32_bf16 v[148:151], a[112:115], a[16:19], v[148:151]
    s_nop 0
    buffer_load_dwordx4 v207, s[12:15], s51 offen offset:0 nt lds
    v_mfma_f32_16x16x32_bf16 v[148:151], a[116:119], a[20:23], v[148:151]
    s_cbranch_vccnz Z_rare_l0c2
Z_back_l0c2:
    v_fma_f32 v180, v144, s25, -v192
    v_mfma_f32_16x16x32_bf16 v[240:243], a[216:219], v[176:179], v[240:243]
    v_fma_f32 v181, v145, s25, -v192
    v_fma_f32 v182, v146, s25, -v192
    v_mfma_f32_16x16x32_bf16 v[96:99], a[120:123], v[176:179], v[96:99]
    ds_read_b64_tr_b16 a[120:121], v197 offset:24576
    ds_read_b64_tr_b16 a[122:123], v197 offset:30720
    v_mfma_f32_16x16x32_bf16 v[100:103], a[124:127], v[176:179], v[100:103]
    v_exp_f32 v180, v180
    v_mfma_f32_16x16x32_bf16 v[104:107], a[128:131], v[176:179], v[104:107]
    v_exp_f32 v181, v181
    v_mfma_f32_16x16x32_bf16 v[108:111], a[132:135], v[176:179], v[108:111]
    ds_read_b64_tr_b16 a[124:125], v198 offset:24576
    ds_read_b64_tr_b16 a[126:127], v198 offset:30720
    v_mfma_f32_16x16x32_bf16 v[112:115], a[136:139], v[176:179], v[112:115]
    v_fma_f32 v183, v147, s25, -v192
    v_fma_f32 v184, v148, s25, -v192
    v_mfma_f32_16x16x32_bf16 v[116:119], a[140:143], v[176:179], v[116:119]
    v_exp_f32 v182, v182
    v_mfma_f32_16x16x32_bf16 v[120:123], a[144:147], v[176:179], v[120:123]
    ds_read_b64_tr_b16 a[128:129], v199 offset:24576
    ds_read_b64_tr_b16 a[130:131], v199 offset:30720
    v_mfma_f32_16x16x32_bf16 v[124:127], a[148:151], v[176:179], v[124:127]
    v_exp_f32 v183, v183
    v_mfma_f32_16x16x32_bf16 v[128:131], a[152:155], v[176:179], v[128:131]
    v_fma_f32 v185, v149, s25, -v192
    v_cvt_pk_bf16_f32 v168, v180, v181
    v_mfma_f32_16x16x32_bf16 v[132:135], a[156:159], v[176:179], v[132:135]
    ds_read_b64_tr_b16 a[132:133], v200 offset:24576
    ds_read_b64_tr_b16 a[134:135], v200 offset:30720
    v_mfma_f32_16x16x32_bf16 v[136:139], a[160:163], v[176:179], v[136:139]
    v_exp_f32 v184, v184
    v_mfma_f32_16x16x32_bf16 v[140:143], a[164:167], v[176:179], v[140:143]
    v_fma_f32 v186, v150, s25, -v192
    v_cvt_pk_bf16_f32 v169, v182, v183
    v_mfma_f32_16x16x32_bf16 v[152:155], a[72:75], a[24:27], 0
    s_cmp_eq_u32 s20, 13
    ds_read_b64_tr_b16 a[136:137], v197 offset:24704
    ds_read_b64_tr_b16 a[138:139], v197 offset:30848
    v_mfma_f32_16x16x32_bf16 v[152:155], a[76:79], a[28:31], v[152:155]
    s_cselect_b32 s34, s32, 12288
    v_exp_f32 v185, v185
    v_mfma_f32_16x16x32_bf16 v[152:155], a[80:83], a[32:35], v[152:155]
    s_add_u32 s21, s21, s34
    v_exp_f32 v186, v186
    v_mfma_f32_16x16x32_bf16 v[152:155], a[84:87], a[36:39], v[152:155]
    ds_read_b64_tr_b16 a[140:141], v198 offset:24704
    ds_read_b64_tr_b16 a[142:143], v198 offset:30848
    v_mfma_f32_16x16x32_bf16 v[152:155], a[88:91], a[40:43], v[152:155]
    v_fma_f32 v187, v151, s25, -v192
    v_cvt_pk_bf16_f32 v170, v184, v185
    v_mfma_f32_16x16x32_bf16 v[152:155], a[92:95], a[44:47], v[152:155]
    v_exp_f32 v187, v187
    v_mfma_f32_16x16x32_bf16 v[156:159], a[96:99], a[24:27], 0
    ds_read_b64_tr_b16 a[144:145], v199 offset:24704
    ds_read_b64_tr_b16 a[146:147], v199 offset:30848
    v_mfma_f32_16x16x32_bf16 v[156:159], a[100:103], a[28:31], v[156:159]
    v_or3_b32 v188, v168, v169, v170
    v_cvt_pk_bf16_f32 v171, v186, v187
    v_mfma_f32_16x16x32_bf16 v[156:159], a[104:107], a[32:35], v[156:159]
    ds_read_b64_tr_b16 a[148:149], v200 offset:24704
    ds_read_b64_tr_b16 a[150:151], v200 offset:30848
    v_mfma_f32_16x16x32_bf16 v[156:159], a[108:111], a[36:39], v[156:159]
    v_bitop3_b32 v188, v188, v171, s26 bitop3:0xa8
    v_cmp_ne_u32 vcc, 0, v188
    v_mfma_f32_16x16x32_bf16 v[156:159], a[112:115], a[40:43], v[156:159]
    ds_read_b64_tr_b16 a[152:153], v197 offset:24832
    ds_read_b64_tr_b16 a[154:155], v197 offset:30976
    v_mfma_f32_16x16x32_bf16 v[156:159], a[116:119], a[44:47], v[156:159]
    s_cbranch_vccnz Z_rare_l0c0
Z_back_l0c0:
Z_g0_0:
    v_mfma_f32_16x16x32_bf16 v[232:235], a[216:219], v[168:171], v[232:235]
    s_waitcnt lgkmcnt(4)
    ds_read_b64_tr_b16 a[156:157], v198 offset:24832
    ds_read_b64_tr_b16 a[158:159], v198 offset:30976
    v_mfma_f32_16x16x32_bf16 v[0:3], a[120:123], v[168:171], v[0:3]
    v_fma_f32 v180, v152, s25, -v193
    v_fma_f32 v181, v153, s25, -v193
    v_mfma_f32_16x16x32_bf16 v[4:7], a[124:127], v[168:171], v[4:7]
    ds_read_b64_tr_b16 a[160:161], v199 offset:24832
    ds_read_b64_tr_b16 a[162:163], v199 offset:30976
    v_mfma_f32_16x16x32_bf16 v[8:11], a[128:131], v[168:171], v[8:11]
    v_exp_f32 v180, v180
    v_mfma_f32_16x16x32_bf16 v[12:15], a[132:135], v[168:171], v[12:15]
    ds_read_b64_tr_b16 a[164:165], v200 offset:24832
    ds_read_b64_tr_b16 a[166:167], v200 offset:30976
    v_mfma_f32_16x16x32_bf16 v[16:19], a[136:139], v[168:171], v[16:19]
    s_add_u32 m0, s30, 24576
    v_fma_f32 v182, v154, s25, -v193
    v_fma_f32 v183, v155, s25, -v193
    v_mfma_f32_16x16x32_bf16 v[20:23], a[140:143], v[168:171], v[20:23]
    v_exp_f32 v181, v181
    v_mfma_f32_16x16x32_bf16 v[24:27], a[144:147], v[168:171], v[24:27]
    s_waitcnt lgkmcnt(4)
    v_exp_f32 v182, v182
    v_mfma_f32_16x16x32_bf16 v[28:31], a[148:151], v[168:171], v[28:31]
    v_fma_f32 v184, v156, s25, -v193
    v_cvt_pk_bf16_f32 v172, v180, v181
    v_mfma_f32_16x16x32_bf16 v[32:35], a[152:155], v[168:171], v[32:35]
    s_waitcnt vmcnt(10) lgkmcnt(0)
    v_exp_f32 v183, v183
    v_mfma_f32_16x16x32_bf16 v[36:39], a[156:159], v[168:171], v[36:39]
    s_barrier
    v_fma_f32 v185, v157, s25, -v193
    v_fma_f32 v186, v158, s25, -v193
    v_mfma_f32_16x16x32_bf16 v[40:43], a[160:163], v[168:171], v[40:43]
    v_exp_f32 v184, v184
    v_mfma_f32_16x16x32_bf16 v[44:47], a[164:167], v[168:171], v[44:47]
    s_nop 0
    buffer_load_dwordx4 v204, s[8:11], s21 offen offset:0 nt lds
    v_mfma_f32_16x16x32_bf16 v[160:163], a[72:75], a[48:51], 0
    v_exp_f32 v185, v185
    v_mfma_f32_16x16x32_bf16 v[160:163], a[76:79], a[52:55], v[160:163]
    ds_read_b128 a[72:75], v195 offset:0
    v_fma_f32 v187, v159, s25, -v193
    v_mfma_f32_16x16x32_bf16 v[160:163], a[80:83], a[56:59], v[160:163]
    v_exp_f32 v186, v186
    v_mfma_f32_16x16x32_bf16 v[160:163], a[84:87], a[60:63], v[160:163]
    s_nop 0
    buffer_load_dwordx4 v205, s[8:11], s21 offen offset:1024 nt lds
    v_mfma_f32_16x16x32_bf16 v[160:163], a[88:91], a[64:67], v[160:163]
    v_exp_f32 v187, v187
    v_mfma_f32_16x16x32_bf16 v[160:163], a[92:95], a[68:71], v[160:163]
    ds_read_b128 a[76:79], v196 offset:0
    v_cvt_pk_bf16_f32 v173, v182, v183
    v_mfma_f32_16x16x32_bf16 v[164:167], a[96:99], a[48:51], 0
    ds_read_b128 a[80:83], v195 offset:128
    v_cvt_pk_bf16_f32 v174, v184, v185
    v_mfma_f32_16x16x32_bf16 v[164:167], a[100:103], a[52:55], v[164:167]
    s_nop 0
    buffer_load_dwordx4 v206, s[8:11], s21 offen offset:2048 nt lds
    v_mfma_f32_16x16x32_bf16 v[164:167], a[104:107], a[56:59], v[164:167]
    s_add_u32 m0, s30, 61440
    v_or3_b32 v188, v172, v173, v174
    v_cvt_pk_bf16_f32 v175, v186, v187
    v_mfma_f32_16x16x32_bf16 v[164:167], a[108:111], a[60:63], v[164:167]
    v_bitop3_b32 v188, v188, v175, s26 bitop3:0xa8
    v_cmp_ne_u32 vcc, 0, v188
    v_mfma_f32_16x16x32_bf16 v[164:167], a[112:115], a[64:67], v[164:167]
    ds_read_b128 a[84:87], v196 offset:128
    ds_read_b128 a[88:91], v195 offset:256
    v_mfma_f32_16x16x32_bf16 v[164:167], a[116:119], a[68:71], v[164:167]
    s_cbranch_vccnz Z_rare_l0c1
Z_back_l0c1:
    buffer_load_dwordx4 v201, s[4:7], s21 offen offset:0 nt lds
    v_mfma_f32_16x16x32_bf16 v[236:239], a[216:219], v[172:175], v[236:239]
    ds_read_b128 a[92:95], v196 offset:256
    v_fma_f32 v180, v160, s25, -v194
    v_mfma_f32_16x16x32_bf16 v[48:51], a[120:123], v[172:175], v[48:51]
    ds_read_b128 a[96:99], v195 offset:6144
    v_fma_f32 v181, v161, s25, -v194
    v_mfma_f32_16x16x32_bf16 v[52:55], a[124:127], v[172:175], v[52:55]
    v_exp_f32 v180, v180
    v_mfma_f32_16x16x32_bf16 v[56:59], a[128:131], v[172:175], v[56:59]
    s_add_u32 s51, s51, s50
    buffer_load_dwordx4 v202, s[4:7], s21 offen offset:1024 nt lds
    v_mfma_f32_16x16x32_bf16 v[60:63], a[132:135], v[172:175], v[60:63]
    s_add_u32 s52, s52, s50
    ds_read_b128 a[100:103], v196 offset:6144
    v_fma_f32 v182, v162, s25, -v194
    v_mfma_f32_16x16x32_bf16 v[64:67], a[136:139], v[172:175], v[64:67]
    s_bitcmp1_b32 s36, s20
    v_exp_f32 v181, v181
    v_mfma_f32_16x16x32_bf16 v[68:71], a[140:143], v[172:175], v[68:71]
    s_cselect_b32 s14, s54, 0
    ds_read_b128 a[104:107], v195 offset:6272
    v_fma_f32 v183, v163, s25, -v194
    v_mfma_f32_16x16x32_bf16 v[72:75], a[144:147], v[172:175], v[72:75]
    s_cselect_b32 s50, 1024, 0
    buffer_load_dwordx4 v203, s[4:7], s21 offen offset:2048 nt lds
    v_mfma_f32_16x16x32_bf16 v[76:79], a[148:151], v[172:175], v[76:79]
    s_cselect_b32 m0, s52, 147456
    v_exp_f32 v182, v182
    v_mfma_f32_16x16x32_bf16 v[80:83], a[152:155], v[172:175], v[80:83]
    ds_read_b128 a[108:111], v196 offset:6272
    v_fma_f32 v184, v164, s25, -v194
    v_mfma_f32_16x16x32_bf16 v[84:87], a[156:159], v[172:175], v[84:87]
    v_exp_f32 v183, v183
    v_mfma_f32_16x16x32_bf16 v[88:91], a[160:163], v[172:175], v[88:91]
    s_add_u32 s20, s20, 1
    buffer_load_dwordx4 v207, s[12:15], s51 offen offset:0 nt lds
    v_mfma_f32_16x16x32_bf16 v[92:95], a[164:167], v[172:175], v[92:95]
    s_waitcnt lgkmcnt(1)
    ds_read_b128 a[112:115], v195 offset:6400
    ds_read_b128 a[116:119], v196 offset:6400
    v_mfma_f32_16x16x32_bf16 v[144:147], a[72:75], a[0:3], 0
    s_add_u32 s51, s51, s50
    v_fma_f32 v185, v165, s25, -v194
    v_cvt_pk_bf16_f32 v176, v180, v181
    v_mfma_f32_16x16x32_bf16 v[144:147], a[76:79], a[4:7], v[144:147]
    s_add_u32 s52, s52, s50
    v_exp_f32 v184, v184
    v_mfma_f32_16x16x32_bf16 v[144:147], a[80:83], a[8:11], v[144:147]
    s_bitcmp1_b32 s33, s20
    v_fma_f32 v186, v166, s25, -v194
    v_mfma_f32_16x16x32_bf16 v[144:147], a[84:87], a[12:15], v[144:147]
    s_cselect_b32 s14, s54, 0
    v_exp_f32 v185, v185
    v_mfma_f32_16x16x32_bf16 v[144:147], a[88:91], a[16:19], v[144:147]
    s_cselect_b32 s50, 1024, 0
    v_fma_f32 v187, v167, s25, -v194
    v_cvt_pk_bf16_f32 v177, v182, v183
    v_mfma_f32_16x16x32_bf16 v[144:147], a[92:95], a[20:23], v[144:147]
    s_cselect_b32 m0, s52, 147456
    v_exp_f32 v186, v186
    v_mfma_f32_16x16x32_bf16 v[148:151], a[96:99], a[0:3], 0
    v_exp_f32 v187, v187
    v_mfma_f32_16x16x32_bf16 v[148:151], a[100:103], a[4:7], v[148:151]
    v_cvt_pk_bf16_f32 v178, v184, v185
    v_or3_b32 v188, v176, v177, v178
    v_mfma_f32_16x16x32_bf16 v[148:151], a[104:107], a[8:11], v[148:151]
    s_waitcnt lgkmcnt(0)
    v_cvt_pk_bf16_f32 v179, v186, v187
    v_bitop3_b32 v188, v188, v179, s26 bitop3:0xa8
    v_mfma_f32_16x16x32_bf16 v[148:151], a[108:111], a[12:15], v[148:151]
    v_cmp_ne_u32 vcc, 0, v188
    v_mfma_f32_16x16x32_bf16 v[148:151], a[112:115], a[16:19], v[148:151]
    s_nop 0
    buffer_load_dwordx4 v207, s[12:15], s51 offen offset:0 nt lds
    v_mfma_f32_16x16x32_bf16 v[148:151], a[116:119], a[20:23], v[148:151]
    s_cbranch_vccnz Z_rare_l0a2
Z_back_l0a2:
    v_fma_f32 v180, v144, s25, -v192
    v_mfma_f32_16x16x32_bf16 v[240:243], a[216:219], v[176:179], v[240:243]
    v_fma_f32 v181, v145, s25, -v192
    v_fma_f32 v182, v146, s25, -v192
    v_mfma_f32_16x16x32_bf16 v[96:99], a[120:123], v[176:179], v[96:99]
    ds_read_b64_tr_b16 a[120:121], v197 offset:0
    ds_read_b64_tr_b16 a[122:123], v197 offset:6144
    v_mfma_f32_16x16x32_bf16 v[100:103], a[124:127], v[176:179], v[100:103]
    v_exp_f32 v180, v180
    v_mfma_f32_16x16x32_bf16 v[104:107], a[128:131], v[176:179], v[104:107]
    v_exp_f32 v181, v181
    v_mfma_f32_16x16x32_bf16 v[108:111], a[132:135], v[176:179], v[108:111]
    ds_read_b64_tr_b16 a[124:125], v198 offset:0
    ds_read_b64_tr_b16 a[126:127], v198 offset:6144
    v_mfma_f32_16x16x32_bf16 v[112:115], a[136:139], v[176:179], v[112:115]
    v_fma_f32 v183, v147, s25, -v192
    v_fma_f32 v184, v148, s25, -v192
    v_mfma_f32_16x16x32_bf16 v[116:119], a[140:143], v[176:179], v[116:119]
    v_exp_f32 v182, v182
    v_mfma_f32_16x16x32_bf16 v[120:123], a[144:147], v[176:179], v[120:123]
    ds_read_b64_tr_b16 a[128:129], v199 offset:0
    ds_read_b64_tr_b16 a[130:131], v199 offset:6144
    v_mfma_f32_16x16x32_bf16 v[124:127], a[148:151], v[176:179], v[124:127]
    v_exp_f32 v183, v183
    v_mfma_f32_16x16x32_bf16 v[128:131], a[152:155], v[176:179], v[128:131]
    v_fma_f32 v185, v149, s25, -v192
    v_cvt_pk_bf16_f32 v168, v180, v181
    v_mfma_f32_16x16x32_bf16 v[132:135], a[156:159], v[176:179], v[132:135]
    ds_read_b64_tr_b16 a[132:133], v200 offset:0
    ds_read_b64_tr_b16 a[134:135], v200 offset:6144
    v_mfma_f32_16x16x32_bf16 v[136:139], a[160:163], v[176:179], v[136:139]
    v_exp_f32 v184, v184
    v_mfma_f32_16x16x32_bf16 v[140:143], a[164:167], v[176:179], v[140:143]
    v_fma_f32 v186, v150, s25, -v192
    v_cvt_pk_bf16_f32 v169, v182, v183
    v_mfma_f32_16x16x32_bf16 v[152:155], a[72:75], a[24:27], 0
    s_cmp_eq_u32 s20, 13
    ds_read_b64_tr_b16 a[136:137], v197 offset:128
    ds_read_b64_tr_b16 a[138:139], v197 offset:6272
    v_mfma_f32_16x16x32_bf16 v[152:155], a[76:79], a[28:31], v[152:155]
    s_cselect_b32 s34, s32, 12288
    v_exp_f32 v185, v185
    v_mfma_f32_16x16x32_bf16 v[152:155], a[80:83], a[32:35], v[152:155]
    s_add_u32 s21, s21, s34
    v_exp_f32 v186, v186
    v_mfma_f32_16x16x32_bf16 v[152:155], a[84:87], a[36:39], v[152:155]
    ds_read_b64_tr_b16 a[140:141], v198 offset:128
    ds_read_b64_tr_b16 a[142:143], v198 offset:6272
    v_mfma_f32_16x16x32_bf16 v[152:155], a[88:91], a[40:43], v[152:155]
    v_fma_f32 v187, v151, s25, -v192
    v_cvt_pk_bf16_f32 v170, v184, v185
    v_mfma_f32_16x16x32_bf16 v[152:155], a[92:95], a[44:47], v[152:155]
    v_exp_f32 v187, v187
    v_mfma_f32_16x16x32_bf16 v[156:159], a[96:99], a[24:27], 0
    ds_read_b64_tr_b16 a[144:145], v199 offset:128
    ds_read_b64_tr_b16 a[146:147], v199 offset:6272
    v_mfma_f32_16x16x32_bf16 v[156:159], a[100:103], a[28:31], v[156:159]
    v_or3_b32 v188, v168, v169, v170
    v_cvt_pk_bf16_f32 v171, v186, v187
    v_mfma_f32_16x16x32_bf16 v[156:159], a[104:107], a[32:35], v[156:159]
    ds_read_b64_tr_b16 a[148:149], v200 offset:128
    ds_read_b64_tr_b16 a[150:151], v200 offset:6272
    v_mfma_f32_16x16x32_bf16 v[156:159], a[108:111], a[36:39], v[156:159]
    v_bitop3_b32 v188, v188, v171, s26 bitop3:0xa8
    v_cmp_ne_u32 vcc, 0, v188
    v_mfma_f32_16x16x32_bf16 v[156:159], a[112:115], a[40:43], v[156:159]
    ds_read_b64_tr_b16 a[152:153], v197 offset:256
    ds_read_b64_tr_b16 a[154:155], v197 offset:6400
    v_mfma_f32_16x16x32_bf16 v[156:159], a[116:119], a[44:47], v[156:159]
    s_cbranch_vccnz Z_rare_l0a0
Z_back_l0a0:
    v_mfma_f32_16x16x32_bf16 v[232:235], a[216:219], v[168:171], v[232:235]
    s_waitcnt lgkmcnt(4)
    ds_read_b64_tr_b16 a[156:157], v198 offset:256
    ds_read_b64_tr_b16 a[158:159], v198 offset:6400
    v_mfma_f32_16x16x32_bf16 v[0:3], a[120:123], v[168:171], v[0:3]
    v_fma_f32 v180, v152, s25, -v193
    v_fma_f32 v181, v153, s25, -v193
    v_mfma_f32_16x16x32_bf16 v[4:7], a[124:127], v[168:171], v[4:7]
    ds_read_b64_tr_b16 a[160:161], v199 offset:256
    ds_read_b64_tr_b16 a[162:163], v199 offset:6400
    v_mfma_f32_16x16x32_bf16 v[8:11], a[128:131], v[168:171], v[8:11]
    v_exp_f32 v180, v180
    v_mfma_f32_16x16x32_bf16 v[12:15], a[132:135], v[168:171], v[12:15]
    ds_read_b64_tr_b16 a[164:165], v200 offset:256
    ds_read_b64_tr_b16 a[166:167], v200 offset:6400
    v_mfma_f32_16x16x32_bf16 v[16:19], a[136:139], v[168:171], v[16:19]
    s_add_u32 m0, s30, 0
    v_fma_f32 v182, v154, s25, -v193
    v_fma_f32 v183, v155, s25, -v193
    v_mfma_f32_16x16x32_bf16 v[20:23], a[140:143], v[168:171], v[20:23]
    v_exp_f32 v181, v181
    v_mfma_f32_16x16x32_bf16 v[24:27], a[144:147], v[168:171], v[24:27]
    s_waitcnt lgkmcnt(4)
    v_exp_f32 v182, v182
    v_mfma_f32_16x16x32_bf16 v[28:31], a[148:151], v[168:171], v[28:31]
    v_fma_f32 v184, v156, s25, -v193
    v_cvt_pk_bf16_f32 v172, v180, v181
    v_mfma_f32_16x16x32_bf16 v[32:35], a[152:155], v[168:171], v[32:35]
    s_waitcnt vmcnt(10) lgkmcnt(0)
    v_exp_f32 v183, v183
    v_mfma_f32_16x16x32_bf16 v[36:39], a[156:159], v[168:171], v[36:39]
    s_barrier
    v_fma_f32 v185, v157, s25, -v193
    v_fma_f32 v186, v158, s25, -v193
    v_mfma_f32_16x16x32_bf16 v[40:43], a[160:163], v[168:171], v[40:43]
    v_exp_f32 v184, v184
    v_mfma_f32_16x16x32_bf16 v[44:47], a[164:167], v[168:171], v[44:47]
    s_nop 0
    buffer_load_dwordx4 v204, s[8:11], s21 offen offset:0 nt lds
    v_mfma_f32_16x16x32_bf16 v[160:163], a[72:75], a[48:51], 0
    v_exp_f32 v185, v185
    v_mfma_f32_16x16x32_bf16 v[160:163], a[76:79], a[52:55], v[160:163]
    ds_read_b128 a[72:75], v195 offset:12288
    v_fma_f32 v187, v159, s25, -v193
    v_mfma_f32_16x16x32_bf16 v[160:163], a[80:83], a[56:59], v[160:163]
    v_exp_f32 v186, v186
    v_mfma_f32_16x16x32_bf16 v[160:163], a[84:87], a[60:63], v[160:163]
    s_nop 0
    buffer_load_dwordx4 v205, s[8:11], s21 offen offset:1024 nt lds
    v_mfma_f32_16x16x32_bf16 v[160:163], a[88:91], a[64:67], v[160:163]
    v_exp_f32 v187, v187
    v_mfma_f32_16x16x32_bf16 v[160:163], a[92:95], a[68:71], v[160:163]
    ds_read_b128 a[76:79], v196 offset:12288
    v_cvt_pk_bf16_f32 v173, v182, v183
    v_mfma_f32_16x16x32_bf16 v[164:167], a[96:99], a[48:51], 0
    ds_read_b128 a[80:83], v195 offset:12416
    v_cvt_pk_bf16_f32 v174, v184, v185
    v_mfma_f32_16x16x32_bf16 v[164:167], a[100:103], a[52:55], v[164:167]
    s_nop 0
    buffer_load_dwordx4 v206, s[8:11], s21 offen offset:2048 nt lds
    v_mfma_f32_16x16x32_bf16 v[164:167], a[104:107], a[56:59], v[164:167]
    s_add_u32 m0, s30, 36864
    v_or3_b32 v188, v172, v173, v174
    v_cvt_pk_bf16_f32 v175, v186, v187
    v_mfma_f32_16x16x32_bf16 v[164:167], a[108:111], a[60:63], v[164:167]
    v_bitop3_b32 v188, v188, v175, s26 bitop3:0xa8
    v_cmp_ne_u32 vcc, 0, v188
    v_mfma_f32_16x16x32_bf16 v[164:167], a[112:115], a[64:67], v[164:167]
    ds_read_b128 a[84:87], v196 offset:12416
    ds_read_b128 a[88:91], v195 offset:12544
    v_mfma_f32_16x16x32_bf16 v[164:167], a[116:119], a[68:71], v[164:167]
    s_cbranch_vccnz Z_rare_l0a1
Z_back_l0a1:
    buffer_load_dwordx4 v201, s[4:7], s21 offen offset:0 nt lds
    s_cmp_lg_u32 s20, s47
    s_cbranch_scc1 Z_loop0
Z_T:
    v_mfma_f32_16x16x32_bf16 v[236:239], a[216:219], v[172:175], v[236:239]
    s_waitcnt vmcnt(37)
    ds_read_b128 a[92:95], v196 offset:12544
    ds_read_b128 a[0:3], v210 offset:0
    v_fma_f32 v180, v160, s25, -v194
    v_mfma_f32_16x16x32_bf16 v[48:51], a[120:123], v[172:175], v[48:51]
    ds_read_b128 a[96:99], v195 offset:18432
    ds_read_b128 a[4:7], v211 offset:0
    v_fma_f32 v181, v161, s25, -v194
    v_mfma_f32_16x16x32_bf16 v[52:55], a[124:127], v[172:175], v[52:55]
    ds_read_b128 a[8:11], v212 offset:0
    v_exp_f32 v180, v180
    v_rcp_f32 v232, v232
    s_nop 0
    v_pk_mul_f32 v[0:1], v[0:1], v[232:233] op_sel_hi:[1,0]
    v_pk_mul_f32 v[2:3], v[2:3], v[232:233] op_sel_hi:[1,0]
    v_pk_mul_f32 v[4:5], v[4:5], v[232:233] op_sel_hi:[1,0]
    v_pk_mul_f32 v[6:7], v[6:7], v[232:233] op_sel_hi:[1,0]
    v_pk_mul_f32 v[8:9], v[8:9], v[232:233] op_sel_hi:[1,0]
    v_pk_mul_f32 v[10:11], v[10:11], v[232:233] op_sel_hi:[1,0]
    v_pk_mul_f32 v[12:13], v[12:13], v[232:233] op_sel_hi:[1,0]
    v_pk_mul_f32 v[14:15], v[14:15], v[232:233] op_sel_hi:[1,0]
    v_mfma_f32_16x16x32_bf16 v[56:59], a[128:131], v[172:175], v[56:59]
    s_nop 0
    buffer_load_dwordx4 v202, s[4:7], s21 offen offset:1024 nt lds
    ds_read_b128 a[12:15], v213 offset:0
    v_mfma_f32_16x16x32_bf16 v[60:63], a[132:135], v[172:175], v[60:63]
    ds_read_b128 a[100:103], v196 offset:18432
    ds_read_b128 a[16:19], v214 offset:0
    v_fma_f32 v182, v162, s25, -v194
    v_mfma_f32_16x16x32_bf16 v[64:67], a[136:139], v[172:175], v[64:67]
    ds_read_b128 a[20:23], v215 offset:0
    v_exp_f32 v181, v181
    v_cvt_pk_bf16_f32 v0, v0, v1
    v_cvt_pk_bf16_f32 v1, v2, v3
    v_mfma_f32_16x16x32_bf16 v[68:71], a[140:143], v[172:175], v[68:71]
    ds_read_b128 a[104:107], v195 offset:18560
    ds_write_b64 v216, v[0:1] offset:0
    v_fma_f32 v183, v163, s25, -v194
    v_mfma_f32_16x16x32_bf16 v[72:75], a[144:147], v[172:175], v[72:75]
    s_nop 0
    buffer_load_dwordx4 v203, s[4:7], s21 offen offset:2048 nt lds
    v_cvt_pk_bf16_f32 v4, v4, v5
    v_cvt_pk_bf16_f32 v5, v6, v7
    v_mfma_f32_16x16x32_bf16 v[76:79], a[148:151], v[172:175], v[76:79]
    ds_write_b64 v217, v[4:5] offset:0
    v_exp_f32 v182, v182
    s_mov_b32 s14, s54
    s_add_u32 m0, s55, 15360
    s_add_u32 s28, s45, 15360
    v_mfma_f32_16x16x32_bf16 v[80:83], a[152:155], v[172:175], v[80:83]
    ds_read_b128 a[108:111], v196 offset:18560
    buffer_load_dwordx4 v207, s[12:15], s28 offen offset:0 nt lds
    v_fma_f32 v184, v164, s25, -v194
    v_cvt_pk_bf16_f32 v8, v8, v9
    v_cvt_pk_bf16_f32 v9, v10, v11
    v_mfma_f32_16x16x32_bf16 v[84:87], a[156:159], v[172:175], v[84:87]
    ds_write_b64 v218, v[8:9] offset:0
    v_exp_f32 v183, v183
    v_mfma_f32_16x16x32_bf16 v[88:91], a[160:163], v[172:175], v[88:91]
    s_add_u32 s20, s20, 1
    v_cvt_pk_bf16_f32 v12, v12, v13
    v_cvt_pk_bf16_f32 v13, v14, v15
    v_mfma_f32_16x16x32_bf16 v[92:95], a[164:167], v[172:175], v[92:95]
    s_waitcnt lgkmcnt(3)
    ds_read_b128 a[112:115], v195 offset:18688
    ds_read_b128 a[116:119], v196 offset:18688
    ds_write_b64 v219, v[12:13] offset:0
    v_pk_mul_f32 v[16:17], v[16:17], v[232:233] op_sel_hi:[1,0]
    v_pk_mul_f32 v[18:19], v[18:19], v[232:233] op_sel_hi:[1,0]
    v_pk_mul_f32 v[20:21], v[20:21], v[232:233] op_sel_hi:[1,0]
    v_pk_mul_f32 v[22:23], v[22:23], v[232:233] op_sel_hi:[1,0]
    v_pk_mul_f32 v[24:25], v[24:25], v[232:233] op_sel_hi:[1,0]
    v_pk_mul_f32 v[26:27], v[26:27], v[232:233] op_sel_hi:[1,0]
    v_pk_mul_f32 v[28:29], v[28:29], v[232:233] op_sel_hi:[1,0]
    v_pk_mul_f32 v[30:31], v[30:31], v[232:233] op_sel_hi:[1,0]
    v_mfma_f32_16x16x32_bf16 v[144:147], a[72:75], a[0:3], 0
    s_nop 0
    buffer_load_dwordx4 v207, s[12:15], s28 offen offset:1024 nt lds
    v_fma_f32 v185, v165, s25, -v194
    v_cvt_pk_bf16_f32 v176, v180, v181
    v_mfma_f32_16x16x32_bf16 v[144:147], a[76:79], a[4:7], v[144:147]
    v_exp_f32 v184, v184
    s_mov_b32 s18, s54
    s_add_u32 s53, s44, 3072
    s_add_u32 s27, s31, 25350144
    v_mfma_f32_16x16x32_bf16 v[144:147], a[80:83], a[8:11], v[144:147]
    s_waitcnt vmcnt(17)
    ds_read_b128 a[24:27], v210 offset:6144
    v_fma_f32 v186, v166, s25, -v194
    v_cvt_pk_bf16_f32 v16, v16, v17
    v_mfma_f32_16x16x32_bf16 v[144:147], a[84:87], a[12:15], v[144:147]
    ds_read_b128 a[28:31], v211 offset:6144
    v_exp_f32 v185, v185
    v_cvt_pk_bf16_f32 v17, v18, v19
    v_mfma_f32_16x16x32_bf16 v[144:147], a[88:91], a[16:19], v[144:147]
    ds_read_b128 a[32:35], v212 offset:6144
    ds_write_b64 v220, v[16:17] offset:0
    buffer_load_dwordx4 v207, s[12:15], s28 offen offset:2048 nt lds
    v_fma_f32 v187, v167, s25, -v194
    v_cvt_pk_bf16_f32 v177, v182, v183
    v_cvt_pk_bf16_f32 v20, v20, v21
    v_cvt_pk_bf16_f32 v21, v22, v23
    v_mfma_f32_16x16x32_bf16 v[144:147], a[92:95], a[20:23], v[144:147]
    ds_read_b128 a[36:39], v213 offset:6144
    ds_write_b64 v221, v[20:21] offset:0
    v_exp_f32 v186, v186
    v_mfma_f32_16x16x32_bf16 v[148:151], a[96:99], a[0:3], 0
    ds_read_b128 a[40:43], v214 offset:6144
    v_exp_f32 v187, v187
    v_cvt_pk_bf16_f32 v24, v24, v25
    v_cvt_pk_bf16_f32 v25, v26, v27
    v_mfma_f32_16x16x32_bf16 v[148:151], a[100:103], a[4:7], v[148:151]
    ds_read_b128 a[44:47], v215 offset:6144
    ds_write_b64 v222, v[24:25] offset:0
    v_cvt_pk_bf16_f32 v178, v184, v185
    v_or3_b32 v188, v176, v177, v178
    v_mfma_f32_16x16x32_bf16 v[148:151], a[104:107], a[8:11], v[148:151]
    s_waitcnt lgkmcnt(8)
    v_cvt_pk_bf16_f32 v179, v186, v187
    v_bitop3_b32 v188, v188, v179, s26 bitop3:0xa8
    v_cvt_pk_bf16_f32 v28, v28, v29
    v_cvt_pk_bf16_f32 v29, v30, v31
    v_mfma_f32_16x16x32_bf16 v[148:151], a[108:111], a[12:15], v[148:151]
    ds_write_b64 v223, v[28:29] offset:0
    v_cmp_ne_u32 vcc, 0, v188
    v_pk_mul_f32 v[32:33], v[32:33], v[232:233] op_sel_hi:[1,0]
    v_pk_mul_f32 v[34:35], v[34:35], v[232:233] op_sel_hi:[1,0]
    v_pk_mul_f32 v[36:37], v[36:37], v[232:233] op_sel_hi:[1,0]
    v_pk_mul_f32 v[38:39], v[38:39], v[232:233] op_sel_hi:[1,0]
    v_pk_mul_f32 v[40:41], v[40:41], v[232:233] op_sel_hi:[1,0]
    v_pk_mul_f32 v[42:43], v[42:43], v[232:233] op_sel_hi:[1,0]
    v_pk_mul_f32 v[44:45], v[44:45], v[232:233] op_sel_hi:[1,0]
    v_pk_mul_f32 v[46:47], v[46:47], v[232:233] op_sel_hi:[1,0]
    v_mfma_f32_16x16x32_bf16 v[148:151], a[112:115], a[16:19], v[148:151]
    v_mfma_f32_16x16x32_bf16 v[148:151], a[116:119], a[20:23], v[148:151]
    s_cbranch_vccnz Z_rare_t162
Z_back_t162:
    v_mfma_f32_16x16x32_bf16 v[240:243], a[216:219], v[176:179], v[240:243]
    v_cvt_pk_bf16_f32 v32, v32, v33
    v_mfma_f32_16x16x32_bf16 v[96:99], a[120:123], v[176:179], v[96:99]
    ds_read_b64_tr_b16 a[120:121], v197 offset:12288
    ds_read_b64_tr_b16 a[122:123], v197 offset:18432
    v_max3_f32 v244, v144, v145, v146
    s_nop 0
    v_max3_f32 v244, v244, v147, v148
    v_cvt_pk_bf16_f32 v33, v34, v35
    v_mfma_f32_16x16x32_bf16 v[100:103], a[124:127], v[176:179], v[100:103]
    ds_write_b64 v224, v[32:33] offset:0
    v_max3_f32 v244, v244, v149, v150
    v_max_f32 v244, v244, v151
    v_cvt_pk_bf16_f32 v36, v36, v37
    v_cvt_pk_bf16_f32 v37, v38, v39
    v_mfma_f32_16x16x32_bf16 v[104:107], a[128:131], v[176:179], v[104:107]
    ds_write_b64 v225, v[36:37] offset:0
    v_mov_b32 v245, v244
    s_nop 1
    v_permlane32_swap_b32 v244, v245
    v_mfma_f32_16x16x32_bf16 v[108:111], a[132:135], v[176:179], v[108:111]
    ds_read_b64_tr_b16 a[124:125], v198 offset:12288
    ds_read_b64_tr_b16 a[126:127], v198 offset:18432
    v_max_f32 v244, v244, v245
    v_cvt_pk_bf16_f32 v40, v40, v41
    v_cvt_pk_bf16_f32 v41, v42, v43
    v_mfma_f32_16x16x32_bf16 v[112:115], a[136:139], v[176:179], v[112:115]
    ds_write_b64 v226, v[40:41] offset:0
    v_mov_b32 v245, v244
    s_nop 1
    v_permlane16_swap_b32 v244, v245
    v_add_u32 v208, s55, v207
    v_mfma_f32_16x16x32_bf16 v[116:119], a[140:143], v[176:179], v[116:119]
    v_max_f32 v244, v244, v245
    v_cvt_pk_bf16_f32 v44, v44, v45
    v_cvt_pk_bf16_f32 v45, v46, v47
    v_mfma_f32_16x16x32_bf16 v[120:123], a[144:147], v[176:179], v[120:123]
    ds_read_b64_tr_b16 a[128:129], v199 offset:12288
    ds_read_b64_tr_b16 a[130:131], v199 offset:18432
    ds_write_b64 v227, v[44:45] offset:0
    v_mul_f32 v192, s25, v244
    v_add_f32 v192, 0x41100000, v192
    v_mfma_f32_16x16x32_bf16 v[124:127], a[148:151], v[176:179], v[124:127]
    v_fma_f32 v180, v144, s25, -v192
    v_fma_f32 v181, v145, s25, -v192
    v_rcp_f32 v236, v236
    s_nop 0
    v_pk_mul_f32 v[48:49], v[48:49], v[236:237] op_sel_hi:[1,0]
    v_pk_mul_f32 v[50:51], v[50:51], v[236:237] op_sel_hi:[1,0]
    v_pk_mul_f32 v[52:53], v[52:53], v[236:237] op_sel_hi:[1,0]
    v_pk_mul_f32 v[54:55], v[54:55], v[236:237] op_sel_hi:[1,0]
    v_pk_mul_f32 v[56:57], v[56:57], v[236:237] op_sel_hi:[1,0]
    v_pk_mul_f32 v[58:59], v[58:59], v[236:237] op_sel_hi:[1,0]
    v_pk_mul_f32 v[60:61], v[60:61], v[236:237] op_sel_hi:[1,0]
    v_pk_mul_f32 v[62:63], v[62:63], v[236:237] op_sel_hi:[1,0]
    v_mfma_f32_16x16x32_bf16 v[128:131], a[152:155], v[176:179], v[128:131]
    v_exp_f32 v180, v180
    v_mfma_f32_16x16x32_bf16 v[132:135], a[156:159], v[176:179], v[132:135]
    ds_read_b64_tr_b16 a[132:133], v200 offset:12288
    ds_read_b64_tr_b16 a[134:135], v200 offset:18432
    v_exp_f32 v181, v181
    v_mfma_f32_16x16x32_bf16 v[136:139], a[160:163], v[176:179], v[136:139]
    ds_read_b128 a[168:171], v208 offset:0
    v_fma_f32 v182, v146, s25, -v192
    v_cvt_pk_bf16_f32 v48, v48, v49
    v_mfma_f32_16x16x32_bf16 v[140:143], a[164:167], v[176:179], v[140:143]
    s_waitcnt lgkmcnt(6)
    ds_read_b128 a[172:175], v208 offset:1024
    v_fma_f32 v183, v147, s25, -v192
    v_exp_f32 v182, v182
    v_cvt_pk_bf16_f32 v49, v50, v51
    v_mfma_f32_16x16x32_bf16 v[152:155], a[72:75], a[24:27], 0
    s_cmp_eq_u32 s20, 13
    ds_read_b64_tr_b16 a[136:137], v197 offset:12416
    ds_read_b64_tr_b16 a[138:139], v197 offset:18560
    ds_write_b64 v216, v[48:49] offset:6144
    ds_read_b128 a[176:179], v208 offset:2048
    v_exp_f32 v183, v183
    v_cvt_pk_bf16_f32 v52, v52, v53
    v_cvt_pk_bf16_f32 v53, v54, v55
    v_mfma_f32_16x16x32_bf16 v[152:155], a[76:79], a[28:31], v[152:155]
    s_cselect_b32 s34, s32, 12288
    ds_write_b64 v217, v[52:53] offset:6144
    v_cvt_pk_bf16_f32 v168, v180, v181
    v_mfma_f32_16x16x32_bf16 v[152:155], a[80:83], a[32:35], v[152:155]
    s_add_u32 s21, s21, s34
    v_fma_f32 v184, v148, s25, -v192
    v_fma_f32 v185, v149, s25, -v192
    v_cvt_pk_bf16_f32 v56, v56, v57
    v_cvt_pk_bf16_f32 v57, v58, v59
    v_mfma_f32_16x16x32_bf16 v[152:155], a[84:87], a[36:39], v[152:155]
    ds_read_b64_tr_b16 a[140:141], v198 offset:12416
    ds_read_b64_tr_b16 a[142:143], v198 offset:18560
    ds_write_b64 v218, v[56:57] offset:6144
    v_exp_f32 v184, v184
    v_mfma_f32_16x16x32_bf16 v[152:155], a[88:91], a[40:43], v[152:155]
    v_cvt_pk_bf16_f32 v169, v182, v183
    v_exp_f32 v185, v185
    v_cvt_pk_bf16_f32 v60, v60, v61
    v_cvt_pk_bf16_f32 v61, v62, v63
    v_add_u32 v208, 3072, v208
    v_mfma_f32_16x16x32_bf16 v[152:155], a[92:95], a[44:47], v[152:155]
    ds_write_b64 v219, v[60:61] offset:6144
    v_fma_f32 v186, v150, s25, -v192
    v_mfma_f32_16x16x32_bf16 v[156:159], a[96:99], a[24:27], 0
    s_waitcnt lgkmcnt(5)
    ds_read_b64_tr_b16 a[144:145], v199 offset:12416
    ds_read_b64_tr_b16 a[146:147], v199 offset:18560
    buffer_store_dwordx4 a[168:171], v209, s[16:19], s44 offen offset:0 nt
    v_fma_f32 v187, v151, s25, -v192
    v_exp_f32 v186, v186
    v_pk_mul_f32 v[64:65], v[64:65], v[236:237] op_sel_hi:[1,0]
    v_pk_mul_f32 v[66:67], v[66:67], v[236:237] op_sel_hi:[1,0]
    v_pk_mul_f32 v[68:69], v[68:69], v[236:237] op_sel_hi:[1,0]
    v_pk_mul_f32 v[70:71], v[70:71], v[236:237] op_sel_hi:[1,0]
    v_pk_mul_f32 v[72:73], v[72:73], v[236:237] op_sel_hi:[1,0]
    v_pk_mul_f32 v[74:75], v[74:75], v[236:237] op_sel_hi:[1,0]
    v_pk_mul_f32 v[76:77], v[76:77], v[236:237] op_sel_hi:[1,0]
    v_pk_mul_f32 v[78:79], v[78:79], v[236:237] op_sel_hi:[1,0]
    v_mfma_f32_16x16x32_bf16 v[156:159], a[100:103], a[28:31], v[156:159]
    v_cvt_pk_bf16_f32 v170, v184, v185
    v_mfma_f32_16x16x32_bf16 v[156:159], a[104:107], a[32:35], v[156:159]
    ds_read_b64_tr_b16 a[148:149], v200 offset:12416
    ds_read_b64_tr_b16 a[150:151], v200 offset:18560
    v_exp_f32 v187, v187
    v_mfma_f32_16x16x32_bf16 v[156:159], a[108:111], a[36:39], v[156:159]
    v_cvt_pk_bf16_f32 v171, v186, v187
    v_cvt_pk_bf16_f32 v64, v64, v65
    v_cvt_pk_bf16_f32 v65, v66, v67
    v_mfma_f32_16x16x32_bf16 v[156:159], a[112:115], a[40:43], v[156:159]
    ds_read_b64_tr_b16 a[152:153], v197 offset:12544
    ds_read_b64_tr_b16 a[154:155], v197 offset:18688
    ds_write_b64 v220, v[64:65] offset:6144
    v_mfma_f32_16x16x32_bf16 v[156:159], a[116:119], a[44:47], v[156:159]
    s_nop 0
    buffer_store_dwordx4 a[172:175], v209, s[16:19], s44 offen offset:1024 nt
    v_cvt_pk_bf16_f32 v68, v68, v69
    v_cvt_pk_bf16_f32 v69, v70, v71
    v_mfma_f32_16x16x32_bf16 v[232:235], a[216:219], v[168:171], 0
    ds_read_b64_tr_b16 a[156:157], v198 offset:12544
    ds_read_b64_tr_b16 a[158:159], v198 offset:18688
    ds_write_b64 v221, v[68:69] offset:6144
    v_cvt_pk_bf16_f32 v72, v72, v73
    v_mfma_f32_16x16x32_bf16 v[0:3], a[120:123], v[168:171], 0
    v_max3_f32 v244, v152, v153, v154
    v_max3_f32 v244, v244, v155, v156
    v_cvt_pk_bf16_f32 v73, v74, v75
    v_mfma_f32_16x16x32_bf16 v[4:7], a[124:127], v[168:171], 0
    ds_read_b64_tr_b16 a[160:161], v199 offset:12544
    ds_read_b64_tr_b16 a[162:163], v199 offset:18688
    ds_write_b64 v222, v[72:73] offset:6144
    v_max3_f32 v244, v244, v157, v158
    v_max_f32 v244, v244, v159
    v_cvt_pk_bf16_f32 v76, v76, v77
    v_mfma_f32_16x16x32_bf16 v[8:11], a[128:131], v[168:171], 0
    v_mov_b32 v245, v244
    s_nop 1
    v_permlane32_swap_b32 v244, v245
    v_cvt_pk_bf16_f32 v77, v78, v79
    v_mfma_f32_16x16x32_bf16 v[12:15], a[132:135], v[168:171], 0
    s_waitcnt lgkmcnt(6)
    ds_read_b64_tr_b16 a[164:165], v200 offset:12544
    ds_read_b64_tr_b16 a[166:167], v200 offset:18688
    ds_write_b64 v223, v[76:77] offset:6144
    buffer_store_dwordx4 a[176:179], v209, s[16:19], s44 offen offset:2048 nt
    v_max_f32 v244, v244, v245
    v_pk_mul_f32 v[80:81], v[80:81], v[236:237] op_sel_hi:[1,0]
    v_pk_mul_f32 v[82:83], v[82:83], v[236:237] op_sel_hi:[1,0]
    v_pk_mul_f32 v[84:85], v[84:85], v[236:237] op_sel_hi:[1,0]
    v_pk_mul_f32 v[86:87], v[86:87], v[236:237] op_sel_hi:[1,0]
    v_pk_mul_f32 v[88:89], v[88:89], v[236:237] op_sel_hi:[1,0]
    v_pk_mul_f32 v[90:91], v[90:91], v[236:237] op_sel_hi:[1,0]
    v_pk_mul_f32 v[92:93], v[92:93], v[236:237] op_sel_hi:[1,0]
    v_pk_mul_f32 v[94:95], v[94:95], v[236:237] op_sel_hi:[1,0]
    v_mfma_f32_16x16x32_bf16 v[16:19], a[136:139], v[168:171], 0
    s_waitcnt vmcnt(3)
    s_add_u32 m0, s30, 12288
    ds_read_b128 a[48:51], v210 offset:12288
    v_mov_b32 v245, v244
    s_nop 1
    v_permlane16_swap_b32 v244, v245
    v_mfma_f32_16x16x32_bf16 v[20:23], a[140:143], v[168:171], 0
    ds_read_b128 a[52:55], v211 offset:12288
    v_max_f32 v244, v244, v245
    v_mfma_f32_16x16x32_bf16 v[24:27], a[144:147], v[168:171], 0
    ds_read_b128 a[56:59], v212 offset:12288
    v_mul_f32 v193, s25, v244
    v_add_f32 v193, 0x41100000, v193
    v_cvt_pk_bf16_f32 v80, v80, v81
    v_cvt_pk_bf16_f32 v81, v82, v83
    v_mfma_f32_16x16x32_bf16 v[28:31], a[148:151], v[168:171], 0
    ds_read_b128 a[60:63], v213 offset:12288
    ds_write_b64 v224, v[80:81] offset:6144
    v_fma_f32 v180, v152, s25, -v193
    v_fma_f32 v181, v153, s25, -v193
    v_mfma_f32_16x16x32_bf16 v[32:35], a[152:155], v[168:171], 0
    s_waitcnt lgkmcnt(8)
    ds_read_b128 a[64:67], v214 offset:12288
    v_exp_f32 v180, v180
    v_cvt_pk_bf16_f32 v84, v84, v85
    v_cvt_pk_bf16_f32 v85, v86, v87
    v_mfma_f32_16x16x32_bf16 v[36:39], a[156:159], v[168:171], 0
    s_waitcnt vmcnt(14) lgkmcnt(0)
    ds_read_b128 a[68:71], v215 offset:12288
    ds_write_b64 v225, v[84:85] offset:6144
    v_exp_f32 v181, v181
    v_mfma_f32_16x16x32_bf16 v[40:43], a[160:163], v[168:171], 0
    s_barrier
    v_fma_f32 v182, v154, s25, -v193
    v_cvt_pk_bf16_f32 v88, v88, v89
    v_cvt_pk_bf16_f32 v89, v90, v91
    v_mfma_f32_16x16x32_bf16 v[44:47], a[164:167], v[168:171], 0
    s_nop 0
    buffer_load_dwordx4 v204, s[8:11], s21 offen offset:0 nt lds
    ds_write_b64 v226, v[88:89] offset:6144
    v_fma_f32 v183, v155, s25, -v193
    v_exp_f32 v182, v182
    v_mfma_f32_16x16x32_bf16 v[160:163], a[72:75], a[48:51], 0
    v_exp_f32 v183, v183
    v_cvt_pk_bf16_f32 v92, v92, v93
    v_cvt_pk_bf16_f32 v93, v94, v95
    v_mfma_f32_16x16x32_bf16 v[160:163], a[76:79], a[52:55], v[160:163]
    ds_read_b128 a[72:75], v195 offset:24576
    ds_write_b64 v227, v[92:93] offset:6144
    v_cvt_pk_bf16_f32 v172, v180, v181
    v_mfma_f32_16x16x32_bf16 v[160:163], a[80:83], a[56:59], v[160:163]
    v_fma_f32 v184, v156, s25, -v193
    v_fma_f32 v185, v157, s25, -v193
    v_rcp_f32 v240, v240
    s_nop 0
    v_pk_mul_f32 v[96:97], v[96:97], v[240:241] op_sel_hi:[1,0]
    v_pk_mul_f32 v[98:99], v[98:99], v[240:241] op_sel_hi:[1,0]
    v_pk_mul_f32 v[100:101], v[100:101], v[240:241] op_sel_hi:[1,0]
    v_pk_mul_f32 v[102:103], v[102:103], v[240:241] op_sel_hi:[1,0]
    v_pk_mul_f32 v[104:105], v[104:105], v[240:241] op_sel_hi:[1,0]
    v_pk_mul_f32 v[106:107], v[106:107], v[240:241] op_sel_hi:[1,0]
    v_pk_mul_f32 v[108:109], v[108:109], v[240:241] op_sel_hi:[1,0]
    v_pk_mul_f32 v[110:111], v[110:111], v[240:241] op_sel_hi:[1,0]
    v_mfma_f32_16x16x32_bf16 v[160:163], a[84:87], a[60:63], v[160:163]
    s_nop 0
    buffer_load_dwordx4 v205, s[8:11], s21 offen offset:1024 nt lds
    v_exp_f32 v184, v184
    v_mfma_f32_16x16x32_bf16 v[160:163], a[88:91], a[64:67], v[160:163]
    s_waitcnt lgkmcnt(3)
    v_cvt_pk_bf16_f32 v173, v182, v183
    v_exp_f32 v185, v185
    v_mfma_f32_16x16x32_bf16 v[160:163], a[92:95], a[68:71], v[160:163]
    ds_read_b128 a[76:79], v196 offset:24576
    v_fma_f32 v186, v158, s25, -v193
    v_cvt_pk_bf16_f32 v96, v96, v97
    v_cvt_pk_bf16_f32 v97, v98, v99
    v_mfma_f32_16x16x32_bf16 v[164:167], a[96:99], a[48:51], 0
    ds_read_b128 a[80:83], v195 offset:24704
    ds_write_b64 v216, v[96:97] offset:12288
    v_fma_f32 v187, v159, s25, -v193
    v_exp_f32 v186, v186
    v_mfma_f32_16x16x32_bf16 v[164:167], a[100:103], a[52:55], v[164:167]
    s_nop 0
    buffer_load_dwordx4 v206, s[8:11], s21 offen offset:2048 nt lds
    v_cvt_pk_bf16_f32 v174, v184, v185
    v_cvt_pk_bf16_f32 v100, v100, v101
    v_cvt_pk_bf16_f32 v101, v102, v103
    v_mfma_f32_16x16x32_bf16 v[164:167], a[104:107], a[56:59], v[164:167]
    s_add_u32 m0, s30, 49152
    ds_write_b64 v217, v[100:101] offset:12288
    v_exp_f32 v187, v187
    v_mfma_f32_16x16x32_bf16 v[164:167], a[108:111], a[60:63], v[164:167]
    v_cvt_pk_bf16_f32 v175, v186, v187
    v_cvt_pk_bf16_f32 v104, v104, v105
    v_cvt_pk_bf16_f32 v105, v106, v107
    v_mfma_f32_16x16x32_bf16 v[164:167], a[112:115], a[64:67], v[164:167]
    ds_read_b128 a[84:87], v196 offset:24704
    ds_read_b128 a[88:91], v195 offset:24832
    ds_write_b64 v218, v[104:105] offset:12288
    v_mfma_f32_16x16x32_bf16 v[164:167], a[116:119], a[68:71], v[164:167]
    s_nop 0
    buffer_load_dwordx4 v201, s[4:7], s21 offen offset:0 nt lds
    v_cvt_pk_bf16_f32 v108, v108, v109
    v_cvt_pk_bf16_f32 v109, v110, v111
    v_mfma_f32_16x16x32_bf16 v[236:239], a[216:219], v[172:175], 0
    ds_read_b128 a[92:95], v196 offset:24832
    ds_write_b64 v219, v[108:109] offset:12288
    v_pk_mul_f32 v[112:113], v[112:113], v[240:241] op_sel_hi:[1,0]
    v_pk_mul_f32 v[114:115], v[114:115], v[240:241] op_sel_hi:[1,0]
    v_pk_mul_f32 v[116:117], v[116:117], v[240:241] op_sel_hi:[1,0]
    v_pk_mul_f32 v[118:119], v[118:119], v[240:241] op_sel_hi:[1,0]
    v_pk_mul_f32 v[120:121], v[120:121], v[240:241] op_sel_hi:[1,0]
    v_pk_mul_f32 v[122:123], v[122:123], v[240:241] op_sel_hi:[1,0]
    v_pk_mul_f32 v[124:125], v[124:125], v[240:241] op_sel_hi:[1,0]
    v_pk_mul_f32 v[126:127], v[126:127], v[240:241] op_sel_hi:[1,0]
    v_mfma_f32_16x16x32_bf16 v[48:51], a[120:123], v[172:175], 0
    ds_read_b128 a[96:99], v195 offset:30720
    v_max3_f32 v244, v160, v161, v162
    v_max3_f32 v244, v244, v163, v164
    v_mfma_f32_16x16x32_bf16 v[52:55], a[124:127], v[172:175], 0
    v_max3_f32 v244, v244, v165, v166
    v_max_f32 v244, v244, v167
    v_mfma_f32_16x16x32_bf16 v[56:59], a[128:131], v[172:175], 0
    s_nop 0
    buffer_load_dwordx4 v202, s[4:7], s21 offen offset:1024 nt lds
    v_mov_b32 v245, v244
    s_nop 1
    v_permlane32_swap_b32 v244, v245
    v_cvt_pk_bf16_f32 v112, v112, v113
    v_mfma_f32_16x16x32_bf16 v[60:63], a[132:135], v[172:175], 0
    ds_read_b128 a[100:103], v196 offset:30720
    v_max_f32 v244, v244, v245
    v_cvt_pk_bf16_f32 v113, v114, v115
    v_mfma_f32_16x16x32_bf16 v[64:67], a[136:139], v[172:175], 0
    ds_write_b64 v220, v[112:113] offset:12288
    v_mov_b32 v245, v244
    s_nop 1
    v_permlane16_swap_b32 v244, v245
    v_cvt_pk_bf16_f32 v116, v116, v117
    v_cvt_pk_bf16_f32 v117, v118, v119
    v_mfma_f32_16x16x32_bf16 v[68:71], a[140:143], v[172:175], 0
    ds_read_b128 a[104:107], v195 offset:30848
    ds_write_b64 v221, v[116:117] offset:12288
    v_max_f32 v244, v244, v245
    v_mfma_f32_16x16x32_bf16 v[72:75], a[144:147], v[172:175], 0
    s_nop 0
    buffer_load_dwordx4 v203, s[4:7], s21 offen offset:2048 nt lds
    v_mul_f32 v194, s25, v244
    v_add_f32 v194, 0x41100000, v194
    v_cvt_pk_bf16_f32 v120, v120, v121
    v_cvt_pk_bf16_f32 v121, v122, v123
    v_mfma_f32_16x16x32_bf16 v[76:79], a[148:151], v[172:175], 0
    ds_write_b64 v222, v[120:121] offset:12288
    v_fma_f32 v180, v160, s25, -v194
    v_fma_f32 v181, v161, s25, -v194
    v_mfma_f32_16x16x32_bf16 v[80:83], a[152:155], v[172:175], 0
    ds_read_b128 a[108:111], v196 offset:30848
    v_exp_f32 v180, v180
    v_cvt_pk_bf16_f32 v124, v124, v125
    v_cvt_pk_bf16_f32 v125, v126, v127
    s_add_u32 m0, s30, 148480
    v_mfma_f32_16x16x32_bf16 v[84:87], a[156:159], v[172:175], 0
    ds_write_b64 v223, v[124:125] offset:12288
    v_exp_f32 v181, v181
    v_pk_mul_f32 v[128:129], v[128:129], v[240:241] op_sel_hi:[1,0]
    v_pk_mul_f32 v[130:131], v[130:131], v[240:241] op_sel_hi:[1,0]
    v_pk_mul_f32 v[132:133], v[132:133], v[240:241] op_sel_hi:[1,0]
    v_pk_mul_f32 v[134:135], v[134:135], v[240:241] op_sel_hi:[1,0]
    v_pk_mul_f32 v[136:137], v[136:137], v[240:241] op_sel_hi:[1,0]
    v_pk_mul_f32 v[138:139], v[138:139], v[240:241] op_sel_hi:[1,0]
    v_pk_mul_f32 v[140:141], v[140:141], v[240:241] op_sel_hi:[1,0]
    v_pk_mul_f32 v[142:143], v[142:143], v[240:241] op_sel_hi:[1,0]
    v_mfma_f32_16x16x32_bf16 v[88:91], a[160:163], v[172:175], 0
    s_add_u32 s20, s20, 1
    buffer_load_dwordx4 v201, s[4:7], s27 offen offset:0 nt lds
    v_fma_f32 v182, v162, s25, -v194
    v_mfma_f32_16x16x32_bf16 v[92:95], a[164:167], v[172:175], 0
    s_waitcnt lgkmcnt(3)
    ds_read_b128 a[112:115], v195 offset:30976
    ds_read_b128 a[116:119], v196 offset:30976
    v_fma_f32 v183, v163, s25, -v194
    v_exp_f32 v182, v182
    v_mfma_f32_16x16x32_bf16 v[144:147], a[72:75], a[0:3], 0
    s_bitcmp1_b32 s37, s20
    v_exp_f32 v183, v183
    v_cvt_pk_bf16_f32 v128, v128, v129
    v_mfma_f32_16x16x32_bf16 v[144:147], a[76:79], a[4:7], v[144:147]
    s_cselect_b32 s18, s54, 0
    v_cvt_pk_bf16_f32 v176, v180, v181
    v_cvt_pk_bf16_f32 v129, v130, v131
    v_mfma_f32_16x16x32_bf16 v[144:147], a[80:83], a[8:11], v[144:147]
    s_cselect_b32 s63, 1024, 0
    ds_read_b128 v[228:231], v208 offset:0
    ds_write_b64 v224, v[128:129] offset:12288
    buffer_load_dwordx4 v202, s[4:7], s27 offen offset:1024 nt lds
    v_fma_f32 v184, v164, s25, -v194
    v_fma_f32 v185, v165, s25, -v194
    v_cvt_pk_bf16_f32 v132, v132, v133
    v_cvt_pk_bf16_f32 v133, v134, v135
    v_mfma_f32_16x16x32_bf16 v[144:147], a[84:87], a[12:15], v[144:147]
    ds_write_b64 v225, v[132:133] offset:12288
    v_exp_f32 v184, v184
    v_mfma_f32_16x16x32_bf16 v[144:147], a[88:91], a[16:19], v[144:147]
    v_cvt_pk_bf16_f32 v177, v182, v183
    v_exp_f32 v185, v185
    v_cvt_pk_bf16_f32 v136, v136, v137
    v_cvt_pk_bf16_f32 v137, v138, v139
    v_mfma_f32_16x16x32_bf16 v[144:147], a[92:95], a[20:23], v[144:147]
    ds_write_b64 v226, v[136:137] offset:12288
    v_fma_f32 v186, v166, s25, -v194
    v_mfma_f32_16x16x32_bf16 v[148:151], a[96:99], a[0:3], 0
    s_nop 0
    buffer_load_dwordx4 v203, s[4:7], s27 offen offset:2048 nt lds
    v_fma_f32 v187, v167, s25, -v194
    v_exp_f32 v186, v186
    v_cvt_pk_bf16_f32 v140, v140, v141
    v_cvt_pk_bf16_f32 v141, v142, v143
    v_mfma_f32_16x16x32_bf16 v[148:151], a[100:103], a[4:7], v[148:151]
    ds_write_b64 v227, v[140:141] offset:12288
    v_cvt_pk_bf16_f32 v178, v184, v185
    v_mfma_f32_16x16x32_bf16 v[148:151], a[104:107], a[8:11], v[148:151]
    s_waitcnt lgkmcnt(3)
    v_exp_f32 v187, v187
    v_mfma_f32_16x16x32_bf16 v[148:151], a[108:111], a[12:15], v[148:151]
    v_cvt_pk_bf16_f32 v179, v186, v187
    v_mfma_f32_16x16x32_bf16 v[148:151], a[112:115], a[16:19], v[148:151]
    s_nop 0
    buffer_store_dwordx4 v[228:231], v209, s[16:19], s53 offen offset:0 nt
    v_mfma_f32_16x16x32_bf16 v[148:151], a[116:119], a[20:23], v[148:151]
    v_fma_f32 v180, v144, s25, -v192
    v_mfma_f32_16x16x32_bf16 v[240:243], a[216:219], v[176:179], 0
    s_add_u32 s53, s53, s63
    v_fma_f32 v181, v145, s25, -v192
    v_fma_f32 v182, v146, s25, -v192
    v_mfma_f32_16x16x32_bf16 v[96:99], a[120:123], v[176:179], 0
    ds_read_b64_tr_b16 a[120:121], v197 offset:24576
    ds_read_b64_tr_b16 a[122:123], v197 offset:30720
    v_mfma_f32_16x16x32_bf16 v[100:103], a[124:127], v[176:179], 0
    v_exp_f32 v180, v180
    v_mfma_f32_16x16x32_bf16 v[104:107], a[128:131], v[176:179], 0
    v_exp_f32 v181, v181
    v_mfma_f32_16x16x32_bf16 v[108:111], a[132:135], v[176:179], 0
    ds_read_b64_tr_b16 a[124:125], v198 offset:24576
    ds_read_b64_tr_b16 a[126:127], v198 offset:30720
    v_mfma_f32_16x16x32_bf16 v[112:115], a[136:139], v[176:179], 0
    v_fma_f32 v183, v147, s25, -v192
    v_fma_f32 v184, v148, s25, -v192
    v_mfma_f32_16x16x32_bf16 v[116:119], a[140:143], v[176:179], 0
    v_exp_f32 v182, v182
    v_mfma_f32_16x16x32_bf16 v[120:123], a[144:147], v[176:179], 0
    ds_read_b64_tr_b16 a[128:129], v199 offset:24576
    ds_read_b64_tr_b16 a[130:131], v199 offset:30720
    v_mfma_f32_16x16x32_bf16 v[124:127], a[148:151], v[176:179], 0
    v_exp_f32 v183, v183
    v_mfma_f32_16x16x32_bf16 v[128:131], a[152:155], v[176:179], 0
    v_fma_f32 v185, v149, s25, -v192
    v_cvt_pk_bf16_f32 v168, v180, v181
    v_mfma_f32_16x16x32_bf16 v[132:135], a[156:159], v[176:179], 0
    ds_read_b64_tr_b16 a[132:133], v200 offset:24576
    ds_read_b64_tr_b16 a[134:135], v200 offset:30720
    v_mfma_f32_16x16x32_bf16 v[136:139], a[160:163], v[176:179], 0
    v_exp_f32 v184, v184
    v_mfma_f32_16x16x32_bf16 v[140:143], a[164:167], v[176:179], 0
    v_fma_f32 v186, v150, s25, -v192
    v_cvt_pk_bf16_f32 v169, v182, v183
    s_branch Z_mid0
.p2align 6
Z_lp2_0:
    v_mfma_f32_16x16x32_bf16 v[240:243], a[216:219], v[176:179], v[240:243]
    s_add_u32 s53, s53, s63
    v_fma_f32 v181, v145, s25, -v192
    v_fma_f32 v182, v146, s25, -v192
    v_mfma_f32_16x16x32_bf16 v[96:99], a[120:123], v[176:179], v[96:99]
    ds_read_b64_tr_b16 a[120:121], v197 offset:0
    ds_read_b64_tr_b16 a[122:123], v197 offset:6144
    v_mfma_f32_16x16x32_bf16 v[100:103], a[124:127], v[176:179], v[100:103]
    v_exp_f32 v180, v180
    v_mfma_f32_16x16x32_bf16 v[104:107], a[128:131], v[176:179], v[104:107]
    v_exp_f32 v181, v181
    v_mfma_f32_16x16x32_bf16 v[108:111], a[132:135], v[176:179], v[108:111]
    ds_read_b64_tr_b16 a[124:125], v198 offset:0
    ds_read_b64_tr_b16 a[126:127], v198 offset:6144
    v_mfma_f32_16x16x32_bf16 v[112:115], a[136:139], v[176:179], v[112:115]
    v_fma_f32 v183, v147, s25, -v192
    v_fma_f32 v184, v148, s25, -v192
    v_mfma_f32_16x16x32_bf16 v[116:119], a[140:143], v[176:179], v[116:119]
    v_exp_f32 v182, v182
    v_mfma_f32_16x16x32_bf16 v[120:123], a[144:147], v[176:179], v[120:123]
    ds_read_b64_tr_b16 a[128:129], v199 offset:0
    ds_read_b64_tr_b16 a[130:131], v199 offset:6144
    v_mfma_f32_16x16x32_bf16 v[124:127], a[148:151], v[176:179], v[124:127]
    v_exp_f32 v183, v183
    v_mfma_f32_16x16x32_bf16 v[128:131], a[152:155], v[176:179], v[128:131]
    v_fma_f32 v185, v149, s25, -v192
    v_cvt_pk_bf16_f32 v168, v180, v181
    v_mfma_f32_16x16x32_bf16 v[132:135], a[156:159], v[176:179], v[132:135]
    ds_read_b64_tr_b16 a[132:133], v200 offset:0
    ds_read_b64_tr_b16 a[134:135], v200 offset:6144
    v_mfma_f32_16x16x32_bf16 v[136:139], a[160:163], v[176:179], v[136:139]
    v_exp_f32 v184, v184
    v_mfma_f32_16x16x32_bf16 v[140:143], a[164:167], v[176:179], v[140:143]
    v_fma_f32 v186, v150, s25, -v192
    v_cvt_pk_bf16_f32 v169, v182, v183
    v_mfma_f32_16x16x32_bf16 v[152:155], a[72:75], a[24:27], 0
    s_add_u32 s21, s21, 12288
    ds_read_b64_tr_b16 a[136:137], v197 offset:128
    ds_read_b64_tr_b16 a[138:139], v197 offset:6272
    v_mfma_f32_16x16x32_bf16 v[152:155], a[76:79], a[28:31], v[152:155]
    s_cmp_lt_u32 s20, 29
    v_exp_f32 v185, v185
    v_mfma_f32_16x16x32_bf16 v[152:155], a[80:83], a[32:35], v[152:155]
    s_cselect_b32 s10, s49, 0
    v_exp_f32 v186, v186
    v_mfma_f32_16x16x32_bf16 v[152:155], a[84:87], a[36:39], v[152:155]
    s_cmp_lt_u32 s20, 28
    ds_read_b64_tr_b16 a[140:141], v198 offset:128
    ds_read_b64_tr_b16 a[142:143], v198 offset:6272
    v_mfma_f32_16x16x32_bf16 v[152:155], a[88:91], a[40:43], v[152:155]
    s_cselect_b32 s6, s49, 0
    v_fma_f32 v187, v151, s25, -v192
    v_cvt_pk_bf16_f32 v170, v184, v185
    v_mfma_f32_16x16x32_bf16 v[152:155], a[92:95], a[44:47], v[152:155]
    v_exp_f32 v187, v187
    v_mfma_f32_16x16x32_bf16 v[156:159], a[96:99], a[24:27], 0
    ds_read_b64_tr_b16 a[144:145], v199 offset:128
    ds_read_b64_tr_b16 a[146:147], v199 offset:6272
    v_mfma_f32_16x16x32_bf16 v[156:159], a[100:103], a[28:31], v[156:159]
    v_or3_b32 v188, v168, v169, v170
    v_cvt_pk_bf16_f32 v171, v186, v187
    v_mfma_f32_16x16x32_bf16 v[156:159], a[104:107], a[32:35], v[156:159]
    ds_read_b64_tr_b16 a[148:149], v200 offset:128
    ds_read_b64_tr_b16 a[150:151], v200 offset:6272
    v_mfma_f32_16x16x32_bf16 v[156:159], a[108:111], a[36:39], v[156:159]
    v_bitop3_b32 v188, v188, v171, s26 bitop3:0xa8
    v_cmp_ne_u32 vcc, 0, v188
    v_mfma_f32_16x16x32_bf16 v[156:159], a[112:115], a[40:43], v[156:159]
    ds_read_b64_tr_b16 a[152:153], v197 offset:256
    ds_read_b64_tr_b16 a[154:155], v197 offset:6400
    v_mfma_f32_16x16x32_bf16 v[156:159], a[116:119], a[44:47], v[156:159]
    s_cbranch_vccnz Z_rare_m0a0
Z_back_m0a0:
    v_add_u32 v208, s63, v208
    v_mfma_f32_16x16x32_bf16 v[232:235], a[216:219], v[168:171], v[232:235]
    s_waitcnt lgkmcnt(4)
    ds_read_b64_tr_b16 a[156:157], v198 offset:256
    ds_read_b64_tr_b16 a[158:159], v198 offset:6400
    v_mfma_f32_16x16x32_bf16 v[0:3], a[120:123], v[168:171], v[0:3]
    v_fma_f32 v180, v152, s25, -v193
    v_fma_f32 v181, v153, s25, -v193
    v_mfma_f32_16x16x32_bf16 v[4:7], a[124:127], v[168:171], v[4:7]
    ds_read_b64_tr_b16 a[160:161], v199 offset:256
    ds_read_b64_tr_b16 a[162:163], v199 offset:6400
    v_mfma_f32_16x16x32_bf16 v[8:11], a[128:131], v[168:171], v[8:11]
    v_exp_f32 v180, v180
    v_mfma_f32_16x16x32_bf16 v[12:15], a[132:135], v[168:171], v[12:15]
    ds_read_b64_tr_b16 a[164:165], v200 offset:256
    ds_read_b64_tr_b16 a[166:167], v200 offset:6400
    v_mfma_f32_16x16x32_bf16 v[16:19], a[136:139], v[168:171], v[16:19]
    s_add_u32 m0, s30, 0
    v_fma_f32 v182, v154, s25, -v193
    v_fma_f32 v183, v155, s25, -v193
    v_mfma_f32_16x16x32_bf16 v[20:23], a[140:143], v[168:171], v[20:23]
    v_exp_f32 v181, v181
    v_mfma_f32_16x16x32_bf16 v[24:27], a[144:147], v[168:171], v[24:27]
    s_waitcnt lgkmcnt(4)
    v_exp_f32 v182, v182
    v_mfma_f32_16x16x32_bf16 v[28:31], a[148:151], v[168:171], v[28:31]
    v_fma_f32 v184, v156, s25, -v193
    v_cvt_pk_bf16_f32 v172, v180, v181
    v_mfma_f32_16x16x32_bf16 v[32:35], a[152:155], v[168:171], v[32:35]
    v_exp_f32 v183, v183
    v_mfma_f32_16x16x32_bf16 v[36:39], a[156:159], v[168:171], v[36:39]
    s_waitcnt vmcnt(8) lgkmcnt(0)
    v_fma_f32 v185, v157, s25, -v193
    v_fma_f32 v186, v158, s25, -v193
    v_mfma_f32_16x16x32_bf16 v[40:43], a[160:163], v[168:171], v[40:43]
    s_barrier
    v_mfma_f32_16x16x32_bf16 v[44:47], a[164:167], v[168:171], v[44:47]
    v_exp_f32 v184, v184
    v_mfma_f32_16x16x32_bf16 v[160:163], a[72:75], a[48:51], 0
    s_nop 0
    buffer_load_dwordx4 v204, s[8:11], s21 offen offset:0 nt lds
    v_mfma_f32_16x16x32_bf16 v[160:163], a[76:79], a[52:55], v[160:163]
    v_exp_f32 v185, v185
    v_mfma_f32_16x16x32_bf16 v[160:163], a[80:83], a[56:59], v[160:163]
    ds_read_b128 a[72:75], v195 offset:12288
    v_fma_f32 v187, v159, s25, -v193
    v_mfma_f32_16x16x32_bf16 v[160:163], a[84:87], a[60:63], v[160:163]
    v_exp_f32 v186, v186
    v_mfma_f32_16x16x32_bf16 v[160:163], a[88:91], a[64:67], v[160:163]
    s_nop 0
    buffer_load_dwordx4 v205, s[8:11], s21 offen offset:1024 nt lds
    v_mfma_f32_16x16x32_bf16 v[160:163], a[92:95], a[68:71], v[160:163]
    v_exp_f32 v187, v187
    v_mfma_f32_16x16x32_bf16 v[164:167], a[96:99], a[48:51], 0
    ds_read_b128 a[76:79], v196 offset:12288
    v_cvt_pk_bf16_f32 v173, v182, v183
    v_mfma_f32_16x16x32_bf16 v[164:167], a[100:103], a[52:55], v[164:167]
    ds_read_b128 a[80:83], v195 offset:12416
    v_cvt_pk_bf16_f32 v174, v184, v185
    v_mfma_f32_16x16x32_bf16 v[164:167], a[104:107], a[56:59], v[164:167]
    v_or3_b32 v188, v172, v173, v174
    v_cvt_pk_bf16_f32 v175, v186, v187
    v_mfma_f32_16x16x32_bf16 v[164:167], a[108:111], a[60:63], v[164:167]
    v_bitop3_b32 v188, v188, v175, s26 bitop3:0xa8
    v_cmp_ne_u32 vcc, 0, v188
    v_mfma_f32_16x16x32_bf16 v[164:167], a[112:115], a[64:67], v[164:167]
    s_nop 0
    buffer_load_dwordx4 v206, s[8:11], s21 offen offset:2048 nt lds
    v_mfma_f32_16x16x32_bf16 v[164:167], a[116:119], a[68:71], v[164:167]
    s_cbranch_vccnz Z_rare_m0a1
Z_back_m0a1:
    ds_read_b128 a[84:87], v196 offset:12416
    ds_read_b128 a[88:91], v195 offset:12544
    v_mfma_f32_16x16x32_bf16 v[236:239], a[216:219], v[172:175], v[236:239]
    s_add_u32 m0, s30, 36864
    ds_read_b128 a[92:95], v196 offset:12544
    v_fma_f32 v180, v160, s25, -v194
    v_mfma_f32_16x16x32_bf16 v[48:51], a[120:123], v[172:175], v[48:51]
    ds_read_b128 a[96:99], v195 offset:18432
    v_fma_f32 v181, v161, s25, -v194
    v_mfma_f32_16x16x32_bf16 v[52:55], a[124:127], v[172:175], v[52:55]
    v_exp_f32 v180, v180
    v_mfma_f32_16x16x32_bf16 v[56:59], a[128:131], v[172:175], v[56:59]
    s_nop 0
    buffer_load_dwordx4 v201, s[4:7], s21 offen offset:0 nt lds
    v_mfma_f32_16x16x32_bf16 v[60:63], a[132:135], v[172:175], v[60:63]
    ds_read_b128 a[100:103], v196 offset:18432
    v_fma_f32 v182, v162, s25, -v194
    v_mfma_f32_16x16x32_bf16 v[64:67], a[136:139], v[172:175], v[64:67]
    v_exp_f32 v181, v181
    v_mfma_f32_16x16x32_bf16 v[68:71], a[140:143], v[172:175], v[68:71]
    ds_read_b128 a[104:107], v195 offset:18560
    v_fma_f32 v183, v163, s25, -v194
    v_mfma_f32_16x16x32_bf16 v[72:75], a[144:147], v[172:175], v[72:75]
    s_nop 0
    buffer_load_dwordx4 v202, s[4:7], s21 offen offset:1024 nt lds
    v_mfma_f32_16x16x32_bf16 v[76:79], a[148:151], v[172:175], v[76:79]
    v_exp_f32 v182, v182
    v_mfma_f32_16x16x32_bf16 v[80:83], a[152:155], v[172:175], v[80:83]
    ds_read_b128 a[108:111], v196 offset:18560
    v_fma_f32 v184, v164, s25, -v194
    v_mfma_f32_16x16x32_bf16 v[84:87], a[156:159], v[172:175], v[84:87]
    v_exp_f32 v183, v183
    v_mfma_f32_16x16x32_bf16 v[88:91], a[160:163], v[172:175], v[88:91]
    s_add_u32 s20, s20, 1
    buffer_load_dwordx4 v203, s[4:7], s21 offen offset:2048 nt lds
    v_mfma_f32_16x16x32_bf16 v[92:95], a[164:167], v[172:175], v[92:95]
    s_waitcnt lgkmcnt(1)
    ds_read_b128 a[112:115], v195 offset:18688
    ds_read_b128 a[116:119], v196 offset:18688
    v_mfma_f32_16x16x32_bf16 v[144:147], a[72:75], a[0:3], 0
    s_bitcmp1_b32 s37, s20
    v_fma_f32 v185, v165, s25, -v194
    v_cvt_pk_bf16_f32 v176, v180, v181
    v_mfma_f32_16x16x32_bf16 v[144:147], a[76:79], a[4:7], v[144:147]
    s_cselect_b32 s18, s54, 0
    v_exp_f32 v184, v184
    v_mfma_f32_16x16x32_bf16 v[144:147], a[80:83], a[8:11], v[144:147]
    s_cselect_b32 s63, 1024, 0
    ds_read_b128 v[228:231], v208 offset:0
    v_fma_f32 v186, v166, s25, -v194
    v_mfma_f32_16x16x32_bf16 v[144:147], a[84:87], a[12:15], v[144:147]
    v_exp_f32 v185, v185
    v_mfma_f32_16x16x32_bf16 v[144:147], a[88:91], a[16:19], v[144:147]
    v_fma_f32 v187, v167, s25, -v194
    v_cvt_pk_bf16_f32 v177, v182, v183
    v_mfma_f32_16x16x32_bf16 v[144:147], a[92:95], a[20:23], v[144:147]
    v_exp_f32 v186, v186
    v_mfma_f32_16x16x32_bf16 v[148:151], a[96:99], a[0:3], 0
    v_exp_f32 v187, v187
    v_mfma_f32_16x16x32_bf16 v[148:151], a[100:103], a[4:7], v[148:151]
    v_cvt_pk_bf16_f32 v178, v184, v185
    v_or3_b32 v188, v176, v177, v178
    v_mfma_f32_16x16x32_bf16 v[148:151], a[104:107], a[8:11], v[148:151]
    s_waitcnt lgkmcnt(0)
    v_cvt_pk_bf16_f32 v179, v186, v187
    v_bitop3_b32 v188, v188, v179, s26 bitop3:0xa8
    v_mfma_f32_16x16x32_bf16 v[148:151], a[108:111], a[12:15], v[148:151]
    v_cmp_ne_u32 vcc, 0, v188
    v_mfma_f32_16x16x32_bf16 v[148:151], a[112:115], a[16:19], v[148:151]
    s_nop 0
    buffer_store_dwordx4 v[228:231], v209, s[16:19], s53 offen offset:0 nt
    v_mfma_f32_16x16x32_bf16 v[148:151], a[116:119], a[20:23], v[148:151]
    s_cbranch_vccnz Z_rare_m0b2
Z_back_m0b2:
    v_fma_f32 v180, v144, s25, -v192
    v_mfma_f32_16x16x32_bf16 v[240:243], a[216:219], v[176:179], v[240:243]
    s_add_u32 s53, s53, s63
    v_fma_f32 v181, v145, s25, -v192
    v_fma_f32 v182, v146, s25, -v192
    v_mfma_f32_16x16x32_bf16 v[96:99], a[120:123], v[176:179], v[96:99]
    ds_read_b64_tr_b16 a[120:121], v197 offset:12288
    ds_read_b64_tr_b16 a[122:123], v197 offset:18432
    v_mfma_f32_16x16x32_bf16 v[100:103], a[124:127], v[176:179], v[100:103]
    v_exp_f32 v180, v180
    v_mfma_f32_16x16x32_bf16 v[104:107], a[128:131], v[176:179], v[104:107]
    v_exp_f32 v181, v181
    v_mfma_f32_16x16x32_bf16 v[108:111], a[132:135], v[176:179], v[108:111]
    ds_read_b64_tr_b16 a[124:125], v198 offset:12288
    ds_read_b64_tr_b16 a[126:127], v198 offset:18432
    v_mfma_f32_16x16x32_bf16 v[112:115], a[136:139], v[176:179], v[112:115]
    v_fma_f32 v183, v147, s25, -v192
    v_fma_f32 v184, v148, s25, -v192
    v_mfma_f32_16x16x32_bf16 v[116:119], a[140:143], v[176:179], v[116:119]
    v_exp_f32 v182, v182
    v_mfma_f32_16x16x32_bf16 v[120:123], a[144:147], v[176:179], v[120:123]
    ds_read_b64_tr_b16 a[128:129], v199 offset:12288
    ds_read_b64_tr_b16 a[130:131], v199 offset:18432
    v_mfma_f32_16x16x32_bf16 v[124:127], a[148:151], v[176:179], v[124:127]
    v_exp_f32 v183, v183
    v_mfma_f32_16x16x32_bf16 v[128:131], a[152:155], v[176:179], v[128:131]
    v_fma_f32 v185, v149, s25, -v192
    v_cvt_pk_bf16_f32 v168, v180, v181
    v_mfma_f32_16x16x32_bf16 v[132:135], a[156:159], v[176:179], v[132:135]
    ds_read_b64_tr_b16 a[132:133], v200 offset:12288
    ds_read_b64_tr_b16 a[134:135], v200 offset:18432
    v_mfma_f32_16x16x32_bf16 v[136:139], a[160:163], v[176:179], v[136:139]
    v_exp_f32 v184, v184
    v_mfma_f32_16x16x32_bf16 v[140:143], a[164:167], v[176:179], v[140:143]
    v_fma_f32 v186, v150, s25, -v192
    v_cvt_pk_bf16_f32 v169, v182, v183
    v_mfma_f32_16x16x32_bf16 v[152:155], a[72:75], a[24:27], 0
    s_add_u32 s21, s21, 12288
    ds_read_b64_tr_b16 a[136:137], v197 offset:12416
    ds_read_b64_tr_b16 a[138:139], v197 offset:18560
    v_mfma_f32_16x16x32_bf16 v[152:155], a[76:79], a[28:31], v[152:155]
    s_cmp_lt_u32 s20, 29
    v_exp_f32 v185, v185
    v_mfma_f32_16x16x32_bf16 v[152:155], a[80:83], a[32:35], v[152:155]
    s_cselect_b32 s10, s49, 0
    v_exp_f32 v186, v186
    v_mfma_f32_16x16x32_bf16 v[152:155], a[84:87], a[36:39], v[152:155]
    s_cmp_lt_u32 s20, 28
    ds_read_b64_tr_b16 a[140:141], v198 offset:12416
    ds_read_b64_tr_b16 a[142:143], v198 offset:18560
    v_mfma_f32_16x16x32_bf16 v[152:155], a[88:91], a[40:43], v[152:155]
    s_cselect_b32 s6, s49, 0
    v_fma_f32 v187, v151, s25, -v192
    v_cvt_pk_bf16_f32 v170, v184, v185
    v_mfma_f32_16x16x32_bf16 v[152:155], a[92:95], a[44:47], v[152:155]
    v_exp_f32 v187, v187
    v_mfma_f32_16x16x32_bf16 v[156:159], a[96:99], a[24:27], 0
    ds_read_b64_tr_b16 a[144:145], v199 offset:12416
    ds_read_b64_tr_b16 a[146:147], v199 offset:18560
    v_mfma_f32_16x16x32_bf16 v[156:159], a[100:103], a[28:31], v[156:159]
    v_or3_b32 v188, v168, v169, v170
    v_cvt_pk_bf16_f32 v171, v186, v187
    v_mfma_f32_16x16x32_bf16 v[156:159], a[104:107], a[32:35], v[156:159]
    ds_read_b64_tr_b16 a[148:149], v200 offset:12416
    ds_read_b64_tr_b16 a[150:151], v200 offset:18560
    v_mfma_f32_16x16x32_bf16 v[156:159], a[108:111], a[36:39], v[156:159]
    v_bitop3_b32 v188, v188, v171, s26 bitop3:0xa8
    v_cmp_ne_u32 vcc, 0, v188
    v_mfma_f32_16x16x32_bf16 v[156:159], a[112:115], a[40:43], v[156:159]
    ds_read_b64_tr_b16 a[152:153], v197 offset:12544
    ds_read_b64_tr_b16 a[154:155], v197 offset:18688
    v_mfma_f32_16x16x32_bf16 v[156:159], a[116:119], a[44:47], v[156:159]
    s_cbranch_vccnz Z_rare_m0b0
Z_back_m0b0:
    v_add_u32 v208, s63, v208
    v_mfma_f32_16x16x32_bf16 v[232:235], a[216:219], v[168:171], v[232:235]
    s_waitcnt lgkmcnt(4)
    ds_read_b64_tr_b16 a[156:157], v198 offset:12544
    ds_read_b64_tr_b16 a[158:159], v198 offset:18688
    v_mfma_f32_16x16x32_bf16 v[0:3], a[120:123], v[168:171], v[0:3]
    v_fma_f32 v180, v152, s25, -v193
    v_fma_f32 v181, v153, s25, -v193
    v_mfma_f32_16x16x32_bf16 v[4:7], a[124:127], v[168:171], v[4:7]
    ds_read_b64_tr_b16 a[160:161], v199 offset:12544
    ds_read_b64_tr_b16 a[162:163], v199 offset:18688
    v_mfma_f32_16x16x32_bf16 v[8:11], a[128:131], v[168:171], v[8:11]
    v_exp_f32 v180, v180
    v_mfma_f32_16x16x32_bf16 v[12:15], a[132:135], v[168:171], v[12:15]
    ds_read_b64_tr_b16 a[164:165], v200 offset:12544
    ds_read_b64_tr_b16 a[166:167], v200 offset:18688
    v_mfma_f32_16x16x32_bf16 v[16:19], a[136:139], v[168:171], v[16:19]
    s_add_u32 m0, s30, 12288
    v_fma_f32 v182, v154, s25, -v193
    v_fma_f32 v183, v155, s25, -v193
    v_mfma_f32_16x16x32_bf16 v[20:23], a[140:143], v[168:171], v[20:23]
    v_exp_f32 v181, v181
    v_mfma_f32_16x16x32_bf16 v[24:27], a[144:147], v[168:171], v[24:27]
    s_waitcnt lgkmcnt(4)
    v_exp_f32 v182, v182
    v_mfma_f32_16x16x32_bf16 v[28:31], a[148:151], v[168:171], v[28:31]
    v_fma_f32 v184, v156, s25, -v193
    v_cvt_pk_bf16_f32 v172, v180, v181
    v_mfma_f32_16x16x32_bf16 v[32:35], a[152:155], v[168:171], v[32:35]
    v_exp_f32 v183, v183
    v_mfma_f32_16x16x32_bf16 v[36:39], a[156:159], v[168:171], v[36:39]
    s_waitcnt vmcnt(8) lgkmcnt(0)
    v_fma_f32 v185, v157, s25, -v193
    v_fma_f32 v186, v158, s25, -v193
    v_mfma_f32_16x16x32_bf16 v[40:43], a[160:163], v[168:171], v[40:43]
    s_barrier
    v_mfma_f32_16x16x32_bf16 v[44:47], a[164:167], v[168:171], v[44:47]
    v_exp_f32 v184, v184
    v_mfma_f32_16x16x32_bf16 v[160:163], a[72:75], a[48:51], 0
    s_nop 0
    buffer_load_dwordx4 v204, s[8:11], s21 offen offset:0 nt lds
    v_mfma_f32_16x16x32_bf16 v[160:163], a[76:79], a[52:55], v[160:163]
    v_exp_f32 v185, v185
    v_mfma_f32_16x16x32_bf16 v[160:163], a[80:83], a[56:59], v[160:163]
    ds_read_b128 a[72:75], v195 offset:24576
    v_fma_f32 v187, v159, s25, -v193
    v_mfma_f32_16x16x32_bf16 v[160:163], a[84:87], a[60:63], v[160:163]
    v_exp_f32 v186, v186
    v_mfma_f32_16x16x32_bf16 v[160:163], a[88:91], a[64:67], v[160:163]
    s_nop 0
    buffer_load_dwordx4 v205, s[8:11], s21 offen offset:1024 nt lds
    v_mfma_f32_16x16x32_bf16 v[160:163], a[92:95], a[68:71], v[160:163]
    v_exp_f32 v187, v187
    v_mfma_f32_16x16x32_bf16 v[164:167], a[96:99], a[48:51], 0
    ds_read_b128 a[76:79], v196 offset:24576
    v_cvt_pk_bf16_f32 v173, v182, v183
    v_mfma_f32_16x16x32_bf16 v[164:167], a[100:103], a[52:55], v[164:167]
    ds_read_b128 a[80:83], v195 offset:24704
    v_cvt_pk_bf16_f32 v174, v184, v185
    v_mfma_f32_16x16x32_bf16 v[164:167], a[104:107], a[56:59], v[164:167]
    v_or3_b32 v188, v172, v173, v174
    v_cvt_pk_bf16_f32 v175, v186, v187
    v_mfma_f32_16x16x32_bf16 v[164:167], a[108:111], a[60:63], v[164:167]
    v_bitop3_b32 v188, v188, v175, s26 bitop3:0xa8
    v_cmp_ne_u32 vcc, 0, v188
    v_mfma_f32_16x16x32_bf16 v[164:167], a[112:115], a[64:67], v[164:167]
    s_nop 0
    buffer_load_dwordx4 v206, s[8:11], s21 offen offset:2048 nt lds
    v_mfma_f32_16x16x32_bf16 v[164:167], a[116:119], a[68:71], v[164:167]
    s_cbranch_vccnz Z_rare_m0b1
Z_back_m0b1:
    ds_read_b128 a[84:87], v196 offset:24704
    ds_read_b128 a[88:91], v195 offset:24832
    v_mfma_f32_16x16x32_bf16 v[236:239], a[216:219], v[172:175], v[236:239]
    s_add_u32 m0, s30, 49152
    ds_read_b128 a[92:95], v196 offset:24832
    v_fma_f32 v180, v160, s25, -v194
    v_mfma_f32_16x16x32_bf16 v[48:51], a[120:123], v[172:175], v[48:51]
    ds_read_b128 a[96:99], v195 offset:30720
    v_fma_f32 v181, v161, s25, -v194
    v_mfma_f32_16x16x32_bf16 v[52:55], a[124:127], v[172:175], v[52:55]
    v_exp_f32 v180, v180
    v_mfma_f32_16x16x32_bf16 v[56:59], a[128:131], v[172:175], v[56:59]
    s_nop 0
    buffer_load_dwordx4 v201, s[4:7], s21 offen offset:0 nt lds
    v_mfma_f32_16x16x32_bf16 v[60:63], a[132:135], v[172:175], v[60:63]
    ds_read_b128 a[100:103], v196 offset:30720
    v_fma_f32 v182, v162, s25, -v194
    v_mfma_f32_16x16x32_bf16 v[64:67], a[136:139], v[172:175], v[64:67]
    v_exp_f32 v181, v181
    v_mfma_f32_16x16x32_bf16 v[68:71], a[140:143], v[172:175], v[68:71]
    ds_read_b128 a[104:107], v195 offset:30848
    v_fma_f32 v183, v163, s25, -v194
    v_mfma_f32_16x16x32_bf16 v[72:75], a[144:147], v[172:175], v[72:75]
    s_nop 0
    buffer_load_dwordx4 v202, s[4:7], s21 offen offset:1024 nt lds
    v_mfma_f32_16x16x32_bf16 v[76:79], a[148:151], v[172:175], v[76:79]
    v_exp_f32 v182, v182
    v_mfma_f32_16x16x32_bf16 v[80:83], a[152:155], v[172:175], v[80:83]
    ds_read_b128 a[108:111], v196 offset:30848
    v_fma_f32 v184, v164, s25, -v194
    v_mfma_f32_16x16x32_bf16 v[84:87], a[156:159], v[172:175], v[84:87]
    v_exp_f32 v183, v183
    v_mfma_f32_16x16x32_bf16 v[88:91], a[160:163], v[172:175], v[88:91]
    s_add_u32 s20, s20, 1
    buffer_load_dwordx4 v203, s[4:7], s21 offen offset:2048 nt lds
    v_mfma_f32_16x16x32_bf16 v[92:95], a[164:167], v[172:175], v[92:95]
    s_waitcnt lgkmcnt(1)
    ds_read_b128 a[112:115], v195 offset:30976
    ds_read_b128 a[116:119], v196 offset:30976
    v_mfma_f32_16x16x32_bf16 v[144:147], a[72:75], a[0:3], 0
    s_bitcmp1_b32 s37, s20
    v_fma_f32 v185, v165, s25, -v194
    v_cvt_pk_bf16_f32 v176, v180, v181
    v_mfma_f32_16x16x32_bf16 v[144:147], a[76:79], a[4:7], v[144:147]
    s_cselect_b32 s18, s54, 0
    v_exp_f32 v184, v184
    v_mfma_f32_16x16x32_bf16 v[144:147], a[80:83], a[8:11], v[144:147]
    s_cselect_b32 s63, 1024, 0
    ds_read_b128 v[228:231], v208 offset:0
    v_fma_f32 v186, v166, s25, -v194
    v_mfma_f32_16x16x32_bf16 v[144:147], a[84:87], a[12:15], v[144:147]
    v_exp_f32 v185, v185
    v_mfma_f32_16x16x32_bf16 v[144:147], a[88:91], a[16:19], v[144:147]
    v_fma_f32 v187, v167, s25, -v194
    v_cvt_pk_bf16_f32 v177, v182, v183
    v_mfma_f32_16x16x32_bf16 v[144:147], a[92:95], a[20:23], v[144:147]
    v_exp_f32 v186, v186
    v_mfma_f32_16x16x32_bf16 v[148:151], a[96:99], a[0:3], 0
    v_exp_f32 v187, v187
    v_mfma_f32_16x16x32_bf16 v[148:151], a[100:103], a[4:7], v[148:151]
    v_cvt_pk_bf16_f32 v178, v184, v185
    v_or3_b32 v188, v176, v177, v178
    v_mfma_f32_16x16x32_bf16 v[148:151], a[104:107], a[8:11], v[148:151]
    s_waitcnt lgkmcnt(0)
    v_cvt_pk_bf16_f32 v179, v186, v187
    v_bitop3_b32 v188, v188, v179, s26 bitop3:0xa8
    v_mfma_f32_16x16x32_bf16 v[148:151], a[108:111], a[12:15], v[148:151]
    v_cmp_ne_u32 vcc, 0, v188
    v_mfma_f32_16x16x32_bf16 v[148:151], a[112:115], a[16:19], v[148:151]
    s_nop 0
    buffer_store_dwordx4 v[228:231], v209, s[16:19], s53 offen offset:0 nt
    v_mfma_f32_16x16x32_bf16 v[148:151], a[116:119], a[20:23], v[148:151]
    s_cbranch_vccnz Z_rare_m0c2
Z_back_m0c2:
    v_fma_f32 v180, v144, s25, -v192
    v_mfma_f32_16x16x32_bf16 v[240:243], a[216:219], v[176:179], v[240:243]
    s_add_u32 s53, s53, s63
    v_fma_f32 v181, v145, s25, -v192
    v_fma_f32 v182, v146, s25, -v192
    v_mfma_f32_16x16x32_bf16 v[96:99], a[120:123], v[176:179], v[96:99]
    ds_read_b64_tr_b16 a[120:121], v197 offset:24576
    ds_read_b64_tr_b16 a[122:123], v197 offset:30720
    v_mfma_f32_16x16x32_bf16 v[100:103], a[124:127], v[176:179], v[100:103]
    v_exp_f32 v180, v180
    v_mfma_f32_16x16x32_bf16 v[104:107], a[128:131], v[176:179], v[104:107]
    v_exp_f32 v181, v181
    v_mfma_f32_16x16x32_bf16 v[108:111], a[132:135], v[176:179], v[108:111]
    ds_read_b64_tr_b16 a[124:125], v198 offset:24576
    ds_read_b64_tr_b16 a[126:127], v198 offset:30720
    v_mfma_f32_16x16x32_bf16 v[112:115], a[136:139], v[176:179], v[112:115]
    v_fma_f32 v183, v147, s25, -v192
    v_fma_f32 v184, v148, s25, -v192
    v_mfma_f32_16x16x32_bf16 v[116:119], a[140:143], v[176:179], v[116:119]
    v_exp_f32 v182, v182
    v_mfma_f32_16x16x32_bf16 v[120:123], a[144:147], v[176:179], v[120:123]
    ds_read_b64_tr_b16 a[128:129], v199 offset:24576
    ds_read_b64_tr_b16 a[130:131], v199 offset:30720
    v_mfma_f32_16x16x32_bf16 v[124:127], a[148:151], v[176:179], v[124:127]
    v_exp_f32 v183, v183
    v_mfma_f32_16x16x32_bf16 v[128:131], a[152:155], v[176:179], v[128:131]
    v_fma_f32 v185, v149, s25, -v192
    v_cvt_pk_bf16_f32 v168, v180, v181
    v_mfma_f32_16x16x32_bf16 v[132:135], a[156:159], v[176:179], v[132:135]
    ds_read_b64_tr_b16 a[132:133], v200 offset:24576
    ds_read_b64_tr_b16 a[134:135], v200 offset:30720
    v_mfma_f32_16x16x32_bf16 v[136:139], a[160:163], v[176:179], v[136:139]
    v_exp_f32 v184, v184
    v_mfma_f32_16x16x32_bf16 v[140:143], a[164:167], v[176:179], v[140:143]
    v_fma_f32 v186, v150, s25, -v192
    v_cvt_pk_bf16_f32 v169, v182, v183
Z_mid0:
    v_mfma_f32_16x16x32_bf16 v[152:155], a[72:75], a[24:27], 0
    s_add_u32 s21, s21, 12288
    ds_read_b64_tr_b16 a[136:137], v197 offset:24704
    ds_read_b64_tr_b16 a[138:139], v197 offset:30848
    v_mfma_f32_16x16x32_bf16 v[152:155], a[76:79], a[28:31], v[152:155]
    s_cmp_lt_u32 s20, 29
    v_exp_f32 v185, v185
    v_mfma_f32_16x16x32_bf16 v[152:155], a[80:83], a[32:35], v[152:155]
    s_cselect_b32 s10, s49, 0
    v_exp_f32 v186, v186
    v_mfma_f32_16x16x32_bf16 v[152:155], a[84:87], a[36:39], v[152:155]
    s_cmp_lt_u32 s20, 28
    ds_read_b64_tr_b16 a[140:141], v198 offset:24704
    ds_read_b64_tr_b16 a[142:143], v198 offset:30848
    v_mfma_f32_16x16x32_bf16 v[152:155], a[88:91], a[40:43], v[152:155]
    s_cselect_b32 s6, s49, 0
    v_fma_f32 v187, v151, s25, -v192
    v_cvt_pk_bf16_f32 v170, v184, v185
    v_mfma_f32_16x16x32_bf16 v[152:155], a[92:95], a[44:47], v[152:155]
    v_exp_f32 v187, v187
    v_mfma_f32_16x16x32_bf16 v[156:159], a[96:99], a[24:27], 0
    ds_read_b64_tr_b16 a[144:145], v199 offset:24704
    ds_read_b64_tr_b16 a[146:147], v199 offset:30848
    v_mfma_f32_16x16x32_bf16 v[156:159], a[100:103], a[28:31], v[156:159]
    v_or3_b32 v188, v168, v169, v170
    v_cvt_pk_bf16_f32 v171, v186, v187
    v_mfma_f32_16x16x32_bf16 v[156:159], a[104:107], a[32:35], v[156:159]
    ds_read_b64_tr_b16 a[148:149], v200 offset:24704
    ds_read_b64_tr_b16 a[150:151], v200 offset:30848
    v_mfma_f32_16x16x32_bf16 v[156:159], a[108:111], a[36:39], v[156:159]
    v_bitop3_b32 v188, v188, v171, s26 bitop3:0xa8
    v_cmp_ne_u32 vcc, 0, v188
    v_mfma_f32_16x16x32_bf16 v[156:159], a[112:115], a[40:43], v[156:159]
    ds_read_b64_tr_b16 a[152:153], v197 offset:24832
    ds_read_b64_tr_b16 a[154:155], v197 offset:30976
    v_mfma_f32_16x16x32_bf16 v[156:159], a[116:119], a[44:47], v[156:159]
    s_cbranch_vccnz Z_rare_m0c0
Z_back_m0c0:
    v_add_u32 v208, s63, v208
    v_mfma_f32_16x16x32_bf16 v[232:235], a[216:219], v[168:171], v[232:235]
    s_waitcnt lgkmcnt(4)
    ds_read_b64_tr_b16 a[156:157], v198 offset:24832
    ds_read_b64_tr_b16 a[158:159], v198 offset:30976
    v_mfma_f32_16x16x32_bf16 v[0:3], a[120:123], v[168:171], v[0:3]
    v_fma_f32 v180, v152, s25, -v193
    v_fma_f32 v181, v153, s25, -v193
    v_mfma_f32_16x16x32_bf16 v[4:7], a[124:127], v[168:171], v[4:7]
    ds_read_b64_tr_b16 a[160:161], v199 offset:24832
    ds_read_b64_tr_b16 a[162:163], v199 offset:30976
    v_mfma_f32_16x16x32_bf16 v[8:11], a[128:131], v[168:171], v[8:11]
    v_exp_f32 v180, v180
    v_mfma_f32_16x16x32_bf16 v[12:15], a[132:135], v[168:171], v[12:15]
    ds_read_b64_tr_b16 a[164:165], v200 offset:24832
    ds_read_b64_tr_b16 a[166:167], v200 offset:30976
    v_mfma_f32_16x16x32_bf16 v[16:19], a[136:139], v[168:171], v[16:19]
    s_add_u32 m0, s30, 24576
    v_fma_f32 v182, v154, s25, -v193
    v_fma_f32 v183, v155, s25, -v193
    v_mfma_f32_16x16x32_bf16 v[20:23], a[140:143], v[168:171], v[20:23]
    v_exp_f32 v181, v181
    v_mfma_f32_16x16x32_bf16 v[24:27], a[144:147], v[168:171], v[24:27]
    s_waitcnt lgkmcnt(4)
    v_exp_f32 v182, v182
    v_mfma_f32_16x16x32_bf16 v[28:31], a[148:151], v[168:171], v[28:31]
    v_fma_f32 v184, v156, s25, -v193
    v_cvt_pk_bf16_f32 v172, v180, v181
    v_mfma_f32_16x16x32_bf16 v[32:35], a[152:155], v[168:171], v[32:35]
    v_exp_f32 v183, v183
    v_mfma_f32_16x16x32_bf16 v[36:39], a[156:159], v[168:171], v[36:39]
    s_waitcnt vmcnt(8) lgkmcnt(0)
    v_fma_f32 v185, v157, s25, -v193
    v_fma_f32 v186, v158, s25, -v193
    v_mfma_f32_16x16x32_bf16 v[40:43], a[160:163], v[168:171], v[40:43]
    s_barrier
    v_mfma_f32_16x16x32_bf16 v[44:47], a[164:167], v[168:171], v[44:47]
    v_exp_f32 v184, v184
    v_mfma_f32_16x16x32_bf16 v[160:163], a[72:75], a[48:51], 0
    s_nop 0
    buffer_load_dwordx4 v204, s[8:11], s21 offen offset:0 nt lds
    v_mfma_f32_16x16x32_bf16 v[160:163], a[76:79], a[52:55], v[160:163]
    v_exp_f32 v185, v185
    v_mfma_f32_16x16x32_bf16 v[160:163], a[80:83], a[56:59], v[160:163]
    ds_read_b128 a[72:75], v195 offset:0
    v_fma_f32 v187, v159, s25, -v193
    v_mfma_f32_16x16x32_bf16 v[160:163], a[84:87], a[60:63], v[160:163]
    v_exp_f32 v186, v186
    v_mfma_f32_16x16x32_bf16 v[160:163], a[88:91], a[64:67], v[160:163]
    s_nop 0
    buffer_load_dwordx4 v205, s[8:11], s21 offen offset:1024 nt lds
    v_mfma_f32_16x16x32_bf16 v[160:163], a[92:95], a[68:71], v[160:163]
    v_exp_f32 v187, v187
    v_mfma_f32_16x16x32_bf16 v[164:167], a[96:99], a[48:51], 0
    ds_read_b128 a[76:79], v196 offset:0
    v_cvt_pk_bf16_f32 v173, v182, v183
    v_mfma_f32_16x16x32_bf16 v[164:167], a[100:103], a[52:55], v[164:167]
    ds_read_b128 a[80:83], v195 offset:128
    v_cvt_pk_bf16_f32 v174, v184, v185
    v_mfma_f32_16x16x32_bf16 v[164:167], a[104:107], a[56:59], v[164:167]
    v_or3_b32 v188, v172, v173, v174
    v_cvt_pk_bf16_f32 v175, v186, v187
    v_mfma_f32_16x16x32_bf16 v[164:167], a[108:111], a[60:63], v[164:167]
    v_bitop3_b32 v188, v188, v175, s26 bitop3:0xa8
    v_cmp_ne_u32 vcc, 0, v188
    v_mfma_f32_16x16x32_bf16 v[164:167], a[112:115], a[64:67], v[164:167]
    s_nop 0
    buffer_load_dwordx4 v206, s[8:11], s21 offen offset:2048 nt lds
    v_mfma_f32_16x16x32_bf16 v[164:167], a[116:119], a[68:71], v[164:167]
    s_cbranch_vccnz Z_rare_m0c1
Z_back_m0c1:
    ds_read_b128 a[84:87], v196 offset:128
    ds_read_b128 a[88:91], v195 offset:256
    v_mfma_f32_16x16x32_bf16 v[236:239], a[216:219], v[172:175], v[236:239]
    s_add_u32 m0, s30, 61440
    ds_read_b128 a[92:95], v196 offset:256
    v_fma_f32 v180, v160, s25, -v194
    v_mfma_f32_16x16x32_bf16 v[48:51], a[120:123], v[172:175], v[48:51]
    ds_read_b128 a[96:99], v195 offset:6144
    v_fma_f32 v181, v161, s25, -v194
    v_mfma_f32_16x16x32_bf16 v[52:55], a[124:127], v[172:175], v[52:55]
    v_exp_f32 v180, v180
    v_mfma_f32_16x16x32_bf16 v[56:59], a[128:131], v[172:175], v[56:59]
    s_nop 0
    buffer_load_dwordx4 v201, s[4:7], s21 offen offset:0 nt lds
    v_mfma_f32_16x16x32_bf16 v[60:63], a[132:135], v[172:175], v[60:63]
    ds_read_b128 a[100:103], v196 offset:6144
    v_fma_f32 v182, v162, s25, -v194
    v_mfma_f32_16x16x32_bf16 v[64:67], a[136:139], v[172:175], v[64:67]
    v_exp_f32 v181, v181
    v_mfma_f32_16x16x32_bf16 v[68:71], a[140:143], v[172:175], v[68:71]
    ds_read_b128 a[104:107], v195 offset:6272
    v_fma_f32 v183, v163, s25, -v194
    v_mfma_f32_16x16x32_bf16 v[72:75], a[144:147], v[172:175], v[72:75]
    s_nop 0
    buffer_load_dwordx4 v202, s[4:7], s21 offen offset:1024 nt lds
    v_mfma_f32_16x16x32_bf16 v[76:79], a[148:151], v[172:175], v[76:79]
    v_exp_f32 v182, v182
    v_mfma_f32_16x16x32_bf16 v[80:83], a[152:155], v[172:175], v[80:83]
    ds_read_b128 a[108:111], v196 offset:6272
    v_fma_f32 v184, v164, s25, -v194
    v_mfma_f32_16x16x32_bf16 v[84:87], a[156:159], v[172:175], v[84:87]
    v_exp_f32 v183, v183
    v_mfma_f32_16x16x32_bf16 v[88:91], a[160:163], v[172:175], v[88:91]
    s_add_u32 s20, s20, 1
    buffer_load_dwordx4 v203, s[4:7], s21 offen offset:2048 nt lds
    v_mfma_f32_16x16x32_bf16 v[92:95], a[164:167], v[172:175], v[92:95]
    s_waitcnt lgkmcnt(1)
    ds_read_b128 a[112:115], v195 offset:6400
    ds_read_b128 a[116:119], v196 offset:6400
    v_mfma_f32_16x16x32_bf16 v[144:147], a[72:75], a[0:3], 0
    s_bitcmp1_b32 s37, s20
    v_fma_f32 v185, v165, s25, -v194
    v_cvt_pk_bf16_f32 v176, v180, v181
    v_mfma_f32_16x16x32_bf16 v[144:147], a[76:79], a[4:7], v[144:147]
    s_cselect_b32 s18, s54, 0
    v_exp_f32 v184, v184
    v_mfma_f32_16x16x32_bf16 v[144:147], a[80:83], a[8:11], v[144:147]
    s_cselect_b32 s63, 1024, 0
    ds_read_b128 v[228:231], v208 offset:0
    v_fma_f32 v186, v166, s25, -v194
    v_mfma_f32_16x16x32_bf16 v[144:147], a[84:87], a[12:15], v[144:147]
    v_exp_f32 v185, v185
    v_mfma_f32_16x16x32_bf16 v[144:147], a[88:91], a[16:19], v[144:147]
    v_fma_f32 v187, v167, s25, -v194
    v_cvt_pk_bf16_f32 v177, v182, v183
    v_mfma_f32_16x16x32_bf16 v[144:147], a[92:95], a[20:23], v[144:147]
    v_exp_f32 v186, v186
    v_mfma_f32_16x16x32_bf16 v[148:151], a[96:99], a[0:3], 0
    v_exp_f32 v187, v187
    v_mfma_f32_16x16x32_bf16 v[148:151], a[100:103], a[4:7], v[148:151]
    v_cvt_pk_bf16_f32 v178, v184, v185
    v_or3_b32 v188, v176, v177, v178
    v_mfma_f32_16x16x32_bf16 v[148:151], a[104:107], a[8:11], v[148:151]
    s_waitcnt lgkmcnt(0)
    v_cvt_pk_bf16_f32 v179, v186, v187
    v_bitop3_b32 v188, v188, v179, s26 bitop3:0xa8
    v_mfma_f32_16x16x32_bf16 v[148:151], a[108:111], a[12:15], v[148:151]
    v_cmp_ne_u32 vcc, 0, v188
    v_mfma_f32_16x16x32_bf16 v[148:151], a[112:115], a[16:19], v[148:151]
    s_nop 0
    buffer_store_dwordx4 v[228:231], v209, s[16:19], s53 offen offset:0 nt
    v_mfma_f32_16x16x32_bf16 v[148:151], a[116:119], a[20:23], v[148:151]
    s_cbranch_vccnz Z_rare_m0a2
Z_back_m0a2:
    v_fma_f32 v180, v144, s25, -v192
    s_cmp_lg_u32 s20, 30
    s_cbranch_scc1 Z_lp2_0
Z_E:
    v_mfma_f32_16x16x32_bf16 v[240:243], a[216:219], v[176:179], v[240:243]
    s_add_u32 s53, s53, s63
    ds_read_b128 a[168:171], v248 offset:0
    ds_read_b128 a[172:175], v249 offset:0
    v_fma_f32 v181, v145, s25, -v192
    v_exp_f32 v180, v180
    v_add_u32 v208, s63, v208
    v_mfma_f32_16x16x32_bf16 v[96:99], a[120:123], v[176:179], v[96:99]
    s_add_u32 s27, s53, 4096
    ds_read_b128 a[176:179], v248 offset:128
    ds_read_b128 a[180:183], v249 offset:128
    v_mfma_f32_16x16x32_bf16 v[100:103], a[124:127], v[176:179], v[100:103]
    s_mov_b32 s18, s54
    ds_read_b128 a[184:187], v248 offset:256
    ds_read_b128 a[188:191], v249 offset:256
    v_exp_f32 v181, v181
    v_mfma_f32_16x16x32_bf16 v[104:107], a[128:131], v[176:179], v[104:107]
    ds_read_b128 a[192:195], v248 offset:6144
    ds_read_b128 a[196:199], v249 offset:6144
    v_fma_f32 v182, v146, s25, -v192
    v_mfma_f32_16x16x32_bf16 v[108:111], a[132:135], v[176:179], v[108:111]
    ds_read_b128 a[200:203], v248 offset:6272
    ds_read_b128 a[204:207], v249 offset:6272
    v_fma_f32 v183, v147, s25, -v192
    v_mfma_f32_16x16x32_bf16 v[112:115], a[136:139], v[176:179], v[112:115]
    ds_read_b128 a[208:211], v248 offset:6400
    ds_read_b128 a[212:215], v249 offset:6400
    v_exp_f32 v182, v182
    v_mfma_f32_16x16x32_bf16 v[116:119], a[140:143], v[176:179], v[116:119]
    ds_read_b64_tr_b16 a[120:121], v197 offset:0
    ds_read_b64_tr_b16 a[122:123], v197 offset:6144
    v_exp_f32 v183, v183
    v_mfma_f32_16x16x32_bf16 v[120:123], a[144:147], v[176:179], v[120:123]
    ds_read_b64_tr_b16 a[124:125], v198 offset:0
    ds_read_b64_tr_b16 a[126:127], v198 offset:6144
    v_mfma_f32_16x16x32_bf16 v[124:127], a[148:151], v[176:179], v[124:127]
    ds_read_b64_tr_b16 a[128:129], v199 offset:0
    ds_read_b64_tr_b16 a[130:131], v199 offset:6144
    v_cvt_pk_bf16_f32 v168, v180, v181
    v_fma_f32 v184, v148, s25, -v192
    v_mfma_f32_16x16x32_bf16 v[128:131], a[152:155], v[176:179], v[128:131]
    ds_read_b64_tr_b16 a[132:133], v200 offset:0
    ds_read_b64_tr_b16 a[134:135], v200 offset:6144
    v_fma_f32 v185, v149, s25, -v192
    v_mfma_f32_16x16x32_bf16 v[132:135], a[156:159], v[176:179], v[132:135]
    ds_read_b64_tr_b16 a[136:137], v197 offset:128
    ds_read_b64_tr_b16 a[138:139], v197 offset:6272
    v_exp_f32 v184, v184
    v_mfma_f32_16x16x32_bf16 v[136:139], a[160:163], v[176:179], v[136:139]
    ds_read_b64_tr_b16 a[140:141], v198 offset:128
    ds_read_b64_tr_b16 a[142:143], v198 offset:6272
    v_cvt_pk_bf16_f32 v169, v182, v183
    v_mfma_f32_16x16x32_bf16 v[140:143], a[164:167], v[176:179], v[140:143]
    s_waitcnt lgkmcnt(10)
    ds_read_b64_tr_b16 a[144:145], v199 offset:128
    ds_read_b64_tr_b16 a[146:147], v199 offset:6272
    v_exp_f32 v185, v185
    v_mfma_f32_16x16x32_bf16 v[152:155], a[168:171], a[0:3], 0
    ds_read_b64_tr_b16 a[148:149], v200 offset:128
    ds_read_b64_tr_b16 a[150:151], v200 offset:6272
    v_fma_f32 v186, v150, s25, -v192
    v_mfma_f32_16x16x32_bf16 v[152:155], a[172:175], a[4:7], v[152:155]
    ds_read_b64_tr_b16 a[152:153], v197 offset:256
    ds_read_b64_tr_b16 a[154:155], v197 offset:6400
    v_fma_f32 v187, v151, s25, -v192
    v_mfma_f32_16x16x32_bf16 v[152:155], a[176:179], a[8:11], v[152:155]
    ds_read_b64_tr_b16 a[156:157], v198 offset:256
    ds_read_b64_tr_b16 a[158:159], v198 offset:6400
    v_exp_f32 v186, v186
    v_mfma_f32_16x16x32_bf16 v[152:155], a[180:183], a[12:15], v[152:155]
    ds_read_b64_tr_b16 a[160:161], v199 offset:256
    ds_read_b64_tr_b16 a[162:163], v199 offset:6400
    v_cvt_pk_bf16_f32 v170, v184, v185
    v_mfma_f32_16x16x32_bf16 v[152:155], a[184:187], a[16:19], v[152:155]
    ds_read_b64_tr_b16 a[164:165], v200 offset:256
    ds_read_b64_tr_b16 a[166:167], v200 offset:6400
    v_exp_f32 v187, v187
    v_mfma_f32_16x16x32_bf16 v[152:155], a[188:191], a[20:23], v[152:155]
    v_mfma_f32_16x16x32_bf16 v[156:159], a[192:195], a[0:3], 0
    v_or3_b32 v188, v168, v169, v170
    v_cvt_pk_bf16_f32 v171, v186, v187
    v_mfma_f32_16x16x32_bf16 v[156:159], a[196:199], a[4:7], v[156:159]
    v_bitop3_b32 v188, v188, v171, s26 bitop3:0xa8
    v_mfma_f32_16x16x32_bf16 v[156:159], a[200:203], a[8:11], v[156:159]
    s_waitcnt vmcnt(8) lgkmcnt(0)
    v_cmp_ne_u32 vcc, 0, v188
    v_mfma_f32_16x16x32_bf16 v[156:159], a[204:207], a[12:15], v[156:159]
    s_barrier
    v_mfma_f32_16x16x32_bf16 v[156:159], a[208:211], a[16:19], v[156:159]
    v_mfma_f32_16x16x32_bf16 v[156:159], a[212:215], a[20:23], v[156:159]
    s_cbranch_vccnz Z_rare_ea
Z_back_ea:
    v_mfma_f32_16x16x32_bf16 v[232:235], a[216:219], v[168:171], v[232:235]
    v_fma_f32 v180, v152, s25, -v192
    v_fma_f32 v181, v153, s25, -v192
    v_mfma_f32_16x16x32_bf16 v[0:3], a[120:123], v[168:171], v[0:3]
    ds_read_b64_tr_b16 a[120:121], v197 offset:12288
    ds_read_b64_tr_b16 a[122:123], v197 offset:18432
    v_exp_f32 v180, v180
    v_mfma_f32_16x16x32_bf16 v[4:7], a[124:127], v[168:171], v[4:7]
    ds_read_b64_tr_b16 a[124:125], v198 offset:12288
    ds_read_b64_tr_b16 a[126:127], v198 offset:18432
    v_exp_f32 v181, v181
    v_mfma_f32_16x16x32_bf16 v[8:11], a[128:131], v[168:171], v[8:11]
    ds_read_b64_tr_b16 a[128:129], v199 offset:12288
    ds_read_b64_tr_b16 a[130:131], v199 offset:18432
    v_mfma_f32_16x16x32_bf16 v[12:15], a[132:135], v[168:171], v[12:15]
    ds_read_b64_tr_b16 a[132:133], v200 offset:12288
    ds_read_b64_tr_b16 a[134:135], v200 offset:18432
    v_fma_f32 v182, v154, s25, -v192
    v_fma_f32 v183, v155, s25, -v192
    v_mfma_f32_16x16x32_bf16 v[16:19], a[136:139], v[168:171], v[16:19]
    ds_read_b64_tr_b16 a[136:137], v197 offset:12416
    ds_read_b64_tr_b16 a[138:139], v197 offset:18560
    v_exp_f32 v182, v182
    v_mfma_f32_16x16x32_bf16 v[20:23], a[140:143], v[168:171], v[20:23]
    ds_read_b64_tr_b16 a[140:141], v198 offset:12416
    ds_read_b64_tr_b16 a[142:143], v198 offset:18560
    v_mfma_f32_16x16x32_bf16 v[24:27], a[144:147], v[168:171], v[24:27]
    ds_read_b64_tr_b16 a[144:145], v199 offset:12416
    ds_read_b64_tr_b16 a[146:147], v199 offset:18560
    v_exp_f32 v183, v183
    v_mfma_f32_16x16x32_bf16 v[28:31], a[148:151], v[168:171], v[28:31]
    ds_read_b64_tr_b16 a[148:149], v200 offset:12416
    ds_read_b64_tr_b16 a[150:151], v200 offset:18560
    v_cvt_pk_bf16_f32 v172, v180, v181
    v_mfma_f32_16x16x32_bf16 v[32:35], a[152:155], v[168:171], v[32:35]
    ds_read_b64_tr_b16 a[152:153], v197 offset:12544
    ds_read_b64_tr_b16 a[154:155], v197 offset:18688
    v_fma_f32 v184, v156, s25, -v192
    v_fma_f32 v185, v157, s25, -v192
    v_mfma_f32_16x16x32_bf16 v[36:39], a[156:159], v[168:171], v[36:39]
    ds_read_b64_tr_b16 a[156:157], v198 offset:12544
    ds_read_b64_tr_b16 a[158:159], v198 offset:18688
    v_exp_f32 v184, v184
    v_mfma_f32_16x16x32_bf16 v[40:43], a[160:163], v[168:171], v[40:43]
    ds_read_b64_tr_b16 a[160:161], v199 offset:12544
    ds_read_b64_tr_b16 a[162:163], v199 offset:18688
    v_mfma_f32_16x16x32_bf16 v[44:47], a[164:167], v[168:171], v[44:47]
    ds_read_b64_tr_b16 a[164:165], v200 offset:12544
    ds_read_b64_tr_b16 a[166:167], v200 offset:18688
    v_cvt_pk_bf16_f32 v173, v182, v183
    v_exp_f32 v185, v185
    v_mfma_f32_16x16x32_bf16 v[160:163], a[168:171], a[24:27], 0
    ds_read_b128 a[220:223], v208 offset:0
    v_mfma_f32_16x16x32_bf16 v[160:163], a[172:175], a[28:31], v[160:163]
    v_fma_f32 v186, v158, s25, -v192
    v_fma_f32 v187, v159, s25, -v192
    v_mfma_f32_16x16x32_bf16 v[160:163], a[176:179], a[32:35], v[160:163]
    v_exp_f32 v186, v186
    v_mfma_f32_16x16x32_bf16 v[160:163], a[180:183], a[36:39], v[160:163]
    v_mfma_f32_16x16x32_bf16 v[160:163], a[184:187], a[40:43], v[160:163]
    v_cvt_pk_bf16_f32 v174, v184, v185
    v_exp_f32 v187, v187
    v_mfma_f32_16x16x32_bf16 v[160:163], a[188:191], a[44:47], v[160:163]
    v_mfma_f32_16x16x32_bf16 v[164:167], a[192:195], a[24:27], 0
    v_or3_b32 v188, v172, v173, v174
    v_cvt_pk_bf16_f32 v175, v186, v187
    v_mfma_f32_16x16x32_bf16 v[164:167], a[196:199], a[28:31], v[164:167]
    v_bitop3_b32 v188, v188, v175, s26 bitop3:0xa8
    v_mfma_f32_16x16x32_bf16 v[164:167], a[200:203], a[32:35], v[164:167]
    s_waitcnt lgkmcnt(0)
    buffer_store_dwordx4 a[220:223], v209, s[16:19], s53 offen offset:0 nt
    v_cmp_ne_u32 vcc, 0, v188
    v_mfma_f32_16x16x32_bf16 v[164:167], a[204:207], a[36:39], v[164:167]
    v_mfma_f32_16x16x32_bf16 v[164:167], a[208:211], a[40:43], v[164:167]
    v_add_u32 v208, s55, v207
    v_mfma_f32_16x16x32_bf16 v[164:167], a[212:215], a[44:47], v[164:167]
    s_cbranch_vccnz Z_rare_eb
Z_back_eb:
    v_mfma_f32_16x16x32_bf16 v[232:235], a[216:219], v[172:175], v[232:235]
    v_fma_f32 v180, v160, s25, -v193
    v_fma_f32 v181, v161, s25, -v193
    v_mfma_f32_16x16x32_bf16 v[0:3], a[120:123], v[172:175], v[0:3]
    v_exp_f32 v180, v180
    v_mfma_f32_16x16x32_bf16 v[4:7], a[124:127], v[172:175], v[4:7]
    v_exp_f32 v181, v181
    v_mfma_f32_16x16x32_bf16 v[8:11], a[128:131], v[172:175], v[8:11]
    v_mfma_f32_16x16x32_bf16 v[12:15], a[132:135], v[172:175], v[12:15]
    v_fma_f32 v182, v162, s25, -v193
    v_fma_f32 v183, v163, s25, -v193
    v_mfma_f32_16x16x32_bf16 v[16:19], a[136:139], v[172:175], v[16:19]
    v_exp_f32 v182, v182
    v_mfma_f32_16x16x32_bf16 v[20:23], a[140:143], v[172:175], v[20:23]
    v_rcp_f32 v232, v232
    v_mfma_f32_16x16x32_bf16 v[24:27], a[144:147], v[172:175], v[24:27]
    v_exp_f32 v183, v183
    v_mfma_f32_16x16x32_bf16 v[28:31], a[148:151], v[172:175], v[28:31]
    v_cvt_pk_bf16_f32 v176, v180, v181
    v_pk_mul_f32 v[0:1], v[0:1], v[232:233] op_sel_hi:[1,0]
    v_pk_mul_f32 v[2:3], v[2:3], v[232:233] op_sel_hi:[1,0]
    v_pk_mul_f32 v[4:5], v[4:5], v[232:233] op_sel_hi:[1,0]
    v_pk_mul_f32 v[6:7], v[6:7], v[232:233] op_sel_hi:[1,0]
    v_pk_mul_f32 v[8:9], v[8:9], v[232:233] op_sel_hi:[1,0]
    v_pk_mul_f32 v[10:11], v[10:11], v[232:233] op_sel_hi:[1,0]
    v_pk_mul_f32 v[12:13], v[12:13], v[232:233] op_sel_hi:[1,0]
    v_pk_mul_f32 v[14:15], v[14:15], v[232:233] op_sel_hi:[1,0]
    v_mfma_f32_16x16x32_bf16 v[32:35], a[152:155], v[172:175], v[32:35]
    v_fma_f32 v184, v164, s25, -v193
    v_fma_f32 v185, v165, s25, -v193
    v_mfma_f32_16x16x32_bf16 v[36:39], a[156:159], v[172:175], v[36:39]
    v_exp_f32 v184, v184
    v_cvt_pk_bf16_f32 v0, v0, v1
    v_cvt_pk_bf16_f32 v1, v2, v3
    v_mfma_f32_16x16x32_bf16 v[40:43], a[160:163], v[172:175], v[40:43]
    ds_write_b64 v216, v[0:1] offset:0
    v_cvt_pk_bf16_f32 v4, v4, v5
    v_cvt_pk_bf16_f32 v5, v6, v7
    v_mfma_f32_16x16x32_bf16 v[44:47], a[164:167], v[172:175], v[44:47]
    ds_write_b64 v217, v[4:5] offset:0
    v_cvt_pk_bf16_f32 v177, v182, v183
    v_exp_f32 v185, v185
    v_cvt_pk_bf16_f32 v8, v8, v9
    v_mfma_f32_16x16x32_bf16 v[144:147], a[72:75], a[24:27], 0
    v_cvt_pk_bf16_f32 v9, v10, v11
    v_mfma_f32_16x16x32_bf16 v[144:147], a[76:79], a[28:31], v[144:147]
    ds_write_b64 v218, v[8:9] offset:0
    v_fma_f32 v186, v166, s25, -v193
    v_fma_f32 v187, v167, s25, -v193
    v_cvt_pk_bf16_f32 v12, v12, v13
    v_cvt_pk_bf16_f32 v13, v14, v15
    v_mfma_f32_16x16x32_bf16 v[144:147], a[80:83], a[32:35], v[144:147]
    ds_write_b64 v219, v[12:13] offset:0
    v_exp_f32 v186, v186
    v_pk_mul_f32 v[16:17], v[16:17], v[232:233] op_sel_hi:[1,0]
    v_pk_mul_f32 v[18:19], v[18:19], v[232:233] op_sel_hi:[1,0]
    v_pk_mul_f32 v[20:21], v[20:21], v[232:233] op_sel_hi:[1,0]
    v_pk_mul_f32 v[22:23], v[22:23], v[232:233] op_sel_hi:[1,0]
    v_pk_mul_f32 v[24:25], v[24:25], v[232:233] op_sel_hi:[1,0]
    v_pk_mul_f32 v[26:27], v[26:27], v[232:233] op_sel_hi:[1,0]
    v_pk_mul_f32 v[28:29], v[28:29], v[232:233] op_sel_hi:[1,0]
    v_pk_mul_f32 v[30:31], v[30:31], v[232:233] op_sel_hi:[1,0]
    v_mfma_f32_16x16x32_bf16 v[144:147], a[84:87], a[36:39], v[144:147]
    v_mfma_f32_16x16x32_bf16 v[144:147], a[88:91], a[40:43], v[144:147]
    v_cvt_pk_bf16_f32 v178, v184, v185
    v_exp_f32 v187, v187
    v_cvt_pk_bf16_f32 v16, v16, v17
    v_mfma_f32_16x16x32_bf16 v[144:147], a[92:95], a[44:47], v[144:147]
    v_cvt_pk_bf16_f32 v17, v18, v19
    v_mfma_f32_16x16x32_bf16 v[148:151], a[96:99], a[24:27], 0
    ds_write_b64 v220, v[16:17] offset:0
    v_or3_b32 v188, v176, v177, v178
    v_cvt_pk_bf16_f32 v179, v186, v187
    v_cvt_pk_bf16_f32 v20, v20, v21
    v_cvt_pk_bf16_f32 v21, v22, v23
    v_mfma_f32_16x16x32_bf16 v[148:151], a[100:103], a[28:31], v[148:151]
    ds_write_b64 v221, v[20:21] offset:0
    v_bitop3_b32 v188, v188, v179, s26 bitop3:0xa8
    v_cvt_pk_bf16_f32 v24, v24, v25
    v_cvt_pk_bf16_f32 v25, v26, v27
    v_mfma_f32_16x16x32_bf16 v[148:151], a[104:107], a[32:35], v[148:151]
    ds_write_b64 v222, v[24:25] offset:0
    v_cmp_ne_u32 vcc, 0, v188
    v_cvt_pk_bf16_f32 v28, v28, v29
    v_mfma_f32_16x16x32_bf16 v[148:151], a[108:111], a[36:39], v[148:151]
    v_cvt_pk_bf16_f32 v29, v30, v31
    v_mfma_f32_16x16x32_bf16 v[148:151], a[112:115], a[40:43], v[148:151]
    ds_write_b64 v223, v[28:29] offset:0
    v_pk_mul_f32 v[32:33], v[32:33], v[232:233] op_sel_hi:[1,0]
    v_pk_mul_f32 v[34:35], v[34:35], v[232:233] op_sel_hi:[1,0]
    v_pk_mul_f32 v[36:37], v[36:37], v[232:233] op_sel_hi:[1,0]
    v_pk_mul_f32 v[38:39], v[38:39], v[232:233] op_sel_hi:[1,0]
    v_pk_mul_f32 v[40:41], v[40:41], v[232:233] op_sel_hi:[1,0]
    v_pk_mul_f32 v[42:43], v[42:43], v[232:233] op_sel_hi:[1,0]
    v_pk_mul_f32 v[44:45], v[44:45], v[232:233] op_sel_hi:[1,0]
    v_pk_mul_f32 v[46:47], v[46:47], v[232:233] op_sel_hi:[1,0]
    v_mfma_f32_16x16x32_bf16 v[148:151], a[116:119], a[44:47], v[148:151]
    s_cbranch_vccnz Z_rare_ec
Z_back_ec:
    v_mfma_f32_16x16x32_bf16 v[236:239], a[216:219], v[176:179], v[236:239]
    v_fma_f32 v180, v144, s25, -v193
    v_fma_f32 v181, v145, s25, -v193
    v_cvt_pk_bf16_f32 v32, v32, v33
    v_cvt_pk_bf16_f32 v33, v34, v35
    v_mfma_f32_16x16x32_bf16 v[48:51], a[120:123], v[176:179], v[48:51]
    ds_read_b64_tr_b16 a[120:121], v197 offset:0
    ds_read_b64_tr_b16 a[122:123], v197 offset:6144
    ds_write_b64 v224, v[32:33] offset:0
    v_exp_f32 v180, v180
    v_cvt_pk_bf16_f32 v36, v36, v37
    v_mfma_f32_16x16x32_bf16 v[52:55], a[124:127], v[176:179], v[52:55]
    ds_read_b64_tr_b16 a[124:125], v198 offset:0
    ds_read_b64_tr_b16 a[126:127], v198 offset:6144
    v_exp_f32 v181, v181
    v_cvt_pk_bf16_f32 v37, v38, v39
    v_mfma_f32_16x16x32_bf16 v[56:59], a[128:131], v[176:179], v[56:59]
    ds_read_b64_tr_b16 a[128:129], v199 offset:0
    ds_read_b64_tr_b16 a[130:131], v199 offset:6144
    ds_write_b64 v225, v[36:37] offset:0
    v_cvt_pk_bf16_f32 v40, v40, v41
    v_cvt_pk_bf16_f32 v41, v42, v43
    v_mfma_f32_16x16x32_bf16 v[60:63], a[132:135], v[176:179], v[60:63]
    ds_read_b64_tr_b16 a[132:133], v200 offset:0
    ds_read_b64_tr_b16 a[134:135], v200 offset:6144
    ds_write_b64 v226, v[40:41] offset:0
    v_fma_f32 v182, v146, s25, -v193
    v_fma_f32 v183, v147, s25, -v193
    v_cvt_pk_bf16_f32 v44, v44, v45
    v_cvt_pk_bf16_f32 v45, v46, v47
    v_mfma_f32_16x16x32_bf16 v[64:67], a[136:139], v[176:179], v[64:67]
    ds_read_b64_tr_b16 a[136:137], v197 offset:128
    ds_read_b64_tr_b16 a[138:139], v197 offset:6272
    ds_write_b64 v227, v[44:45] offset:0
    v_exp_f32 v182, v182
    v_mfma_f32_16x16x32_bf16 v[68:71], a[140:143], v[176:179], v[68:71]
    ds_read_b64_tr_b16 a[140:141], v198 offset:128
    ds_read_b64_tr_b16 a[142:143], v198 offset:6272
    v_mfma_f32_16x16x32_bf16 v[72:75], a[144:147], v[176:179], v[72:75]
    ds_read_b64_tr_b16 a[144:145], v199 offset:128
    ds_read_b64_tr_b16 a[146:147], v199 offset:6272
    ds_read_b128 v[0:3], v208 offset:0
    ds_read_b128 v[4:7], v208 offset:1024
    v_exp_f32 v183, v183
    s_add_u32 s27, s45, 0
    s_add_u32 s28, s45, 3072
    v_mfma_f32_16x16x32_bf16 v[76:79], a[148:151], v[176:179], v[76:79]
    ds_read_b64_tr_b16 a[148:149], v200 offset:128
    ds_read_b64_tr_b16 a[150:151], v200 offset:6272
    ds_read_b128 v[8:11], v208 offset:2048
    ds_read_b128 v[12:15], v208 offset:3072
    v_cvt_pk_bf16_f32 v168, v180, v181
    v_mfma_f32_16x16x32_bf16 v[80:83], a[152:155], v[176:179], v[80:83]
    ds_read_b64_tr_b16 a[152:153], v197 offset:256
    ds_read_b64_tr_b16 a[154:155], v197 offset:6400
    ds_read_b128 v[16:19], v208 offset:4096
    ds_read_b128 v[20:23], v208 offset:5120
    v_fma_f32 v184, v148, s25, -v193
    v_fma_f32 v185, v149, s25, -v193
    v_mfma_f32_16x16x32_bf16 v[84:87], a[156:159], v[176:179], v[84:87]
    ds_read_b64_tr_b16 a[156:157], v198 offset:256
    ds_read_b64_tr_b16 a[158:159], v198 offset:6400
    v_exp_f32 v184, v184
    v_mfma_f32_16x16x32_bf16 v[88:91], a[160:163], v[176:179], v[88:91]
    ds_read_b64_tr_b16 a[160:161], v199 offset:256
    ds_read_b64_tr_b16 a[162:163], v199 offset:6400
    v_mfma_f32_16x16x32_bf16 v[92:95], a[164:167], v[176:179], v[92:95]
    ds_read_b64_tr_b16 a[164:165], v200 offset:256
    ds_read_b64_tr_b16 a[166:167], v200 offset:6400
    v_cvt_pk_bf16_f32 v169, v182, v183
    v_exp_f32 v185, v185
    v_mfma_f32_16x16x32_bf16 v[152:155], a[72:75], a[48:51], 0
    v_mfma_f32_16x16x32_bf16 v[152:155], a[76:79], a[52:55], v[152:155]
    v_fma_f32 v186, v150, s25, -v193
    v_fma_f32 v187, v151, s25, -v193
    v_mfma_f32_16x16x32_bf16 v[152:155], a[80:83], a[56:59], v[152:155]
    s_waitcnt lgkmcnt(6)
    buffer_store_dwordx4 v[0:3], v209, s[16:19], s27 offen offset:0 nt
    v_exp_f32 v186, v186
    v_mfma_f32_16x16x32_bf16 v[152:155], a[84:87], a[60:63], v[152:155]
    v_mfma_f32_16x16x32_bf16 v[152:155], a[88:91], a[64:67], v[152:155]
    v_cvt_pk_bf16_f32 v170, v184, v185
    v_exp_f32 v187, v187
    v_mfma_f32_16x16x32_bf16 v[152:155], a[92:95], a[68:71], v[152:155]
    v_mfma_f32_16x16x32_bf16 v[156:159], a[96:99], a[48:51], 0
    s_nop 0
    buffer_store_dwordx4 v[4:7], v209, s[16:19], s27 offen offset:1024 nt
    v_or3_b32 v188, v168, v169, v170
    v_cvt_pk_bf16_f32 v171, v186, v187
    v_mfma_f32_16x16x32_bf16 v[156:159], a[100:103], a[52:55], v[156:159]
    v_bitop3_b32 v188, v188, v171, s26 bitop3:0xa8
    v_mfma_f32_16x16x32_bf16 v[156:159], a[104:107], a[56:59], v[156:159]
    v_cmp_ne_u32 vcc, 0, v188
    v_mfma_f32_16x16x32_bf16 v[156:159], a[108:111], a[60:63], v[156:159]
    v_mfma_f32_16x16x32_bf16 v[156:159], a[112:115], a[64:67], v[156:159]
    s_nop 0
    buffer_store_dwordx4 v[8:11], v209, s[16:19], s27 offen offset:2048 nt
    v_mfma_f32_16x16x32_bf16 v[156:159], a[116:119], a[68:71], v[156:159]
    s_cbranch_vccnz Z_rare_ed
Z_back_ed:
    v_mfma_f32_16x16x32_bf16 v[236:239], a[216:219], v[168:171], v[236:239]
    v_fma_f32 v180, v152, s25, -v194
    v_fma_f32 v181, v153, s25, -v194
    v_mfma_f32_16x16x32_bf16 v[48:51], a[120:123], v[168:171], v[48:51]
    v_exp_f32 v180, v180
    v_mfma_f32_16x16x32_bf16 v[52:55], a[124:127], v[168:171], v[52:55]
    s_nop 0
    buffer_store_dwordx4 v[12:15], v209, s[16:19], s28 offen offset:0 nt
    v_exp_f32 v181, v181
    v_mfma_f32_16x16x32_bf16 v[56:59], a[128:131], v[168:171], v[56:59]
    v_mfma_f32_16x16x32_bf16 v[60:63], a[132:135], v[168:171], v[60:63]
    v_fma_f32 v182, v154, s25, -v194
    v_fma_f32 v183, v155, s25, -v194
    v_mfma_f32_16x16x32_bf16 v[64:67], a[136:139], v[168:171], v[64:67]
    v_exp_f32 v182, v182
    v_mfma_f32_16x16x32_bf16 v[68:71], a[140:143], v[168:171], v[68:71]
    s_nop 0
    buffer_store_dwordx4 v[16:19], v209, s[16:19], s28 offen offset:1024 nt
    v_rcp_f32 v236, v236
    v_mfma_f32_16x16x32_bf16 v[72:75], a[144:147], v[168:171], v[72:75]
    v_exp_f32 v183, v183
    v_mfma_f32_16x16x32_bf16 v[76:79], a[148:151], v[168:171], v[76:79]
    v_cvt_pk_bf16_f32 v172, v180, v181
    v_pk_mul_f32 v[48:49], v[48:49], v[236:237] op_sel_hi:[1,0]
    v_pk_mul_f32 v[50:51], v[50:51], v[236:237] op_sel_hi:[1,0]
    v_pk_mul_f32 v[52:53], v[52:53], v[236:237] op_sel_hi:[1,0]
    v_pk_mul_f32 v[54:55], v[54:55], v[236:237] op_sel_hi:[1,0]
    v_pk_mul_f32 v[56:57], v[56:57], v[236:237] op_sel_hi:[1,0]
    v_pk_mul_f32 v[58:59], v[58:59], v[236:237] op_sel_hi:[1,0]
    v_pk_mul_f32 v[60:61], v[60:61], v[236:237] op_sel_hi:[1,0]
    v_pk_mul_f32 v[62:63], v[62:63], v[236:237] op_sel_hi:[1,0]
    v_mfma_f32_16x16x32_bf16 v[80:83], a[152:155], v[168:171], v[80:83]
    s_waitcnt lgkmcnt(0)
    v_fma_f32 v184, v156, s25, -v194
    v_fma_f32 v185, v157, s25, -v194
    v_mfma_f32_16x16x32_bf16 v[84:87], a[156:159], v[168:171], v[84:87]
    s_nop 0
    buffer_store_dwordx4 v[20:23], v209, s[16:19], s28 offen offset:2048 nt
    v_exp_f32 v184, v184
    v_cvt_pk_bf16_f32 v48, v48, v49
    v_cvt_pk_bf16_f32 v49, v50, v51
    v_mfma_f32_16x16x32_bf16 v[88:91], a[160:163], v[168:171], v[88:91]
    ds_write_b64 v216, v[48:49] offset:6144
    v_cvt_pk_bf16_f32 v52, v52, v53
    v_cvt_pk_bf16_f32 v53, v54, v55
    v_mfma_f32_16x16x32_bf16 v[92:95], a[164:167], v[168:171], v[92:95]
    ds_write_b64 v217, v[52:53] offset:6144
    v_cvt_pk_bf16_f32 v173, v182, v183
    v_exp_f32 v185, v185
    v_cvt_pk_bf16_f32 v56, v56, v57
    v_cvt_pk_bf16_f32 v57, v58, v59
    v_mfma_f32_16x16x32_bf16 v[160:163], a[168:171], a[48:51], 0
    ds_write_b64 v218, v[56:57] offset:6144
    v_cvt_pk_bf16_f32 v60, v60, v61
    v_mfma_f32_16x16x32_bf16 v[160:163], a[172:175], a[52:55], v[160:163]
    v_fma_f32 v186, v158, s25, -v194
    v_fma_f32 v187, v159, s25, -v194
    v_cvt_pk_bf16_f32 v61, v62, v63
    v_mfma_f32_16x16x32_bf16 v[160:163], a[176:179], a[56:59], v[160:163]
    ds_write_b64 v219, v[60:61] offset:6144
    v_exp_f32 v186, v186
    v_pk_mul_f32 v[64:65], v[64:65], v[236:237] op_sel_hi:[1,0]
    v_pk_mul_f32 v[66:67], v[66:67], v[236:237] op_sel_hi:[1,0]
    v_pk_mul_f32 v[68:69], v[68:69], v[236:237] op_sel_hi:[1,0]
    v_pk_mul_f32 v[70:71], v[70:71], v[236:237] op_sel_hi:[1,0]
    v_pk_mul_f32 v[72:73], v[72:73], v[236:237] op_sel_hi:[1,0]
    v_pk_mul_f32 v[74:75], v[74:75], v[236:237] op_sel_hi:[1,0]
    v_pk_mul_f32 v[76:77], v[76:77], v[236:237] op_sel_hi:[1,0]
    v_pk_mul_f32 v[78:79], v[78:79], v[236:237] op_sel_hi:[1,0]
    v_mfma_f32_16x16x32_bf16 v[160:163], a[180:183], a[60:63], v[160:163]
    v_mfma_f32_16x16x32_bf16 v[160:163], a[184:187], a[64:67], v[160:163]
    v_cvt_pk_bf16_f32 v174, v184, v185
    v_exp_f32 v187, v187
    v_cvt_pk_bf16_f32 v64, v64, v65
    v_cvt_pk_bf16_f32 v65, v66, v67
    v_mfma_f32_16x16x32_bf16 v[160:163], a[188:191], a[68:71], v[160:163]
    ds_write_b64 v220, v[64:65] offset:6144
    v_cvt_pk_bf16_f32 v68, v68, v69
    v_cvt_pk_bf16_f32 v69, v70, v71
    v_mfma_f32_16x16x32_bf16 v[164:167], a[192:195], a[48:51], 0
    ds_write_b64 v221, v[68:69] offset:6144
    v_or3_b32 v188, v172, v173, v174
    v_cvt_pk_bf16_f32 v175, v186, v187
    v_cvt_pk_bf16_f32 v72, v72, v73
    v_cvt_pk_bf16_f32 v73, v74, v75
    v_mfma_f32_16x16x32_bf16 v[164:167], a[196:199], a[52:55], v[164:167]
    ds_write_b64 v222, v[72:73] offset:6144
    v_bitop3_b32 v188, v188, v175, s26 bitop3:0xa8
    v_cvt_pk_bf16_f32 v76, v76, v77
    v_mfma_f32_16x16x32_bf16 v[164:167], a[200:203], a[56:59], v[164:167]
    v_cmp_ne_u32 vcc, 0, v188
    v_cvt_pk_bf16_f32 v77, v78, v79
    v_mfma_f32_16x16x32_bf16 v[164:167], a[204:207], a[60:63], v[164:167]
    ds_write_b64 v223, v[76:77] offset:6144
    v_pk_mul_f32 v[80:81], v[80:81], v[236:237] op_sel_hi:[1,0]
    v_pk_mul_f32 v[82:83], v[82:83], v[236:237] op_sel_hi:[1,0]
    v_pk_mul_f32 v[84:85], v[84:85], v[236:237] op_sel_hi:[1,0]
    v_pk_mul_f32 v[86:87], v[86:87], v[236:237] op_sel_hi:[1,0]
    v_pk_mul_f32 v[88:89], v[88:89], v[236:237] op_sel_hi:[1,0]
    v_pk_mul_f32 v[90:91], v[90:91], v[236:237] op_sel_hi:[1,0]
    v_pk_mul_f32 v[92:93], v[92:93], v[236:237] op_sel_hi:[1,0]
    v_pk_mul_f32 v[94:95], v[94:95], v[236:237] op_sel_hi:[1,0]
    v_mfma_f32_16x16x32_bf16 v[164:167], a[208:211], a[64:67], v[164:167]
    v_mfma_f32_16x16x32_bf16 v[164:167], a[212:215], a[68:71], v[164:167]
    s_cbranch_vccnz Z_rare_ee
Z_back_ee:
    v_cvt_pk_bf16_f32 v80, v80, v81
    v_cvt_pk_bf16_f32 v81, v82, v83
    v_mfma_f32_16x16x32_bf16 v[240:243], a[216:219], v[172:175], v[240:243]
    ds_write_b64 v224, v[80:81] offset:6144
    v_fma_f32 v180, v160, s25, -v194
    v_fma_f32 v181, v161, s25, -v194
    v_exp_f32 v180, v180
    v_cvt_pk_bf16_f32 v84, v84, v85
    v_cvt_pk_bf16_f32 v85, v86, v87
    v_mfma_f32_16x16x32_bf16 v[96:99], a[120:123], v[172:175], v[96:99]
    ds_read_b64_tr_b16 a[120:121], v197 offset:12288
    ds_read_b64_tr_b16 a[122:123], v197 offset:18432
    ds_write_b64 v225, v[84:85] offset:6144
    v_exp_f32 v181, v181
    v_fma_f32 v182, v162, s25, -v194
    v_cvt_pk_bf16_f32 v88, v88, v89
    v_cvt_pk_bf16_f32 v89, v90, v91
    v_mfma_f32_16x16x32_bf16 v[100:103], a[124:127], v[172:175], v[100:103]
    ds_read_b64_tr_b16 a[124:125], v198 offset:12288
    ds_read_b64_tr_b16 a[126:127], v198 offset:18432
    ds_write_b64 v226, v[88:89] offset:6144
    v_fma_f32 v183, v163, s25, -v194
    v_exp_f32 v182, v182
    v_cvt_pk_bf16_f32 v92, v92, v93
    v_mfma_f32_16x16x32_bf16 v[104:107], a[128:131], v[172:175], v[104:107]
    ds_read_b64_tr_b16 a[128:129], v199 offset:12288
    ds_read_b64_tr_b16 a[130:131], v199 offset:18432
    v_exp_f32 v183, v183
    v_cvt_pk_bf16_f32 v176, v180, v181
    v_cvt_pk_bf16_f32 v93, v94, v95
    v_mfma_f32_16x16x32_bf16 v[108:111], a[132:135], v[172:175], v[108:111]
    ds_read_b64_tr_b16 a[132:133], v200 offset:12288
    ds_read_b64_tr_b16 a[134:135], v200 offset:18432
    ds_write_b64 v227, v[92:93] offset:6144
    v_fma_f32 v184, v164, s25, -v194
    v_fma_f32 v185, v165, s25, -v194
    v_exp_f32 v184, v184
    v_mfma_f32_16x16x32_bf16 v[112:115], a[136:139], v[172:175], v[112:115]
    ds_read_b64_tr_b16 a[136:137], v197 offset:12416
    ds_read_b64_tr_b16 a[138:139], v197 offset:18560
    ds_read_b128 v[48:51], v208 offset:6144
    ds_read_b128 v[52:55], v208 offset:7168
    v_cvt_pk_bf16_f32 v177, v182, v183
    v_exp_f32 v185, v185
    s_add_u32 s27, s45, 6144
    s_add_u32 s28, s45, 9216
    v_mfma_f32_16x16x32_bf16 v[116:119], a[140:143], v[172:175], v[116:119]
    ds_read_b64_tr_b16 a[140:141], v198 offset:12416
    ds_read_b64_tr_b16 a[142:143], v198 offset:18560
    ds_read_b128 v[56:59], v208 offset:8192
    ds_read_b128 v[60:63], v208 offset:9216
    v_fma_f32 v186, v166, s25, -v194
    v_fma_f32 v187, v167, s25, -v194
    v_mfma_f32_16x16x32_bf16 v[120:123], a[144:147], v[172:175], v[120:123]
    ds_read_b64_tr_b16 a[144:145], v199 offset:12416
    ds_read_b64_tr_b16 a[146:147], v199 offset:18560
    ds_read_b128 v[64:67], v208 offset:10240
    ds_read_b128 v[68:71], v208 offset:11264
    v_exp_f32 v186, v186
    v_cvt_pk_bf16_f32 v178, v184, v185
    v_mfma_f32_16x16x32_bf16 v[124:127], a[148:151], v[172:175], v[124:127]
    ds_read_b64_tr_b16 a[148:149], v200 offset:12416
    ds_read_b64_tr_b16 a[150:151], v200 offset:18560
    v_exp_f32 v187, v187
    v_or3_b32 v188, v176, v177, v178
    v_mfma_f32_16x16x32_bf16 v[128:131], a[152:155], v[172:175], v[128:131]
    ds_read_b64_tr_b16 a[152:153], v197 offset:12544
    ds_read_b64_tr_b16 a[154:155], v197 offset:18688
    v_cvt_pk_bf16_f32 v179, v186, v187
    v_bitop3_b32 v188, v188, v179, s26 bitop3:0xa8
    v_cmp_ne_u32 vcc, 0, v188
    v_mfma_f32_16x16x32_bf16 v[132:135], a[156:159], v[172:175], v[132:135]
    ds_read_b64_tr_b16 a[156:157], v198 offset:12544
    ds_read_b64_tr_b16 a[158:159], v198 offset:18688
    v_mfma_f32_16x16x32_bf16 v[136:139], a[160:163], v[172:175], v[136:139]
    ds_read_b64_tr_b16 a[160:161], v199 offset:12544
    ds_read_b64_tr_b16 a[162:163], v199 offset:18688
    v_mfma_f32_16x16x32_bf16 v[140:143], a[164:167], v[172:175], v[140:143]
    s_cbranch_vccnz Z_rare_ef
Z_back_ef:
    ds_read_b64_tr_b16 a[164:165], v200 offset:12544
    ds_read_b64_tr_b16 a[166:167], v200 offset:18688
    v_mfma_f32_16x16x32_bf16 v[240:243], a[216:219], v[176:179], v[240:243]
    s_waitcnt lgkmcnt(10)
    v_mfma_f32_16x16x32_bf16 v[96:99], a[120:123], v[176:179], v[96:99]
    s_nop 0
    buffer_store_dwordx4 v[48:51], v209, s[16:19], s27 offen offset:0 nt
    v_mfma_f32_16x16x32_bf16 v[100:103], a[124:127], v[176:179], v[100:103]
    s_nop 2
    v_rcp_f32 v240, v240
    v_mfma_f32_16x16x32_bf16 v[104:107], a[128:131], v[176:179], v[104:107]
    s_nop 0
    buffer_store_dwordx4 v[52:55], v209, s[16:19], s27 offen offset:1024 nt
    v_mul_f32 v96, v96, v240
    v_mul_f32 v97, v97, v240
    v_mul_f32 v98, v98, v240
    v_mul_f32 v99, v99, v240
    v_cvt_pk_bf16_f32 v96, v96, v97
    v_cvt_pk_bf16_f32 v97, v98, v99
    v_mfma_f32_16x16x32_bf16 v[108:111], a[132:135], v[176:179], v[108:111]
    ds_write_b64 v216, v[96:97] offset:12288
    v_mul_f32 v100, v100, v240
    v_mul_f32 v101, v101, v240
    v_mul_f32 v102, v102, v240
    v_mul_f32 v103, v103, v240
    v_cvt_pk_bf16_f32 v100, v100, v101
    v_cvt_pk_bf16_f32 v101, v102, v103
    v_mfma_f32_16x16x32_bf16 v[112:115], a[136:139], v[176:179], v[112:115]
    s_nop 0
    buffer_store_dwordx4 v[56:59], v209, s[16:19], s27 offen offset:2048 nt
    ds_write_b64 v217, v[100:101] offset:12288
    v_mul_f32 v104, v104, v240
    v_mul_f32 v105, v105, v240
    v_mul_f32 v106, v106, v240
    v_mul_f32 v107, v107, v240
    v_cvt_pk_bf16_f32 v104, v104, v105
    v_cvt_pk_bf16_f32 v105, v106, v107
    v_mfma_f32_16x16x32_bf16 v[116:119], a[140:143], v[176:179], v[116:119]
    ds_write_b64 v218, v[104:105] offset:12288
    v_mul_f32 v108, v108, v240
    v_mul_f32 v109, v109, v240
    v_mul_f32 v110, v110, v240
    v_mul_f32 v111, v111, v240
    v_cvt_pk_bf16_f32 v108, v108, v109
    v_cvt_pk_bf16_f32 v109, v110, v111
    v_mfma_f32_16x16x32_bf16 v[120:123], a[144:147], v[176:179], v[120:123]
    s_waitcnt lgkmcnt(3)
    buffer_store_dwordx4 v[60:63], v209, s[16:19], s28 offen offset:0 nt
    ds_write_b64 v219, v[108:109] offset:12288
    v_mul_f32 v112, v112, v240
    v_mul_f32 v113, v113, v240
    v_mul_f32 v114, v114, v240
    v_mul_f32 v115, v115, v240
    v_cvt_pk_bf16_f32 v112, v112, v113
    v_cvt_pk_bf16_f32 v113, v114, v115
    v_mfma_f32_16x16x32_bf16 v[124:127], a[148:151], v[176:179], v[124:127]
    ds_write_b64 v220, v[112:113] offset:12288
    v_mul_f32 v116, v116, v240
    v_mul_f32 v117, v117, v240
    v_mul_f32 v118, v118, v240
    v_mul_f32 v119, v119, v240
    v_cvt_pk_bf16_f32 v116, v116, v117
    v_cvt_pk_bf16_f32 v117, v118, v119
    v_mfma_f32_16x16x32_bf16 v[128:131], a[152:155], v[176:179], v[128:131]
    s_nop 0
    buffer_store_dwordx4 v[64:67], v209, s[16:19], s28 offen offset:1024 nt
    ds_write_b64 v221, v[116:117] offset:12288
    v_mul_f32 v120, v120, v240
    v_mul_f32 v121, v121, v240
    v_mul_f32 v122, v122, v240
    v_mul_f32 v123, v123, v240
    v_cvt_pk_bf16_f32 v120, v120, v121
    v_cvt_pk_bf16_f32 v121, v122, v123
    v_mfma_f32_16x16x32_bf16 v[132:135], a[156:159], v[176:179], v[132:135]
    ds_write_b64 v222, v[120:121] offset:12288
    v_mul_f32 v124, v124, v240
    v_mul_f32 v125, v125, v240
    v_mul_f32 v126, v126, v240
    v_mul_f32 v127, v127, v240
    v_cvt_pk_bf16_f32 v124, v124, v125
    v_cvt_pk_bf16_f32 v125, v126, v127
    v_mfma_f32_16x16x32_bf16 v[136:139], a[160:163], v[176:179], v[136:139]
    s_nop 0
    buffer_store_dwordx4 v[68:71], v209, s[16:19], s28 offen offset:2048 nt
    ds_write_b64 v223, v[124:125] offset:12288
    v_mul_f32 v128, v128, v240
    v_mul_f32 v129, v129, v240
    v_mul_f32 v130, v130, v240
    v_mul_f32 v131, v131, v240
    v_cvt_pk_bf16_f32 v128, v128, v129
    v_cvt_pk_bf16_f32 v129, v130, v131
    v_mfma_f32_16x16x32_bf16 v[140:143], a[164:167], v[176:179], v[140:143]
    ds_write_b64 v224, v[128:129] offset:12288
    v_mul_f32 v132, v132, v240
    v_mul_f32 v133, v133, v240
    v_mul_f32 v134, v134, v240
    v_mul_f32 v135, v135, v240
    v_cvt_pk_bf16_f32 v132, v132, v133
    v_cvt_pk_bf16_f32 v133, v134, v135
    ds_write_b64 v225, v[132:133] offset:12288
    v_pk_mul_f32 v[136:137], v[136:137], v[240:241] op_sel_hi:[1,0]
    v_pk_mul_f32 v[138:139], v[138:139], v[240:241] op_sel_hi:[1,0]
    v_cvt_pk_bf16_f32 v136, v136, v137
    v_cvt_pk_bf16_f32 v137, v138, v139
    ds_write_b64 v226, v[136:137] offset:12288
    v_pk_mul_f32 v[140:141], v[140:141], v[240:241] op_sel_hi:[1,0]
    v_pk_mul_f32 v[142:143], v[142:143], v[240:241] op_sel_hi:[1,0]
    v_cvt_pk_bf16_f32 v140, v140, v141
    v_cvt_pk_bf16_f32 v141, v142, v143
    ds_write_b64 v227, v[140:141] offset:12288
    ds_read_b128 v[96:99], v208 offset:12288
    ds_read_b128 v[100:103], v208 offset:13312
    ds_read_b128 v[104:107], v208 offset:14336
    ds_read_b128 v[108:111], v208 offset:15360
    ds_read_b128 v[112:115], v208 offset:16384
    ds_read_b128 v[116:119], v208 offset:17408
    s_add_u32 s27, s45, 12288
    s_add_u32 s28, s45, 15360
    s_waitcnt lgkmcnt(5)
    buffer_store_dwordx4 v[96:99], v209, s[16:19], s27 offen offset:0 nt
    s_waitcnt lgkmcnt(4)
    buffer_store_dwordx4 v[100:103], v209, s[16:19], s27 offen offset:1024 nt
    s_waitcnt lgkmcnt(3)
    buffer_store_dwordx4 v[104:107], v209, s[16:19], s27 offen offset:2048 nt
    s_waitcnt lgkmcnt(2)
    buffer_store_dwordx4 v[108:111], v209, s[16:19], s28 offen offset:0 nt
    s_waitcnt lgkmcnt(1)
    buffer_store_dwordx4 v[112:115], v209, s[16:19], s28 offen offset:1024 nt
    s_waitcnt lgkmcnt(0)
    buffer_store_dwordx4 v[116:119], v209, s[16:19], s28 offen offset:2048 nt
Z_end:
    s_endpgm
Z_rare_l0b2:
    v_max3_f32 v244, v160, v161, v162
    v_max3_f32 v244, v244, v163, v164
    v_max3_f32 v244, v244, v165, v166
    v_max_f32 v244, v244, v167
    v_mov_b32 v245, v244
    s_nop 1
    v_permlane32_swap_b32 v244, v245
    v_max_f32 v244, v244, v245
    v_mov_b32 v245, v244
    s_nop 1
    v_permlane16_swap_b32 v244, v245
    v_max_f32 v244, v244, v245
    v_mul_f32 v244, s25, v244
    v_add_f32 v244, 0x41100000, v244
    v_max_f32 v244, v244, v194
    v_sub_f32 v246, v194, v244
    v_exp_f32 v246, v246
    v_mov_b32 v194, v244
    v_pk_mul_f32 v[240:241], v[240:241], v[246:247] op_sel_hi:[1,0]
    v_pk_mul_f32 v[242:243], v[242:243], v[246:247] op_sel_hi:[1,0]
    v_pk_mul_f32 v[96:97], v[96:97], v[246:247] op_sel_hi:[1,0]
    v_pk_mul_f32 v[98:99], v[98:99], v[246:247] op_sel_hi:[1,0]
    v_pk_mul_f32 v[100:101], v[100:101], v[246:247] op_sel_hi:[1,0]
    v_pk_mul_f32 v[102:103], v[102:103], v[246:247] op_sel_hi:[1,0]
    v_pk_mul_f32 v[104:105], v[104:105], v[246:247] op_sel_hi:[1,0]
    v_pk_mul_f32 v[106:107], v[106:107], v[246:247] op_sel_hi:[1,0]
    v_pk_mul_f32 v[108:109], v[108:109], v[246:247] op_sel_hi:[1,0]
    v_pk_mul_f32 v[110:111], v[110:111], v[246:247] op_sel_hi:[1,0]
    v_pk_mul_f32 v[112:113], v[112:113], v[246:247] op_sel_hi:[1,0]
    v_pk_mul_f32 v[114:115], v[114:115], v[246:247] op_sel_hi:[1,0]
    v_pk_mul_f32 v[116:117], v[116:117], v[246:247] op_sel_hi:[1,0]
    v_pk_mul_f32 v[118:119], v[118:119], v[246:247] op_sel_hi:[1,0]
    v_pk_mul_f32 v[120:121], v[120:121], v[246:247] op_sel_hi:[1,0]
    v_pk_mul_f32 v[122:123], v[122:123], v[246:247] op_sel_hi:[1,0]
    v_pk_mul_f32 v[124:125], v[124:125], v[246:247] op_sel_hi:[1,0]
    v_pk_mul_f32 v[126:127], v[126:127], v[246:247] op_sel_hi:[1,0]
    v_pk_mul_f32 v[128:129], v[128:129], v[246:247] op_sel_hi:[1,0]
    v_pk_mul_f32 v[130:131], v[130:131], v[246:247] op_sel_hi:[1,0]
    v_pk_mul_f32 v[132:133], v[132:133], v[246:247] op_sel_hi:[1,0]
    v_pk_mul_f32 v[134:135], v[134:135], v[246:247] op_sel_hi:[1,0]
    v_pk_mul_f32 v[136:137], v[136:137], v[246:247] op_sel_hi:[1,0]
    v_pk_mul_f32 v[138:139], v[138:139], v[246:247] op_sel_hi:[1,0]
    v_pk_mul_f32 v[140:141], v[140:141], v[246:247] op_sel_hi:[1,0]
    v_pk_mul_f32 v[142:143], v[142:143], v[246:247] op_sel_hi:[1,0]
    v_fma_f32 v180, v160, s25, -v194
    v_fma_f32 v181, v161, s25, -v194
    v_exp_f32 v180, v180
    v_exp_f32 v181, v181
    v_fma_f32 v182, v162, s25, -v194
    v_fma_f32 v183, v163, s25, -v194
    v_exp_f32 v182, v182
    v_exp_f32 v183, v183
    v_cvt_pk_bf16_f32 v176, v180, v181
    v_fma_f32 v184, v164, s25, -v194
    v_fma_f32 v185, v165, s25, -v194
    v_exp_f32 v184, v184
    v_cvt_pk_bf16_f32 v177, v182, v183
    v_exp_f32 v185, v185
    v_fma_f32 v186, v166, s25, -v194
    v_fma_f32 v187, v167, s25, -v194
    v_exp_f32 v186, v186
    v_cvt_pk_bf16_f32 v178, v184, v185
    v_exp_f32 v187, v187
    s_nop 0
    v_cvt_pk_bf16_f32 v179, v186, v187
    s_nop 1
    s_branch Z_back_l0b2
Z_rare_l0b0:
    v_max3_f32 v244, v144, v145, v146
    v_max3_f32 v244, v244, v147, v148
    v_max3_f32 v244, v244, v149, v150
    v_max_f32 v244, v244, v151
    v_mov_b32 v245, v244
    s_nop 1
    v_permlane32_swap_b32 v244, v245
    v_max_f32 v244, v244, v245
    v_mov_b32 v245, v244
    s_nop 1
    v_permlane16_swap_b32 v244, v245
    v_max_f32 v244, v244, v245
    v_mul_f32 v244, s25, v244
    v_add_f32 v244, 0x41100000, v244
    v_max_f32 v244, v244, v192
    v_sub_f32 v246, v192, v244
    v_exp_f32 v246, v246
    v_mov_b32 v192, v244
    v_pk_mul_f32 v[232:233], v[232:233], v[246:247] op_sel_hi:[1,0]
    v_pk_mul_f32 v[234:235], v[234:235], v[246:247] op_sel_hi:[1,0]
    v_pk_mul_f32 v[0:1], v[0:1], v[246:247] op_sel_hi:[1,0]
    v_pk_mul_f32 v[2:3], v[2:3], v[246:247] op_sel_hi:[1,0]
    v_pk_mul_f32 v[4:5], v[4:5], v[246:247] op_sel_hi:[1,0]
    v_pk_mul_f32 v[6:7], v[6:7], v[246:247] op_sel_hi:[1,0]
    v_pk_mul_f32 v[8:9], v[8:9], v[246:247] op_sel_hi:[1,0]
    v_pk_mul_f32 v[10:11], v[10:11], v[246:247] op_sel_hi:[1,0]
    v_pk_mul_f32 v[12:13], v[12:13], v[246:247] op_sel_hi:[1,0]
    v_pk_mul_f32 v[14:15], v[14:15], v[246:247] op_sel_hi:[1,0]
    v_pk_mul_f32 v[16:17], v[16:17], v[246:247] op_sel_hi:[1,0]
    v_pk_mul_f32 v[18:19], v[18:19], v[246:247] op_sel_hi:[1,0]
    v_pk_mul_f32 v[20:21], v[20:21], v[246:247] op_sel_hi:[1,0]
    v_pk_mul_f32 v[22:23], v[22:23], v[246:247] op_sel_hi:[1,0]
    v_pk_mul_f32 v[24:25], v[24:25], v[246:247] op_sel_hi:[1,0]
    v_pk_mul_f32 v[26:27], v[26:27], v[246:247] op_sel_hi:[1,0]
    v_pk_mul_f32 v[28:29], v[28:29], v[246:247] op_sel_hi:[1,0]
    v_pk_mul_f32 v[30:31], v[30:31], v[246:247] op_sel_hi:[1,0]
    v_pk_mul_f32 v[32:33], v[32:33], v[246:247] op_sel_hi:[1,0]
    v_pk_mul_f32 v[34:35], v[34:35], v[246:247] op_sel_hi:[1,0]
    v_pk_mul_f32 v[36:37], v[36:37], v[246:247] op_sel_hi:[1,0]
    v_pk_mul_f32 v[38:39], v[38:39], v[246:247] op_sel_hi:[1,0]
    v_pk_mul_f32 v[40:41], v[40:41], v[246:247] op_sel_hi:[1,0]
    v_pk_mul_f32 v[42:43], v[42:43], v[246:247] op_sel_hi:[1,0]
    v_pk_mul_f32 v[44:45], v[44:45], v[246:247] op_sel_hi:[1,0]
    v_pk_mul_f32 v[46:47], v[46:47], v[246:247] op_sel_hi:[1,0]
    v_fma_f32 v180, v144, s25, -v192
    v_fma_f32 v181, v145, s25, -v192
    v_exp_f32 v180, v180
    v_exp_f32 v181, v181
    v_fma_f32 v182, v146, s25, -v192
    v_fma_f32 v183, v147, s25, -v192
    v_exp_f32 v182, v182
    v_exp_f32 v183, v183
    v_cvt_pk_bf16_f32 v168, v180, v181
    v_fma_f32 v184, v148, s25, -v192
    v_fma_f32 v185, v149, s25, -v192
    v_exp_f32 v184, v184
    v_cvt_pk_bf16_f32 v169, v182, v183
    v_exp_f32 v185, v185
    v_fma_f32 v186, v150, s25, -v192
    v_fma_f32 v187, v151, s25, -v192
    v_exp_f32 v186, v186
    v_cvt_pk_bf16_f32 v170, v184, v185
    v_exp_f32 v187, v187
    s_nop 0
    v_cvt_pk_bf16_f32 v171, v186, v187
    s_nop 1
    s_branch Z_back_l0b0
Z_rare_l0b1:
    v_max3_f32 v244, v152, v153, v154
    v_max3_f32 v244, v244, v155, v156
    v_max3_f32 v244, v244, v157, v158
    v_max_f32 v244, v244, v159
    v_mov_b32 v245, v244
    s_nop 1
    v_permlane32_swap_b32 v244, v245
    v_max_f32 v244, v244, v245
    v_mov_b32 v245, v244
    s_nop 1
    v_permlane16_swap_b32 v244, v245
    v_max_f32 v244, v244, v245
    v_mul_f32 v244, s25, v244
    v_add_f32 v244, 0x41100000, v244
    v_max_f32 v244, v244, v193
    v_sub_f32 v246, v193, v244
    v_exp_f32 v246, v246
    v_mov_b32 v193, v244
    v_pk_mul_f32 v[236:237], v[236:237], v[246:247] op_sel_hi:[1,0]
    v_pk_mul_f32 v[238:239], v[238:239], v[246:247] op_sel_hi:[1,0]
    v_pk_mul_f32 v[48:49], v[48:49], v[246:247] op_sel_hi:[1,0]
    v_pk_mul_f32 v[50:51], v[50:51], v[246:247] op_sel_hi:[1,0]
    v_pk_mul_f32 v[52:53], v[52:53], v[246:247] op_sel_hi:[1,0]
    v_pk_mul_f32 v[54:55], v[54:55], v[246:247] op_sel_hi:[1,0]
    v_pk_mul_f32 v[56:57], v[56:57], v[246:247] op_sel_hi:[1,0]
    v_pk_mul_f32 v[58:59], v[58:59], v[246:247] op_sel_hi:[1,0]
    v_pk_mul_f32 v[60:61], v[60:61], v[246:247] op_sel_hi:[1,0]
    v_pk_mul_f32 v[62:63], v[62:63], v[246:247] op_sel_hi:[1,0]
    v_pk_mul_f32 v[64:65], v[64:65], v[246:247] op_sel_hi:[1,0]
    v_pk_mul_f32 v[66:67], v[66:67], v[246:247] op_sel_hi:[1,0]
    v_pk_mul_f32 v[68:69], v[68:69], v[246:247] op_sel_hi:[1,0]
    v_pk_mul_f32 v[70:71], v[70:71], v[246:247] op_sel_hi:[1,0]
    v_pk_mul_f32 v[72:73], v[72:73], v[246:247] op_sel_hi:[1,0]
    v_pk_mul_f32 v[74:75], v[74:75], v[246:247] op_sel_hi:[1,0]
    v_pk_mul_f32 v[76:77], v[76:77], v[246:247] op_sel_hi:[1,0]
    v_pk_mul_f32 v[78:79], v[78:79], v[246:247] op_sel_hi:[1,0]
    v_pk_mul_f32 v[80:81], v[80:81], v[246:247] op_sel_hi:[1,0]
    v_pk_mul_f32 v[82:83], v[82:83], v[246:247] op_sel_hi:[1,0]
    v_pk_mul_f32 v[84:85], v[84:85], v[246:247] op_sel_hi:[1,0]
    v_pk_mul_f32 v[86:87], v[86:87], v[246:247] op_sel_hi:[1,0]
    v_pk_mul_f32 v[88:89], v[88:89], v[246:247] op_sel_hi:[1,0]
    v_pk_mul_f32 v[90:91], v[90:91], v[246:247] op_sel_hi:[1,0]
    v_pk_mul_f32 v[92:93], v[92:93], v[246:247] op_sel_hi:[1,0]
    v_pk_mul_f32 v[94:95], v[94:95], v[246:247] op_sel_hi:[1,0]
    v_fma_f32 v180, v152, s25, -v193
    v_fma_f32 v181, v153, s25, -v193
    v_exp_f32 v180, v180
    v_exp_f32 v181, v181
    v_fma_f32 v182, v154, s25, -v193
    v_fma_f32 v183, v155, s25, -v193
    v_exp_f32 v182, v182
    v_exp_f32 v183, v183
    v_cvt_pk_bf16_f32 v172, v180, v181
    v_fma_f32 v184, v156, s25, -v193
    v_fma_f32 v185, v157, s25, -v193
    v_exp_f32 v184, v184
    v_cvt_pk_bf16_f32 v173, v182, v183
    v_exp_f32 v185, v185
    v_fma_f32 v186, v158, s25, -v193
    v_fma_f32 v187, v159, s25, -v193
    v_exp_f32 v186, v186
    v_cvt_pk_bf16_f32 v174, v184, v185
    v_exp_f32 v187, v187
    s_nop 0
    v_cvt_pk_bf16_f32 v175, v186, v187
    s_nop 1
    s_branch Z_back_l0b1
Z_rare_l0c2:
    v_max3_f32 v244, v160, v161, v162
    v_max3_f32 v244, v244, v163, v164
    v_max3_f32 v244, v244, v165, v166
    v_max_f32 v244, v244, v167
    v_mov_b32 v245, v244
    s_nop 1
    v_permlane32_swap_b32 v244, v245
    v_max_f32 v244, v244, v245
    v_mov_b32 v245, v244
    s_nop 1
    v_permlane16_swap_b32 v244, v245
    v_max_f32 v244, v244, v245
    v_mul_f32 v244, s25, v244
    v_add_f32 v244, 0x41100000, v244
    v_max_f32 v244, v244, v194
    v_sub_f32 v246, v194, v244
    v_exp_f32 v246, v246
    v_mov_b32 v194, v244
    v_pk_mul_f32 v[240:241], v[240:241], v[246:247] op_sel_hi:[1,0]
    v_pk_mul_f32 v[242:243], v[242:243], v[246:247] op_sel_hi:[1,0]
    v_pk_mul_f32 v[96:97], v[96:97], v[246:247] op_sel_hi:[1,0]
    v_pk_mul_f32 v[98:99], v[98:99], v[246:247] op_sel_hi:[1,0]
    v_pk_mul_f32 v[100:101], v[100:101], v[246:247] op_sel_hi:[1,0]
    v_pk_mul_f32 v[102:103], v[102:103], v[246:247] op_sel_hi:[1,0]
    v_pk_mul_f32 v[104:105], v[104:105], v[246:247] op_sel_hi:[1,0]
    v_pk_mul_f32 v[106:107], v[106:107], v[246:247] op_sel_hi:[1,0]
    v_pk_mul_f32 v[108:109], v[108:109], v[246:247] op_sel_hi:[1,0]
    v_pk_mul_f32 v[110:111], v[110:111], v[246:247] op_sel_hi:[1,0]
    v_pk_mul_f32 v[112:113], v[112:113], v[246:247] op_sel_hi:[1,0]
    v_pk_mul_f32 v[114:115], v[114:115], v[246:247] op_sel_hi:[1,0]
    v_pk_mul_f32 v[116:117], v[116:117], v[246:247] op_sel_hi:[1,0]
    v_pk_mul_f32 v[118:119], v[118:119], v[246:247] op_sel_hi:[1,0]
    v_pk_mul_f32 v[120:121], v[120:121], v[246:247] op_sel_hi:[1,0]
    v_pk_mul_f32 v[122:123], v[122:123], v[246:247] op_sel_hi:[1,0]
    v_pk_mul_f32 v[124:125], v[124:125], v[246:247] op_sel_hi:[1,0]
    v_pk_mul_f32 v[126:127], v[126:127], v[246:247] op_sel_hi:[1,0]
    v_pk_mul_f32 v[128:129], v[128:129], v[246:247] op_sel_hi:[1,0]
    v_pk_mul_f32 v[130:131], v[130:131], v[246:247] op_sel_hi:[1,0]
    v_pk_mul_f32 v[132:133], v[132:133], v[246:247] op_sel_hi:[1,0]
    v_pk_mul_f32 v[134:135], v[134:135], v[246:247] op_sel_hi:[1,0]
    v_pk_mul_f32 v[136:137], v[136:137], v[246:247] op_sel_hi:[1,0]
    v_pk_mul_f32 v[138:139], v[138:139], v[246:247] op_sel_hi:[1,0]
    v_pk_mul_f32 v[140:141], v[140:141], v[246:247] op_sel_hi:[1,0]
    v_pk_mul_f32 v[142:143], v[142:143], v[246:247] op_sel_hi:[1,0]
    v_fma_f32 v180, v160, s25, -v194
    v_fma_f32 v181, v161, s25, -v194
    v_exp_f32 v180, v180
    v_exp_f32 v181, v181
    v_fma_f32 v182, v162, s25, -v194
    v_fma_f32 v183, v163, s25, -v194
    v_exp_f32 v182, v182
    v_exp_f32 v183, v183
    v_cvt_pk_bf16_f32 v176, v180, v181
    v_fma_f32 v184, v164, s25, -v194
    v_fma_f32 v185, v165, s25, -v194
    v_exp_f32 v184, v184
    v_cvt_pk_bf16_f32 v177, v182, v183
    v_exp_f32 v185, v185
    v_fma_f32 v186, v166, s25, -v194
    v_fma_f32 v187, v167, s25, -v194
    v_exp_f32 v186, v186
    v_cvt_pk_bf16_f32 v178, v184, v185
    v_exp_f32 v187, v187
    s_nop 0
    v_cvt_pk_bf16_f32 v179, v186, v187
    s_nop 1
    s_branch Z_back_l0c2
Z_rare_l0c0:
    v_max3_f32 v244, v144, v145, v146
    v_max3_f32 v244, v244, v147, v148
    v_max3_f32 v244, v244, v149, v150
    v_max_f32 v244, v244, v151
    v_mov_b32 v245, v244
    s_nop 1
    v_permlane32_swap_b32 v244, v245
    v_max_f32 v244, v244, v245
    v_mov_b32 v245, v244
    s_nop 1
    v_permlane16_swap_b32 v244, v245
    v_max_f32 v244, v244, v245
    v_mul_f32 v244, s25, v244
    v_add_f32 v244, 0x41100000, v244
    v_max_f32 v244, v244, v192
    v_sub_f32 v246, v192, v244
    v_exp_f32 v246, v246
    v_mov_b32 v192, v244
    v_pk_mul_f32 v[232:233], v[232:233], v[246:247] op_sel_hi:[1,0]
    v_pk_mul_f32 v[234:235], v[234:235], v[246:247] op_sel_hi:[1,0]
    v_pk_mul_f32 v[0:1], v[0:1], v[246:247] op_sel_hi:[1,0]
    v_pk_mul_f32 v[2:3], v[2:3], v[246:247] op_sel_hi:[1,0]
    v_pk_mul_f32 v[4:5], v[4:5], v[246:247] op_sel_hi:[1,0]
    v_pk_mul_f32 v[6:7], v[6:7], v[246:247] op_sel_hi:[1,0]
    v_pk_mul_f32 v[8:9], v[8:9], v[246:247] op_sel_hi:[1,0]
    v_pk_mul_f32 v[10:11], v[10:11], v[246:247] op_sel_hi:[1,0]
    v_pk_mul_f32 v[12:13], v[12:13], v[246:247] op_sel_hi:[1,0]
    v_pk_mul_f32 v[14:15], v[14:15], v[246:247] op_sel_hi:[1,0]
    v_pk_mul_f32 v[16:17], v[16:17], v[246:247] op_sel_hi:[1,0]
    v_pk_mul_f32 v[18:19], v[18:19], v[246:247] op_sel_hi:[1,0]
    v_pk_mul_f32 v[20:21], v[20:21], v[246:247] op_sel_hi:[1,0]
    v_pk_mul_f32 v[22:23], v[22:23], v[246:247] op_sel_hi:[1,0]
    v_pk_mul_f32 v[24:25], v[24:25], v[246:247] op_sel_hi:[1,0]
    v_pk_mul_f32 v[26:27], v[26:27], v[246:247] op_sel_hi:[1,0]
    v_pk_mul_f32 v[28:29], v[28:29], v[246:247] op_sel_hi:[1,0]
    v_pk_mul_f32 v[30:31], v[30:31], v[246:247] op_sel_hi:[1,0]
    v_pk_mul_f32 v[32:33], v[32:33], v[246:247] op_sel_hi:[1,0]
    v_pk_mul_f32 v[34:35], v[34:35], v[246:247] op_sel_hi:[1,0]
    v_pk_mul_f32 v[36:37], v[36:37], v[246:247] op_sel_hi:[1,0]
    v_pk_mul_f32 v[38:39], v[38:39], v[246:247] op_sel_hi:[1,0]
    v_pk_mul_f32 v[40:41], v[40:41], v[246:247] op_sel_hi:[1,0]
    v_pk_mul_f32 v[42:43], v[42:43], v[246:247] op_sel_hi:[1,0]
    v_pk_mul_f32 v[44:45], v[44:45], v[246:247] op_sel_hi:[1,0]
    v_pk_mul_f32 v[46:47], v[46:47], v[246:247] op_sel_hi:[1,0]
    v_fma_f32 v180, v144, s25, -v192
    v_fma_f32 v181, v145, s25, -v192
    v_exp_f32 v180, v180
    v_exp_f32 v181, v181
    v_fma_f32 v182, v146, s25, -v192
    v_fma_f32 v183, v147, s25, -v192
    v_exp_f32 v182, v182
    v_exp_f32 v183, v183
    v_cvt_pk_bf16_f32 v168, v180, v181
    v_fma_f32 v184, v148, s25, -v192
    v_fma_f32 v185, v149, s25, -v192
    v_exp_f32 v184, v184
    v_cvt_pk_bf16_f32 v169, v182, v183
    v_exp_f32 v185, v185
    v_fma_f32 v186, v150, s25, -v192
    v_fma_f32 v187, v151, s25, -v192
    v_exp_f32 v186, v186
    v_cvt_pk_bf16_f32 v170, v184, v185
    v_exp_f32 v187, v187
    s_nop 0
    v_cvt_pk_bf16_f32 v171, v186, v187
    s_nop 1
    s_branch Z_back_l0c0
Z_rare_l0c1:
    v_max3_f32 v244, v152, v153, v154
    v_max3_f32 v244, v244, v155, v156
    v_max3_f32 v244, v244, v157, v158
    v_max_f32 v244, v244, v159
    v_mov_b32 v245, v244
    s_nop 1
    v_permlane32_swap_b32 v244, v245
    v_max_f32 v244, v244, v245
    v_mov_b32 v245, v244
    s_nop 1
    v_permlane16_swap_b32 v244, v245
    v_max_f32 v244, v244, v245
    v_mul_f32 v244, s25, v244
    v_add_f32 v244, 0x41100000, v244
    v_max_f32 v244, v244, v193
    v_sub_f32 v246, v193, v244
    v_exp_f32 v246, v246
    v_mov_b32 v193, v244
    v_pk_mul_f32 v[236:237], v[236:237], v[246:247] op_sel_hi:[1,0]
    v_pk_mul_f32 v[238:239], v[238:239], v[246:247] op_sel_hi:[1,0]
    v_pk_mul_f32 v[48:49], v[48:49], v[246:247] op_sel_hi:[1,0]
    v_pk_mul_f32 v[50:51], v[50:51], v[246:247] op_sel_hi:[1,0]
    v_pk_mul_f32 v[52:53], v[52:53], v[246:247] op_sel_hi:[1,0]
    v_pk_mul_f32 v[54:55], v[54:55], v[246:247] op_sel_hi:[1,0]
    v_pk_mul_f32 v[56:57], v[56:57], v[246:247] op_sel_hi:[1,0]
    v_pk_mul_f32 v[58:59], v[58:59], v[246:247] op_sel_hi:[1,0]
    v_pk_mul_f32 v[60:61], v[60:61], v[246:247] op_sel_hi:[1,0]
    v_pk_mul_f32 v[62:63], v[62:63], v[246:247] op_sel_hi:[1,0]
    v_pk_mul_f32 v[64:65], v[64:65], v[246:247] op_sel_hi:[1,0]
    v_pk_mul_f32 v[66:67], v[66:67], v[246:247] op_sel_hi:[1,0]
    v_pk_mul_f32 v[68:69], v[68:69], v[246:247] op_sel_hi:[1,0]
    v_pk_mul_f32 v[70:71], v[70:71], v[246:247] op_sel_hi:[1,0]
    v_pk_mul_f32 v[72:73], v[72:73], v[246:247] op_sel_hi:[1,0]
    v_pk_mul_f32 v[74:75], v[74:75], v[246:247] op_sel_hi:[1,0]
    v_pk_mul_f32 v[76:77], v[76:77], v[246:247] op_sel_hi:[1,0]
    v_pk_mul_f32 v[78:79], v[78:79], v[246:247] op_sel_hi:[1,0]
    v_pk_mul_f32 v[80:81], v[80:81], v[246:247] op_sel_hi:[1,0]
    v_pk_mul_f32 v[82:83], v[82:83], v[246:247] op_sel_hi:[1,0]
    v_pk_mul_f32 v[84:85], v[84:85], v[246:247] op_sel_hi:[1,0]
    v_pk_mul_f32 v[86:87], v[86:87], v[246:247] op_sel_hi:[1,0]
    v_pk_mul_f32 v[88:89], v[88:89], v[246:247] op_sel_hi:[1,0]
    v_pk_mul_f32 v[90:91], v[90:91], v[246:247] op_sel_hi:[1,0]
    v_pk_mul_f32 v[92:93], v[92:93], v[246:247] op_sel_hi:[1,0]
    v_pk_mul_f32 v[94:95], v[94:95], v[246:247] op_sel_hi:[1,0]
    v_fma_f32 v180, v152, s25, -v193
    v_fma_f32 v181, v153, s25, -v193
    v_exp_f32 v180, v180
    v_exp_f32 v181, v181
    v_fma_f32 v182, v154, s25, -v193
    v_fma_f32 v183, v155, s25, -v193
    v_exp_f32 v182, v182
    v_exp_f32 v183, v183
    v_cvt_pk_bf16_f32 v172, v180, v181
    v_fma_f32 v184, v156, s25, -v193
    v_fma_f32 v185, v157, s25, -v193
    v_exp_f32 v184, v184
    v_cvt_pk_bf16_f32 v173, v182, v183
    v_exp_f32 v185, v185
    v_fma_f32 v186, v158, s25, -v193
    v_fma_f32 v187, v159, s25, -v193
    v_exp_f32 v186, v186
    v_cvt_pk_bf16_f32 v174, v184, v185
    v_exp_f32 v187, v187
    s_nop 0
    v_cvt_pk_bf16_f32 v175, v186, v187
    s_nop 1
    s_branch Z_back_l0c1
Z_rare_l0a2:
    v_max3_f32 v244, v160, v161, v162
    v_max3_f32 v244, v244, v163, v164
    v_max3_f32 v244, v244, v165, v166
    v_max_f32 v244, v244, v167
    v_mov_b32 v245, v244
    s_nop 1
    v_permlane32_swap_b32 v244, v245
    v_max_f32 v244, v244, v245
    v_mov_b32 v245, v244
    s_nop 1
    v_permlane16_swap_b32 v244, v245
    v_max_f32 v244, v244, v245
    v_mul_f32 v244, s25, v244
    v_add_f32 v244, 0x41100000, v244
    v_max_f32 v244, v244, v194
    v_sub_f32 v246, v194, v244
    v_exp_f32 v246, v246
    v_mov_b32 v194, v244
    v_pk_mul_f32 v[240:241], v[240:241], v[246:247] op_sel_hi:[1,0]
    v_pk_mul_f32 v[242:243], v[242:243], v[246:247] op_sel_hi:[1,0]
    v_pk_mul_f32 v[96:97], v[96:97], v[246:247] op_sel_hi:[1,0]
    v_pk_mul_f32 v[98:99], v[98:99], v[246:247] op_sel_hi:[1,0]
    v_pk_mul_f32 v[100:101], v[100:101], v[246:247] op_sel_hi:[1,0]
    v_pk_mul_f32 v[102:103], v[102:103], v[246:247] op_sel_hi:[1,0]
    v_pk_mul_f32 v[104:105], v[104:105], v[246:247] op_sel_hi:[1,0]
    v_pk_mul_f32 v[106:107], v[106:107], v[246:247] op_sel_hi:[1,0]
    v_pk_mul_f32 v[108:109], v[108:109], v[246:247] op_sel_hi:[1,0]
    v_pk_mul_f32 v[110:111], v[110:111], v[246:247] op_sel_hi:[1,0]
    v_pk_mul_f32 v[112:113], v[112:113], v[246:247] op_sel_hi:[1,0]
    v_pk_mul_f32 v[114:115], v[114:115], v[246:247] op_sel_hi:[1,0]
    v_pk_mul_f32 v[116:117], v[116:117], v[246:247] op_sel_hi:[1,0]
    v_pk_mul_f32 v[118:119], v[118:119], v[246:247] op_sel_hi:[1,0]
    v_pk_mul_f32 v[120:121], v[120:121], v[246:247] op_sel_hi:[1,0]
    v_pk_mul_f32 v[122:123], v[122:123], v[246:247] op_sel_hi:[1,0]
    v_pk_mul_f32 v[124:125], v[124:125], v[246:247] op_sel_hi:[1,0]
    v_pk_mul_f32 v[126:127], v[126:127], v[246:247] op_sel_hi:[1,0]
    v_pk_mul_f32 v[128:129], v[128:129], v[246:247] op_sel_hi:[1,0]
    v_pk_mul_f32 v[130:131], v[130:131], v[246:247] op_sel_hi:[1,0]
    v_pk_mul_f32 v[132:133], v[132:133], v[246:247] op_sel_hi:[1,0]
    v_pk_mul_f32 v[134:135], v[134:135], v[246:247] op_sel_hi:[1,0]
    v_pk_mul_f32 v[136:137], v[136:137], v[246:247] op_sel_hi:[1,0]
    v_pk_mul_f32 v[138:139], v[138:139], v[246:247] op_sel_hi:[1,0]
    v_pk_mul_f32 v[140:141], v[140:141], v[246:247] op_sel_hi:[1,0]
    v_pk_mul_f32 v[142:143], v[142:143], v[246:247] op_sel_hi:[1,0]
    v_fma_f32 v180, v160, s25, -v194
    v_fma_f32 v181, v161, s25, -v194
    v_exp_f32 v180, v180
    v_exp_f32 v181, v181
    v_fma_f32 v182, v162, s25, -v194
    v_fma_f32 v183, v163, s25, -v194
    v_exp_f32 v182, v182
    v_exp_f32 v183, v183
    v_cvt_pk_bf16_f32 v176, v180, v181
    v_fma_f32 v184, v164, s25, -v194
    v_fma_f32 v185, v165, s25, -v194
    v_exp_f32 v184, v184
    v_cvt_pk_bf16_f32 v177, v182, v183
    v_exp_f32 v185, v185
    v_fma_f32 v186, v166, s25, -v194
    v_fma_f32 v187, v167, s25, -v194
    v_exp_f32 v186, v186
    v_cvt_pk_bf16_f32 v178, v184, v185
    v_exp_f32 v187, v187
    s_nop 0
    v_cvt_pk_bf16_f32 v179, v186, v187
    s_nop 1
    s_branch Z_back_l0a2
Z_rare_l0a0:
    v_max3_f32 v244, v144, v145, v146
    v_max3_f32 v244, v244, v147, v148
    v_max3_f32 v244, v244, v149, v150
    v_max_f32 v244, v244, v151
    v_mov_b32 v245, v244
    s_nop 1
    v_permlane32_swap_b32 v244, v245
    v_max_f32 v244, v244, v245
    v_mov_b32 v245, v244
    s_nop 1
    v_permlane16_swap_b32 v244, v245
    v_max_f32 v244, v244, v245
    v_mul_f32 v244, s25, v244
    v_add_f32 v244, 0x41100000, v244
    v_max_f32 v244, v244, v192
    v_sub_f32 v246, v192, v244
    v_exp_f32 v246, v246
    v_mov_b32 v192, v244
    v_pk_mul_f32 v[232:233], v[232:233], v[246:247] op_sel_hi:[1,0]
    v_pk_mul_f32 v[234:235], v[234:235], v[246:247] op_sel_hi:[1,0]
    v_pk_mul_f32 v[0:1], v[0:1], v[246:247] op_sel_hi:[1,0]
    v_pk_mul_f32 v[2:3], v[2:3], v[246:247] op_sel_hi:[1,0]
    v_pk_mul_f32 v[4:5], v[4:5], v[246:247] op_sel_hi:[1,0]
    v_pk_mul_f32 v[6:7], v[6:7], v[246:247] op_sel_hi:[1,0]
    v_pk_mul_f32 v[8:9], v[8:9], v[246:247] op_sel_hi:[1,0]
    v_pk_mul_f32 v[10:11], v[10:11], v[246:247] op_sel_hi:[1,0]
    v_pk_mul_f32 v[12:13], v[12:13], v[246:247] op_sel_hi:[1,0]
    v_pk_mul_f32 v[14:15], v[14:15], v[246:247] op_sel_hi:[1,0]
    v_pk_mul_f32 v[16:17], v[16:17], v[246:247] op_sel_hi:[1,0]
    v_pk_mul_f32 v[18:19], v[18:19], v[246:247] op_sel_hi:[1,0]
    v_pk_mul_f32 v[20:21], v[20:21], v[246:247] op_sel_hi:[1,0]
    v_pk_mul_f32 v[22:23], v[22:23], v[246:247] op_sel_hi:[1,0]
    v_pk_mul_f32 v[24:25], v[24:25], v[246:247] op_sel_hi:[1,0]
    v_pk_mul_f32 v[26:27], v[26:27], v[246:247] op_sel_hi:[1,0]
    v_pk_mul_f32 v[28:29], v[28:29], v[246:247] op_sel_hi:[1,0]
    v_pk_mul_f32 v[30:31], v[30:31], v[246:247] op_sel_hi:[1,0]
    v_pk_mul_f32 v[32:33], v[32:33], v[246:247] op_sel_hi:[1,0]
    v_pk_mul_f32 v[34:35], v[34:35], v[246:247] op_sel_hi:[1,0]
    v_pk_mul_f32 v[36:37], v[36:37], v[246:247] op_sel_hi:[1,0]
    v_pk_mul_f32 v[38:39], v[38:39], v[246:247] op_sel_hi:[1,0]
    v_pk_mul_f32 v[40:41], v[40:41], v[246:247] op_sel_hi:[1,0]
    v_pk_mul_f32 v[42:43], v[42:43], v[246:247] op_sel_hi:[1,0]
    v_pk_mul_f32 v[44:45], v[44:45], v[246:247] op_sel_hi:[1,0]
    v_pk_mul_f32 v[46:47], v[46:47], v[246:247] op_sel_hi:[1,0]
    v_fma_f32 v180, v144, s25, -v192
    v_fma_f32 v181, v145, s25, -v192
    v_exp_f32 v180, v180
    v_exp_f32 v181, v181
    v_fma_f32 v182, v146, s25, -v192
    v_fma_f32 v183, v147, s25, -v192
    v_exp_f32 v182, v182
    v_exp_f32 v183, v183
    v_cvt_pk_bf16_f32 v168, v180, v181
    v_fma_f32 v184, v148, s25, -v192
    v_fma_f32 v185, v149, s25, -v192
    v_exp_f32 v184, v184
    v_cvt_pk_bf16_f32 v169, v182, v183
    v_exp_f32 v185, v185
    v_fma_f32 v186, v150, s25, -v192
    v_fma_f32 v187, v151, s25, -v192
    v_exp_f32 v186, v186
    v_cvt_pk_bf16_f32 v170, v184, v185
    v_exp_f32 v187, v187
    s_nop 0
    v_cvt_pk_bf16_f32 v171, v186, v187
    s_nop 1
    s_branch Z_back_l0a0
Z_rare_l0a1:
    v_max3_f32 v244, v152, v153, v154
    v_max3_f32 v244, v244, v155, v156
    v_max3_f32 v244, v244, v157, v158
    v_max_f32 v244, v244, v159
    v_mov_b32 v245, v244
    s_nop 1
    v_permlane32_swap_b32 v244, v245
    v_max_f32 v244, v244, v245
    v_mov_b32 v245, v244
    s_nop 1
    v_permlane16_swap_b32 v244, v245
    v_max_f32 v244, v244, v245
    v_mul_f32 v244, s25, v244
    v_add_f32 v244, 0x41100000, v244
    v_max_f32 v244, v244, v193
    v_sub_f32 v246, v193, v244
    v_exp_f32 v246, v246
    v_mov_b32 v193, v244
    v_pk_mul_f32 v[236:237], v[236:237], v[246:247] op_sel_hi:[1,0]
    v_pk_mul_f32 v[238:239], v[238:239], v[246:247] op_sel_hi:[1,0]
    v_pk_mul_f32 v[48:49], v[48:49], v[246:247] op_sel_hi:[1,0]
    v_pk_mul_f32 v[50:51], v[50:51], v[246:247] op_sel_hi:[1,0]
    v_pk_mul_f32 v[52:53], v[52:53], v[246:247] op_sel_hi:[1,0]
    v_pk_mul_f32 v[54:55], v[54:55], v[246:247] op_sel_hi:[1,0]
    v_pk_mul_f32 v[56:57], v[56:57], v[246:247] op_sel_hi:[1,0]
    v_pk_mul_f32 v[58:59], v[58:59], v[246:247] op_sel_hi:[1,0]
    v_pk_mul_f32 v[60:61], v[60:61], v[246:247] op_sel_hi:[1,0]
    v_pk_mul_f32 v[62:63], v[62:63], v[246:247] op_sel_hi:[1,0]
    v_pk_mul_f32 v[64:65], v[64:65], v[246:247] op_sel_hi:[1,0]
    v_pk_mul_f32 v[66:67], v[66:67], v[246:247] op_sel_hi:[1,0]
    v_pk_mul_f32 v[68:69], v[68:69], v[246:247] op_sel_hi:[1,0]
    v_pk_mul_f32 v[70:71], v[70:71], v[246:247] op_sel_hi:[1,0]
    v_pk_mul_f32 v[72:73], v[72:73], v[246:247] op_sel_hi:[1,0]
    v_pk_mul_f32 v[74:75], v[74:75], v[246:247] op_sel_hi:[1,0]
    v_pk_mul_f32 v[76:77], v[76:77], v[246:247] op_sel_hi:[1,0]
    v_pk_mul_f32 v[78:79], v[78:79], v[246:247] op_sel_hi:[1,0]
    v_pk_mul_f32 v[80:81], v[80:81], v[246:247] op_sel_hi:[1,0]
    v_pk_mul_f32 v[82:83], v[82:83], v[246:247] op_sel_hi:[1,0]
    v_pk_mul_f32 v[84:85], v[84:85], v[246:247] op_sel_hi:[1,0]
    v_pk_mul_f32 v[86:87], v[86:87], v[246:247] op_sel_hi:[1,0]
    v_pk_mul_f32 v[88:89], v[88:89], v[246:247] op_sel_hi:[1,0]
    v_pk_mul_f32 v[90:91], v[90:91], v[246:247] op_sel_hi:[1,0]
    v_pk_mul_f32 v[92:93], v[92:93], v[246:247] op_sel_hi:[1,0]
    v_pk_mul_f32 v[94:95], v[94:95], v[246:247] op_sel_hi:[1,0]
    v_fma_f32 v180, v152, s25, -v193
    v_fma_f32 v181, v153, s25, -v193
    v_exp_f32 v180, v180
    v_exp_f32 v181, v181
    v_fma_f32 v182, v154, s25, -v193
    v_fma_f32 v183, v155, s25, -v193
    v_exp_f32 v182, v182
    v_exp_f32 v183, v183
    v_cvt_pk_bf16_f32 v172, v180, v181
    v_fma_f32 v184, v156, s25, -v193
    v_fma_f32 v185, v157, s25, -v193
    v_exp_f32 v184, v184
    v_cvt_pk_bf16_f32 v173, v182, v183
    v_exp_f32 v185, v185
    v_fma_f32 v186, v158, s25, -v193
    v_fma_f32 v187, v159, s25, -v193
    v_exp_f32 v186, v186
    v_cvt_pk_bf16_f32 v174, v184, v185
    v_exp_f32 v187, v187
    s_nop 0
    v_cvt_pk_bf16_f32 v175, v186, v187
    s_nop 1
    s_branch Z_back_l0a1
Z_rare_m0a0:
    v_max3_f32 v244, v144, v145, v146
    v_max3_f32 v244, v244, v147, v148
    v_max3_f32 v244, v244, v149, v150
    v_max_f32 v244, v244, v151
    v_mov_b32 v245, v244
    s_nop 1
    v_permlane32_swap_b32 v244, v245
    v_max_f32 v244, v244, v245
    v_mov_b32 v245, v244
    s_nop 1
    v_permlane16_swap_b32 v244, v245
    v_max_f32 v244, v244, v245
    v_mul_f32 v244, s25, v244
    v_add_f32 v244, 0x41100000, v244
    v_max_f32 v244, v244, v192
    v_sub_f32 v246, v192, v244
    v_exp_f32 v246, v246
    v_mov_b32 v192, v244
    v_pk_mul_f32 v[232:233], v[232:233], v[246:247] op_sel_hi:[1,0]
    v_pk_mul_f32 v[234:235], v[234:235], v[246:247] op_sel_hi:[1,0]
    v_pk_mul_f32 v[0:1], v[0:1], v[246:247] op_sel_hi:[1,0]
    v_pk_mul_f32 v[2:3], v[2:3], v[246:247] op_sel_hi:[1,0]
    v_pk_mul_f32 v[4:5], v[4:5], v[246:247] op_sel_hi:[1,0]
    v_pk_mul_f32 v[6:7], v[6:7], v[246:247] op_sel_hi:[1,0]
    v_pk_mul_f32 v[8:9], v[8:9], v[246:247] op_sel_hi:[1,0]
    v_pk_mul_f32 v[10:11], v[10:11], v[246:247] op_sel_hi:[1,0]
    v_pk_mul_f32 v[12:13], v[12:13], v[246:247] op_sel_hi:[1,0]
    v_pk_mul_f32 v[14:15], v[14:15], v[246:247] op_sel_hi:[1,0]
    v_pk_mul_f32 v[16:17], v[16:17], v[246:247] op_sel_hi:[1,0]
    v_pk_mul_f32 v[18:19], v[18:19], v[246:247] op_sel_hi:[1,0]
    v_pk_mul_f32 v[20:21], v[20:21], v[246:247] op_sel_hi:[1,0]
    v_pk_mul_f32 v[22:23], v[22:23], v[246:247] op_sel_hi:[1,0]
    v_pk_mul_f32 v[24:25], v[24:25], v[246:247] op_sel_hi:[1,0]
    v_pk_mul_f32 v[26:27], v[26:27], v[246:247] op_sel_hi:[1,0]
    v_pk_mul_f32 v[28:29], v[28:29], v[246:247] op_sel_hi:[1,0]
    v_pk_mul_f32 v[30:31], v[30:31], v[246:247] op_sel_hi:[1,0]
    v_pk_mul_f32 v[32:33], v[32:33], v[246:247] op_sel_hi:[1,0]
    v_pk_mul_f32 v[34:35], v[34:35], v[246:247] op_sel_hi:[1,0]
    v_pk_mul_f32 v[36:37], v[36:37], v[246:247] op_sel_hi:[1,0]
    v_pk_mul_f32 v[38:39], v[38:39], v[246:247] op_sel_hi:[1,0]
    v_pk_mul_f32 v[40:41], v[40:41], v[246:247] op_sel_hi:[1,0]
    v_pk_mul_f32 v[42:43], v[42:43], v[246:247] op_sel_hi:[1,0]
    v_pk_mul_f32 v[44:45], v[44:45], v[246:247] op_sel_hi:[1,0]
    v_pk_mul_f32 v[46:47], v[46:47], v[246:247] op_sel_hi:[1,0]
    v_fma_f32 v180, v144, s25, -v192
    v_fma_f32 v181, v145, s25, -v192
    v_exp_f32 v180, v180
    v_exp_f32 v181, v181
    v_fma_f32 v182, v146, s25, -v192
    v_fma_f32 v183, v147, s25, -v192
    v_exp_f32 v182, v182
    v_exp_f32 v183, v183
    v_cvt_pk_bf16_f32 v168, v180, v181
    v_fma_f32 v184, v148, s25, -v192
    v_fma_f32 v185, v149, s25, -v192
    v_exp_f32 v184, v184
    v_cvt_pk_bf16_f32 v169, v182, v183
    v_exp_f32 v185, v185
    v_fma_f32 v186, v150, s25, -v192
    v_fma_f32 v187, v151, s25, -v192
    v_exp_f32 v186, v186
    v_cvt_pk_bf16_f32 v170, v184, v185
    v_exp_f32 v187, v187
    s_nop 0
    v_cvt_pk_bf16_f32 v171, v186, v187
    s_nop 1
    s_branch Z_back_m0a0
Z_rare_m0a1:
    v_max3_f32 v244, v152, v153, v154
    v_max3_f32 v244, v244, v155, v156
    v_max3_f32 v244, v244, v157, v158
    v_max_f32 v244, v244, v159
    v_mov_b32 v245, v244
    s_nop 1
    v_permlane32_swap_b32 v244, v245
    v_max_f32 v244, v244, v245
    v_mov_b32 v245, v244
    s_nop 1
    v_permlane16_swap_b32 v244, v245
    v_max_f32 v244, v244, v245
    v_mul_f32 v244, s25, v244
    v_add_f32 v244, 0x41100000, v244
    v_max_f32 v244, v244, v193
    v_sub_f32 v246, v193, v244
    v_exp_f32 v246, v246
    v_mov_b32 v193, v244
    v_pk_mul_f32 v[236:237], v[236:237], v[246:247] op_sel_hi:[1,0]
    v_pk_mul_f32 v[238:239], v[238:239], v[246:247] op_sel_hi:[1,0]
    v_pk_mul_f32 v[48:49], v[48:49], v[246:247] op_sel_hi:[1,0]
    v_pk_mul_f32 v[50:51], v[50:51], v[246:247] op_sel_hi:[1,0]
    v_pk_mul_f32 v[52:53], v[52:53], v[246:247] op_sel_hi:[1,0]
    v_pk_mul_f32 v[54:55], v[54:55], v[246:247] op_sel_hi:[1,0]
    v_pk_mul_f32 v[56:57], v[56:57], v[246:247] op_sel_hi:[1,0]
    v_pk_mul_f32 v[58:59], v[58:59], v[246:247] op_sel_hi:[1,0]
    v_pk_mul_f32 v[60:61], v[60:61], v[246:247] op_sel_hi:[1,0]
    v_pk_mul_f32 v[62:63], v[62:63], v[246:247] op_sel_hi:[1,0]
    v_pk_mul_f32 v[64:65], v[64:65], v[246:247] op_sel_hi:[1,0]
    v_pk_mul_f32 v[66:67], v[66:67], v[246:247] op_sel_hi:[1,0]
    v_pk_mul_f32 v[68:69], v[68:69], v[246:247] op_sel_hi:[1,0]
    v_pk_mul_f32 v[70:71], v[70:71], v[246:247] op_sel_hi:[1,0]
    v_pk_mul_f32 v[72:73], v[72:73], v[246:247] op_sel_hi:[1,0]
    v_pk_mul_f32 v[74:75], v[74:75], v[246:247] op_sel_hi:[1,0]
    v_pk_mul_f32 v[76:77], v[76:77], v[246:247] op_sel_hi:[1,0]
    v_pk_mul_f32 v[78:79], v[78:79], v[246:247] op_sel_hi:[1,0]
    v_pk_mul_f32 v[80:81], v[80:81], v[246:247] op_sel_hi:[1,0]
    v_pk_mul_f32 v[82:83], v[82:83], v[246:247] op_sel_hi:[1,0]
    v_pk_mul_f32 v[84:85], v[84:85], v[246:247] op_sel_hi:[1,0]
    v_pk_mul_f32 v[86:87], v[86:87], v[246:247] op_sel_hi:[1,0]
    v_pk_mul_f32 v[88:89], v[88:89], v[246:247] op_sel_hi:[1,0]
    v_pk_mul_f32 v[90:91], v[90:91], v[246:247] op_sel_hi:[1,0]
    v_pk_mul_f32 v[92:93], v[92:93], v[246:247] op_sel_hi:[1,0]
    v_pk_mul_f32 v[94:95], v[94:95], v[246:247] op_sel_hi:[1,0]
    v_fma_f32 v180, v152, s25, -v193
    v_fma_f32 v181, v153, s25, -v193
    v_exp_f32 v180, v180
    v_exp_f32 v181, v181
    v_fma_f32 v182, v154, s25, -v193
    v_fma_f32 v183, v155, s25, -v193
    v_exp_f32 v182, v182
    v_exp_f32 v183, v183
    v_cvt_pk_bf16_f32 v172, v180, v181
    v_fma_f32 v184, v156, s25, -v193
    v_fma_f32 v185, v157, s25, -v193
    v_exp_f32 v184, v184
    v_cvt_pk_bf16_f32 v173, v182, v183
    v_exp_f32 v185, v185
    v_fma_f32 v186, v158, s25, -v193
    v_fma_f32 v187, v159, s25, -v193
    v_exp_f32 v186, v186
    v_cvt_pk_bf16_f32 v174, v184, v185
    v_exp_f32 v187, v187
    s_nop 0
    v_cvt_pk_bf16_f32 v175, v186, v187
    s_nop 1
    s_branch Z_back_m0a1
Z_rare_m0b2:
    v_max3_f32 v244, v160, v161, v162
    v_max3_f32 v244, v244, v163, v164
    v_max3_f32 v244, v244, v165, v166
    v_max_f32 v244, v244, v167
    v_mov_b32 v245, v244
    s_nop 1
    v_permlane32_swap_b32 v244, v245
    v_max_f32 v244, v244, v245
    v_mov_b32 v245, v244
    s_nop 1
    v_permlane16_swap_b32 v244, v245
    v_max_f32 v244, v244, v245
    v_mul_f32 v244, s25, v244
    v_add_f32 v244, 0x41100000, v244
    v_max_f32 v244, v244, v194
    v_sub_f32 v246, v194, v244
    v_exp_f32 v246, v246
    v_mov_b32 v194, v244
    v_pk_mul_f32 v[240:241], v[240:241], v[246:247] op_sel_hi:[1,0]
    v_pk_mul_f32 v[242:243], v[242:243], v[246:247] op_sel_hi:[1,0]
    v_pk_mul_f32 v[96:97], v[96:97], v[246:247] op_sel_hi:[1,0]
    v_pk_mul_f32 v[98:99], v[98:99], v[246:247] op_sel_hi:[1,0]
    v_pk_mul_f32 v[100:101], v[100:101], v[246:247] op_sel_hi:[1,0]
    v_pk_mul_f32 v[102:103], v[102:103], v[246:247] op_sel_hi:[1,0]
    v_pk_mul_f32 v[104:105], v[104:105], v[246:247] op_sel_hi:[1,0]
    v_pk_mul_f32 v[106:107], v[106:107], v[246:247] op_sel_hi:[1,0]
    v_pk_mul_f32 v[108:109], v[108:109], v[246:247] op_sel_hi:[1,0]
    v_pk_mul_f32 v[110:111], v[110:111], v[246:247] op_sel_hi:[1,0]
    v_pk_mul_f32 v[112:113], v[112:113], v[246:247] op_sel_hi:[1,0]
    v_pk_mul_f32 v[114:115], v[114:115], v[246:247] op_sel_hi:[1,0]
    v_pk_mul_f32 v[116:117], v[116:117], v[246:247] op_sel_hi:[1,0]
    v_pk_mul_f32 v[118:119], v[118:119], v[246:247] op_sel_hi:[1,0]
    v_pk_mul_f32 v[120:121], v[120:121], v[246:247] op_sel_hi:[1,0]
    v_pk_mul_f32 v[122:123], v[122:123], v[246:247] op_sel_hi:[1,0]
    v_pk_mul_f32 v[124:125], v[124:125], v[246:247] op_sel_hi:[1,0]
    v_pk_mul_f32 v[126:127], v[126:127], v[246:247] op_sel_hi:[1,0]
    v_pk_mul_f32 v[128:129], v[128:129], v[246:247] op_sel_hi:[1,0]
    v_pk_mul_f32 v[130:131], v[130:131], v[246:247] op_sel_hi:[1,0]
    v_pk_mul_f32 v[132:133], v[132:133], v[246:247] op_sel_hi:[1,0]
    v_pk_mul_f32 v[134:135], v[134:135], v[246:247] op_sel_hi:[1,0]
    v_pk_mul_f32 v[136:137], v[136:137], v[246:247] op_sel_hi:[1,0]
    v_pk_mul_f32 v[138:139], v[138:139], v[246:247] op_sel_hi:[1,0]
    v_pk_mul_f32 v[140:141], v[140:141], v[246:247] op_sel_hi:[1,0]
    v_pk_mul_f32 v[142:143], v[142:143], v[246:247] op_sel_hi:[1,0]
    v_fma_f32 v180, v160, s25, -v194
    v_fma_f32 v181, v161, s25, -v194
    v_exp_f32 v180, v180
    v_exp_f32 v181, v181
    v_fma_f32 v182, v162, s25, -v194
    v_fma_f32 v183, v163, s25, -v194
    v_exp_f32 v182, v182
    v_exp_f32 v183, v183
    v_cvt_pk_bf16_f32 v176, v180, v181
    v_fma_f32 v184, v164, s25, -v194
    v_fma_f32 v185, v165, s25, -v194
    v_exp_f32 v184, v184
    v_cvt_pk_bf16_f32 v177, v182, v183
    v_exp_f32 v185, v185
    v_fma_f32 v186, v166, s25, -v194
    v_fma_f32 v187, v167, s25, -v194
    v_exp_f32 v186, v186
    v_cvt_pk_bf16_f32 v178, v184, v185
    v_exp_f32 v187, v187
    s_nop 0
    v_cvt_pk_bf16_f32 v179, v186, v187
    s_nop 1
    s_branch Z_back_m0b2
Z_rare_m0b0:
    v_max3_f32 v244, v144, v145, v146
    v_max3_f32 v244, v244, v147, v148
    v_max3_f32 v244, v244, v149, v150
    v_max_f32 v244, v244, v151
    v_mov_b32 v245, v244
    s_nop 1
    v_permlane32_swap_b32 v244, v245
    v_max_f32 v244, v244, v245
    v_mov_b32 v245, v244
    s_nop 1
    v_permlane16_swap_b32 v244, v245
    v_max_f32 v244, v244, v245
    v_mul_f32 v244, s25, v244
    v_add_f32 v244, 0x41100000, v244
    v_max_f32 v244, v244, v192
    v_sub_f32 v246, v192, v244
    v_exp_f32 v246, v246
    v_mov_b32 v192, v244
    v_pk_mul_f32 v[232:233], v[232:233], v[246:247] op_sel_hi:[1,0]
    v_pk_mul_f32 v[234:235], v[234:235], v[246:247] op_sel_hi:[1,0]
    v_pk_mul_f32 v[0:1], v[0:1], v[246:247] op_sel_hi:[1,0]
    v_pk_mul_f32 v[2:3], v[2:3], v[246:247] op_sel_hi:[1,0]
    v_pk_mul_f32 v[4:5], v[4:5], v[246:247] op_sel_hi:[1,0]
    v_pk_mul_f32 v[6:7], v[6:7], v[246:247] op_sel_hi:[1,0]
    v_pk_mul_f32 v[8:9], v[8:9], v[246:247] op_sel_hi:[1,0]
    v_pk_mul_f32 v[10:11], v[10:11], v[246:247] op_sel_hi:[1,0]
    v_pk_mul_f32 v[12:13], v[12:13], v[246:247] op_sel_hi:[1,0]
    v_pk_mul_f32 v[14:15], v[14:15], v[246:247] op_sel_hi:[1,0]
    v_pk_mul_f32 v[16:17], v[16:17], v[246:247] op_sel_hi:[1,0]
    v_pk_mul_f32 v[18:19], v[18:19], v[246:247] op_sel_hi:[1,0]
    v_pk_mul_f32 v[20:21], v[20:21], v[246:247] op_sel_hi:[1,0]
    v_pk_mul_f32 v[22:23], v[22:23], v[246:247] op_sel_hi:[1,0]
    v_pk_mul_f32 v[24:25], v[24:25], v[246:247] op_sel_hi:[1,0]
    v_pk_mul_f32 v[26:27], v[26:27], v[246:247] op_sel_hi:[1,0]
    v_pk_mul_f32 v[28:29], v[28:29], v[246:247] op_sel_hi:[1,0]
    v_pk_mul_f32 v[30:31], v[30:31], v[246:247] op_sel_hi:[1,0]
    v_pk_mul_f32 v[32:33], v[32:33], v[246:247] op_sel_hi:[1,0]
    v_pk_mul_f32 v[34:35], v[34:35], v[246:247] op_sel_hi:[1,0]
    v_pk_mul_f32 v[36:37], v[36:37], v[246:247] op_sel_hi:[1,0]
    v_pk_mul_f32 v[38:39], v[38:39], v[246:247] op_sel_hi:[1,0]
    v_pk_mul_f32 v[40:41], v[40:41], v[246:247] op_sel_hi:[1,0]
    v_pk_mul_f32 v[42:43], v[42:43], v[246:247] op_sel_hi:[1,0]
    v_pk_mul_f32 v[44:45], v[44:45], v[246:247] op_sel_hi:[1,0]
    v_pk_mul_f32 v[46:47], v[46:47], v[246:247] op_sel_hi:[1,0]
    v_fma_f32 v180, v144, s25, -v192
    v_fma_f32 v181, v145, s25, -v192
    v_exp_f32 v180, v180
    v_exp_f32 v181, v181
    v_fma_f32 v182, v146, s25, -v192
    v_fma_f32 v183, v147, s25, -v192
    v_exp_f32 v182, v182
    v_exp_f32 v183, v183
    v_cvt_pk_bf16_f32 v168, v180, v181
    v_fma_f32 v184, v148, s25, -v192
    v_fma_f32 v185, v149, s25, -v192
    v_exp_f32 v184, v184
    v_cvt_pk_bf16_f32 v169, v182, v183
    v_exp_f32 v185, v185
    v_fma_f32 v186, v150, s25, -v192
    v_fma_f32 v187, v151, s25, -v192
    v_exp_f32 v186, v186
    v_cvt_pk_bf16_f32 v170, v184, v185
    v_exp_f32 v187, v187
    s_nop 0
    v_cvt_pk_bf16_f32 v171, v186, v187
    s_nop 1
    s_branch Z_back_m0b0
Z_rare_m0b1:
    v_max3_f32 v244, v152, v153, v154
    v_max3_f32 v244, v244, v155, v156
    v_max3_f32 v244, v244, v157, v158
    v_max_f32 v244, v244, v159
    v_mov_b32 v245, v244
    s_nop 1
    v_permlane32_swap_b32 v244, v245
    v_max_f32 v244, v244, v245
    v_mov_b32 v245, v244
    s_nop 1
    v_permlane16_swap_b32 v244, v245
    v_max_f32 v244, v244, v245
    v_mul_f32 v244, s25, v244
    v_add_f32 v244, 0x41100000, v244
    v_max_f32 v244, v244, v193
    v_sub_f32 v246, v193, v244
    v_exp_f32 v246, v246
    v_mov_b32 v193, v244
    v_pk_mul_f32 v[236:237], v[236:237], v[246:247] op_sel_hi:[1,0]
    v_pk_mul_f32 v[238:239], v[238:239], v[246:247] op_sel_hi:[1,0]
    v_pk_mul_f32 v[48:49], v[48:49], v[246:247] op_sel_hi:[1,0]
    v_pk_mul_f32 v[50:51], v[50:51], v[246:247] op_sel_hi:[1,0]
    v_pk_mul_f32 v[52:53], v[52:53], v[246:247] op_sel_hi:[1,0]
    v_pk_mul_f32 v[54:55], v[54:55], v[246:247] op_sel_hi:[1,0]
    v_pk_mul_f32 v[56:57], v[56:57], v[246:247] op_sel_hi:[1,0]
    v_pk_mul_f32 v[58:59], v[58:59], v[246:247] op_sel_hi:[1,0]
    v_pk_mul_f32 v[60:61], v[60:61], v[246:247] op_sel_hi:[1,0]
    v_pk_mul_f32 v[62:63], v[62:63], v[246:247] op_sel_hi:[1,0]
    v_pk_mul_f32 v[64:65], v[64:65], v[246:247] op_sel_hi:[1,0]
    v_pk_mul_f32 v[66:67], v[66:67], v[246:247] op_sel_hi:[1,0]
    v_pk_mul_f32 v[68:69], v[68:69], v[246:247] op_sel_hi:[1,0]
    v_pk_mul_f32 v[70:71], v[70:71], v[246:247] op_sel_hi:[1,0]
    v_pk_mul_f32 v[72:73], v[72:73], v[246:247] op_sel_hi:[1,0]
    v_pk_mul_f32 v[74:75], v[74:75], v[246:247] op_sel_hi:[1,0]
    v_pk_mul_f32 v[76:77], v[76:77], v[246:247] op_sel_hi:[1,0]
    v_pk_mul_f32 v[78:79], v[78:79], v[246:247] op_sel_hi:[1,0]
    v_pk_mul_f32 v[80:81], v[80:81], v[246:247] op_sel_hi:[1,0]
    v_pk_mul_f32 v[82:83], v[82:83], v[246:247] op_sel_hi:[1,0]
    v_pk_mul_f32 v[84:85], v[84:85], v[246:247] op_sel_hi:[1,0]
    v_pk_mul_f32 v[86:87], v[86:87], v[246:247] op_sel_hi:[1,0]
    v_pk_mul_f32 v[88:89], v[88:89], v[246:247] op_sel_hi:[1,0]
    v_pk_mul_f32 v[90:91], v[90:91], v[246:247] op_sel_hi:[1,0]
    v_pk_mul_f32 v[92:93], v[92:93], v[246:247] op_sel_hi:[1,0]
    v_pk_mul_f32 v[94:95], v[94:95], v[246:247] op_sel_hi:[1,0]
    v_fma_f32 v180, v152, s25, -v193
    v_fma_f32 v181, v153, s25, -v193
    v_exp_f32 v180, v180
    v_exp_f32 v181, v181
    v_fma_f32 v182, v154, s25, -v193
    v_fma_f32 v183, v155, s25, -v193
    v_exp_f32 v182, v182
    v_exp_f32 v183, v183
    v_cvt_pk_bf16_f32 v172, v180, v181
    v_fma_f32 v184, v156, s25, -v193
    v_fma_f32 v185, v157, s25, -v193
    v_exp_f32 v184, v184
    v_cvt_pk_bf16_f32 v173, v182, v183
    v_exp_f32 v185, v185
    v_fma_f32 v186, v158, s25, -v193
    v_fma_f32 v187, v159, s25, -v193
    v_exp_f32 v186, v186
    v_cvt_pk_bf16_f32 v174, v184, v185
    v_exp_f32 v187, v187
    s_nop 0
    v_cvt_pk_bf16_f32 v175, v186, v187
    s_nop 1
    s_branch Z_back_m0b1
Z_rare_m0c2:
    v_max3_f32 v244, v160, v161, v162
    v_max3_f32 v244, v244, v163, v164
    v_max3_f32 v244, v244, v165, v166
    v_max_f32 v244, v244, v167
    v_mov_b32 v245, v244
    s_nop 1
    v_permlane32_swap_b32 v244, v245
    v_max_f32 v244, v244, v245
    v_mov_b32 v245, v244
    s_nop 1
    v_permlane16_swap_b32 v244, v245
    v_max_f32 v244, v244, v245
    v_mul_f32 v244, s25, v244
    v_add_f32 v244, 0x41100000, v244
    v_max_f32 v244, v244, v194
    v_sub_f32 v246, v194, v244
    v_exp_f32 v246, v246
    v_mov_b32 v194, v244
    v_pk_mul_f32 v[240:241], v[240:241], v[246:247] op_sel_hi:[1,0]
    v_pk_mul_f32 v[242:243], v[242:243], v[246:247] op_sel_hi:[1,0]
    v_pk_mul_f32 v[96:97], v[96:97], v[246:247] op_sel_hi:[1,0]
    v_pk_mul_f32 v[98:99], v[98:99], v[246:247] op_sel_hi:[1,0]
    v_pk_mul_f32 v[100:101], v[100:101], v[246:247] op_sel_hi:[1,0]
    v_pk_mul_f32 v[102:103], v[102:103], v[246:247] op_sel_hi:[1,0]
    v_pk_mul_f32 v[104:105], v[104:105], v[246:247] op_sel_hi:[1,0]
    v_pk_mul_f32 v[106:107], v[106:107], v[246:247] op_sel_hi:[1,0]
    v_pk_mul_f32 v[108:109], v[108:109], v[246:247] op_sel_hi:[1,0]
    v_pk_mul_f32 v[110:111], v[110:111], v[246:247] op_sel_hi:[1,0]
    v_pk_mul_f32 v[112:113], v[112:113], v[246:247] op_sel_hi:[1,0]
    v_pk_mul_f32 v[114:115], v[114:115], v[246:247] op_sel_hi:[1,0]
    v_pk_mul_f32 v[116:117], v[116:117], v[246:247] op_sel_hi:[1,0]
    v_pk_mul_f32 v[118:119], v[118:119], v[246:247] op_sel_hi:[1,0]
    v_pk_mul_f32 v[120:121], v[120:121], v[246:247] op_sel_hi:[1,0]
    v_pk_mul_f32 v[122:123], v[122:123], v[246:247] op_sel_hi:[1,0]
    v_pk_mul_f32 v[124:125], v[124:125], v[246:247] op_sel_hi:[1,0]
    v_pk_mul_f32 v[126:127], v[126:127], v[246:247] op_sel_hi:[1,0]
    v_pk_mul_f32 v[128:129], v[128:129], v[246:247] op_sel_hi:[1,0]
    v_pk_mul_f32 v[130:131], v[130:131], v[246:247] op_sel_hi:[1,0]
    v_pk_mul_f32 v[132:133], v[132:133], v[246:247] op_sel_hi:[1,0]
    v_pk_mul_f32 v[134:135], v[134:135], v[246:247] op_sel_hi:[1,0]
    v_pk_mul_f32 v[136:137], v[136:137], v[246:247] op_sel_hi:[1,0]
    v_pk_mul_f32 v[138:139], v[138:139], v[246:247] op_sel_hi:[1,0]
    v_pk_mul_f32 v[140:141], v[140:141], v[246:247] op_sel_hi:[1,0]
    v_pk_mul_f32 v[142:143], v[142:143], v[246:247] op_sel_hi:[1,0]
    v_fma_f32 v180, v160, s25, -v194
    v_fma_f32 v181, v161, s25, -v194
    v_exp_f32 v180, v180
    v_exp_f32 v181, v181
    v_fma_f32 v182, v162, s25, -v194
    v_fma_f32 v183, v163, s25, -v194
    v_exp_f32 v182, v182
    v_exp_f32 v183, v183
    v_cvt_pk_bf16_f32 v176, v180, v181
    v_fma_f32 v184, v164, s25, -v194
    v_fma_f32 v185, v165, s25, -v194
    v_exp_f32 v184, v184
    v_cvt_pk_bf16_f32 v177, v182, v183
    v_exp_f32 v185, v185
    v_fma_f32 v186, v166, s25, -v194
    v_fma_f32 v187, v167, s25, -v194
    v_exp_f32 v186, v186
    v_cvt_pk_bf16_f32 v178, v184, v185
    v_exp_f32 v187, v187
    s_nop 0
    v_cvt_pk_bf16_f32 v179, v186, v187
    s_nop 1
    s_branch Z_back_m0c2
Z_rare_m0c0:
    v_max3_f32 v244, v144, v145, v146
    v_max3_f32 v244, v244, v147, v148
    v_max3_f32 v244, v244, v149, v150
    v_max_f32 v244, v244, v151
    v_mov_b32 v245, v244
    s_nop 1
    v_permlane32_swap_b32 v244, v245
    v_max_f32 v244, v244, v245
    v_mov_b32 v245, v244
    s_nop 1
    v_permlane16_swap_b32 v244, v245
    v_max_f32 v244, v244, v245
    v_mul_f32 v244, s25, v244
    v_add_f32 v244, 0x41100000, v244
    v_max_f32 v244, v244, v192
    v_sub_f32 v246, v192, v244
    v_exp_f32 v246, v246
    v_mov_b32 v192, v244
    v_pk_mul_f32 v[232:233], v[232:233], v[246:247] op_sel_hi:[1,0]
    v_pk_mul_f32 v[234:235], v[234:235], v[246:247] op_sel_hi:[1,0]
    v_pk_mul_f32 v[0:1], v[0:1], v[246:247] op_sel_hi:[1,0]
    v_pk_mul_f32 v[2:3], v[2:3], v[246:247] op_sel_hi:[1,0]
    v_pk_mul_f32 v[4:5], v[4:5], v[246:247] op_sel_hi:[1,0]
    v_pk_mul_f32 v[6:7], v[6:7], v[246:247] op_sel_hi:[1,0]
    v_pk_mul_f32 v[8:9], v[8:9], v[246:247] op_sel_hi:[1,0]
    v_pk_mul_f32 v[10:11], v[10:11], v[246:247] op_sel_hi:[1,0]
    v_pk_mul_f32 v[12:13], v[12:13], v[246:247] op_sel_hi:[1,0]
    v_pk_mul_f32 v[14:15], v[14:15], v[246:247] op_sel_hi:[1,0]
    v_pk_mul_f32 v[16:17], v[16:17], v[246:247] op_sel_hi:[1,0]
    v_pk_mul_f32 v[18:19], v[18:19], v[246:247] op_sel_hi:[1,0]
    v_pk_mul_f32 v[20:21], v[20:21], v[246:247] op_sel_hi:[1,0]
    v_pk_mul_f32 v[22:23], v[22:23], v[246:247] op_sel_hi:[1,0]
    v_pk_mul_f32 v[24:25], v[24:25], v[246:247] op_sel_hi:[1,0]
    v_pk_mul_f32 v[26:27], v[26:27], v[246:247] op_sel_hi:[1,0]
    v_pk_mul_f32 v[28:29], v[28:29], v[246:247] op_sel_hi:[1,0]
    v_pk_mul_f32 v[30:31], v[30:31], v[246:247] op_sel_hi:[1,0]
    v_pk_mul_f32 v[32:33], v[32:33], v[246:247] op_sel_hi:[1,0]
    v_pk_mul_f32 v[34:35], v[34:35], v[246:247] op_sel_hi:[1,0]
    v_pk_mul_f32 v[36:37], v[36:37], v[246:247] op_sel_hi:[1,0]
    v_pk_mul_f32 v[38:39], v[38:39], v[246:247] op_sel_hi:[1,0]
    v_pk_mul_f32 v[40:41], v[40:41], v[246:247] op_sel_hi:[1,0]
    v_pk_mul_f32 v[42:43], v[42:43], v[246:247] op_sel_hi:[1,0]
    v_pk_mul_f32 v[44:45], v[44:45], v[246:247] op_sel_hi:[1,0]
    v_pk_mul_f32 v[46:47], v[46:47], v[246:247] op_sel_hi:[1,0]
    v_fma_f32 v180, v144, s25, -v192
    v_fma_f32 v181, v145, s25, -v192
    v_exp_f32 v180, v180
    v_exp_f32 v181, v181
    v_fma_f32 v182, v146, s25, -v192
    v_fma_f32 v183, v147, s25, -v192
    v_exp_f32 v182, v182
    v_exp_f32 v183, v183
    v_cvt_pk_bf16_f32 v168, v180, v181
    v_fma_f32 v184, v148, s25, -v192
    v_fma_f32 v185, v149, s25, -v192
    v_exp_f32 v184, v184
    v_cvt_pk_bf16_f32 v169, v182, v183
    v_exp_f32 v185, v185
    v_fma_f32 v186, v150, s25, -v192
    v_fma_f32 v187, v151, s25, -v192
    v_exp_f32 v186, v186
    v_cvt_pk_bf16_f32 v170, v184, v185
    v_exp_f32 v187, v187
    s_nop 0
    v_cvt_pk_bf16_f32 v171, v186, v187
    s_nop 1
    s_branch Z_back_m0c0
Z_rare_m0c1:
    v_max3_f32 v244, v152, v153, v154
    v_max3_f32 v244, v244, v155, v156
    v_max3_f32 v244, v244, v157, v158
    v_max_f32 v244, v244, v159
    v_mov_b32 v245, v244
    s_nop 1
    v_permlane32_swap_b32 v244, v245
    v_max_f32 v244, v244, v245
    v_mov_b32 v245, v244
    s_nop 1
    v_permlane16_swap_b32 v244, v245
    v_max_f32 v244, v244, v245
    v_mul_f32 v244, s25, v244
    v_add_f32 v244, 0x41100000, v244
    v_max_f32 v244, v244, v193
    v_sub_f32 v246, v193, v244
    v_exp_f32 v246, v246
    v_mov_b32 v193, v244
    v_pk_mul_f32 v[236:237], v[236:237], v[246:247] op_sel_hi:[1,0]
    v_pk_mul_f32 v[238:239], v[238:239], v[246:247] op_sel_hi:[1,0]
    v_pk_mul_f32 v[48:49], v[48:49], v[246:247] op_sel_hi:[1,0]
    v_pk_mul_f32 v[50:51], v[50:51], v[246:247] op_sel_hi:[1,0]
    v_pk_mul_f32 v[52:53], v[52:53], v[246:247] op_sel_hi:[1,0]
    v_pk_mul_f32 v[54:55], v[54:55], v[246:247] op_sel_hi:[1,0]
    v_pk_mul_f32 v[56:57], v[56:57], v[246:247] op_sel_hi:[1,0]
    v_pk_mul_f32 v[58:59], v[58:59], v[246:247] op_sel_hi:[1,0]
    v_pk_mul_f32 v[60:61], v[60:61], v[246:247] op_sel_hi:[1,0]
    v_pk_mul_f32 v[62:63], v[62:63], v[246:247] op_sel_hi:[1,0]
    v_pk_mul_f32 v[64:65], v[64:65], v[246:247] op_sel_hi:[1,0]
    v_pk_mul_f32 v[66:67], v[66:67], v[246:247] op_sel_hi:[1,0]
    v_pk_mul_f32 v[68:69], v[68:69], v[246:247] op_sel_hi:[1,0]
    v_pk_mul_f32 v[70:71], v[70:71], v[246:247] op_sel_hi:[1,0]
    v_pk_mul_f32 v[72:73], v[72:73], v[246:247] op_sel_hi:[1,0]
    v_pk_mul_f32 v[74:75], v[74:75], v[246:247] op_sel_hi:[1,0]
    v_pk_mul_f32 v[76:77], v[76:77], v[246:247] op_sel_hi:[1,0]
    v_pk_mul_f32 v[78:79], v[78:79], v[246:247] op_sel_hi:[1,0]
    v_pk_mul_f32 v[80:81], v[80:81], v[246:247] op_sel_hi:[1,0]
    v_pk_mul_f32 v[82:83], v[82:83], v[246:247] op_sel_hi:[1,0]
    v_pk_mul_f32 v[84:85], v[84:85], v[246:247] op_sel_hi:[1,0]
    v_pk_mul_f32 v[86:87], v[86:87], v[246:247] op_sel_hi:[1,0]
    v_pk_mul_f32 v[88:89], v[88:89], v[246:247] op_sel_hi:[1,0]
    v_pk_mul_f32 v[90:91], v[90:91], v[246:247] op_sel_hi:[1,0]
    v_pk_mul_f32 v[92:93], v[92:93], v[246:247] op_sel_hi:[1,0]
    v_pk_mul_f32 v[94:95], v[94:95], v[246:247] op_sel_hi:[1,0]
    v_fma_f32 v180, v152, s25, -v193
    v_fma_f32 v181, v153, s25, -v193
    v_exp_f32 v180, v180
    v_exp_f32 v181, v181
    v_fma_f32 v182, v154, s25, -v193
    v_fma_f32 v183, v155, s25, -v193
    v_exp_f32 v182, v182
    v_exp_f32 v183, v183
    v_cvt_pk_bf16_f32 v172, v180, v181
    v_fma_f32 v184, v156, s25, -v193
    v_fma_f32 v185, v157, s25, -v193
    v_exp_f32 v184, v184
    v_cvt_pk_bf16_f32 v173, v182, v183
    v_exp_f32 v185, v185
    v_fma_f32 v186, v158, s25, -v193
    v_fma_f32 v187, v159, s25, -v193
    v_exp_f32 v186, v186
    v_cvt_pk_bf16_f32 v174, v184, v185
    v_exp_f32 v187, v187
    s_nop 0
    v_cvt_pk_bf16_f32 v175, v186, v187
    s_nop 1
    s_branch Z_back_m0c1
Z_rare_m0a2:
    v_max3_f32 v244, v160, v161, v162
    v_max3_f32 v244, v244, v163, v164
    v_max3_f32 v244, v244, v165, v166
    v_max_f32 v244, v244, v167
    v_mov_b32 v245, v244
    s_nop 1
    v_permlane32_swap_b32 v244, v245
    v_max_f32 v244, v244, v245
    v_mov_b32 v245, v244
    s_nop 1
    v_permlane16_swap_b32 v244, v245
    v_max_f32 v244, v244, v245
    v_mul_f32 v244, s25, v244
    v_add_f32 v244, 0x41100000, v244
    v_max_f32 v244, v244, v194
    v_sub_f32 v246, v194, v244
    v_exp_f32 v246, v246
    v_mov_b32 v194, v244
    v_pk_mul_f32 v[240:241], v[240:241], v[246:247] op_sel_hi:[1,0]
    v_pk_mul_f32 v[242:243], v[242:243], v[246:247] op_sel_hi:[1,0]
    v_pk_mul_f32 v[96:97], v[96:97], v[246:247] op_sel_hi:[1,0]
    v_pk_mul_f32 v[98:99], v[98:99], v[246:247] op_sel_hi:[1,0]
    v_pk_mul_f32 v[100:101], v[100:101], v[246:247] op_sel_hi:[1,0]
    v_pk_mul_f32 v[102:103], v[102:103], v[246:247] op_sel_hi:[1,0]
    v_pk_mul_f32 v[104:105], v[104:105], v[246:247] op_sel_hi:[1,0]
    v_pk_mul_f32 v[106:107], v[106:107], v[246:247] op_sel_hi:[1,0]
    v_pk_mul_f32 v[108:109], v[108:109], v[246:247] op_sel_hi:[1,0]
    v_pk_mul_f32 v[110:111], v[110:111], v[246:247] op_sel_hi:[1,0]
    v_pk_mul_f32 v[112:113], v[112:113], v[246:247] op_sel_hi:[1,0]
    v_pk_mul_f32 v[114:115], v[114:115], v[246:247] op_sel_hi:[1,0]
    v_pk_mul_f32 v[116:117], v[116:117], v[246:247] op_sel_hi:[1,0]
    v_pk_mul_f32 v[118:119], v[118:119], v[246:247] op_sel_hi:[1,0]
    v_pk_mul_f32 v[120:121], v[120:121], v[246:247] op_sel_hi:[1,0]
    v_pk_mul_f32 v[122:123], v[122:123], v[246:247] op_sel_hi:[1,0]
    v_pk_mul_f32 v[124:125], v[124:125], v[246:247] op_sel_hi:[1,0]
    v_pk_mul_f32 v[126:127], v[126:127], v[246:247] op_sel_hi:[1,0]
    v_pk_mul_f32 v[128:129], v[128:129], v[246:247] op_sel_hi:[1,0]
    v_pk_mul_f32 v[130:131], v[130:131], v[246:247] op_sel_hi:[1,0]
    v_pk_mul_f32 v[132:133], v[132:133], v[246:247] op_sel_hi:[1,0]
    v_pk_mul_f32 v[134:135], v[134:135], v[246:247] op_sel_hi:[1,0]
    v_pk_mul_f32 v[136:137], v[136:137], v[246:247] op_sel_hi:[1,0]
    v_pk_mul_f32 v[138:139], v[138:139], v[246:247] op_sel_hi:[1,0]
    v_pk_mul_f32 v[140:141], v[140:141], v[246:247] op_sel_hi:[1,0]
    v_pk_mul_f32 v[142:143], v[142:143], v[246:247] op_sel_hi:[1,0]
    v_fma_f32 v180, v160, s25, -v194
    v_fma_f32 v181, v161, s25, -v194
    v_exp_f32 v180, v180
    v_exp_f32 v181, v181
    v_fma_f32 v182, v162, s25, -v194
    v_fma_f32 v183, v163, s25, -v194
    v_exp_f32 v182, v182
    v_exp_f32 v183, v183
    v_cvt_pk_bf16_f32 v176, v180, v181
    v_fma_f32 v184, v164, s25, -v194
    v_fma_f32 v185, v165, s25, -v194
    v_exp_f32 v184, v184
    v_cvt_pk_bf16_f32 v177, v182, v183
    v_exp_f32 v185, v185
    v_fma_f32 v186, v166, s25, -v194
    v_fma_f32 v187, v167, s25, -v194
    v_exp_f32 v186, v186
    v_cvt_pk_bf16_f32 v178, v184, v185
    v_exp_f32 v187, v187
    s_nop 0
    v_cvt_pk_bf16_f32 v179, v186, v187
    s_nop 1
    s_branch Z_back_m0a2
Z_rare_t162:
    v_max3_f32 v244, v160, v161, v162
    v_max3_f32 v244, v244, v163, v164
    v_max3_f32 v244, v244, v165, v166
    v_max_f32 v244, v244, v167
    v_mov_b32 v245, v244
    s_nop 1
    v_permlane32_swap_b32 v244, v245
    v_max_f32 v244, v244, v245
    v_mov_b32 v245, v244
    s_nop 1
    v_permlane16_swap_b32 v244, v245
    v_max_f32 v244, v244, v245
    v_mul_f32 v244, s25, v244
    v_add_f32 v244, 0x41100000, v244
    v_max_f32 v244, v244, v194
    v_sub_f32 v246, v194, v244
    v_exp_f32 v246, v246
    v_mov_b32 v194, v244
    v_pk_mul_f32 v[240:241], v[240:241], v[246:247] op_sel_hi:[1,0]
    v_pk_mul_f32 v[242:243], v[242:243], v[246:247] op_sel_hi:[1,0]
    v_pk_mul_f32 v[96:97], v[96:97], v[246:247] op_sel_hi:[1,0]
    v_pk_mul_f32 v[98:99], v[98:99], v[246:247] op_sel_hi:[1,0]
    v_pk_mul_f32 v[100:101], v[100:101], v[246:247] op_sel_hi:[1,0]
    v_pk_mul_f32 v[102:103], v[102:103], v[246:247] op_sel_hi:[1,0]
    v_pk_mul_f32 v[104:105], v[104:105], v[246:247] op_sel_hi:[1,0]
    v_pk_mul_f32 v[106:107], v[106:107], v[246:247] op_sel_hi:[1,0]
    v_pk_mul_f32 v[108:109], v[108:109], v[246:247] op_sel_hi:[1,0]
    v_pk_mul_f32 v[110:111], v[110:111], v[246:247] op_sel_hi:[1,0]
    v_pk_mul_f32 v[112:113], v[112:113], v[246:247] op_sel_hi:[1,0]
    v_pk_mul_f32 v[114:115], v[114:115], v[246:247] op_sel_hi:[1,0]
    v_pk_mul_f32 v[116:117], v[116:117], v[246:247] op_sel_hi:[1,0]
    v_pk_mul_f32 v[118:119], v[118:119], v[246:247] op_sel_hi:[1,0]
    v_pk_mul_f32 v[120:121], v[120:121], v[246:247] op_sel_hi:[1,0]
    v_pk_mul_f32 v[122:123], v[122:123], v[246:247] op_sel_hi:[1,0]
    v_pk_mul_f32 v[124:125], v[124:125], v[246:247] op_sel_hi:[1,0]
    v_pk_mul_f32 v[126:127], v[126:127], v[246:247] op_sel_hi:[1,0]
    v_pk_mul_f32 v[128:129], v[128:129], v[246:247] op_sel_hi:[1,0]
    v_pk_mul_f32 v[130:131], v[130:131], v[246:247] op_sel_hi:[1,0]
    v_pk_mul_f32 v[132:133], v[132:133], v[246:247] op_sel_hi:[1,0]
    v_pk_mul_f32 v[134:135], v[134:135], v[246:247] op_sel_hi:[1,0]
    v_pk_mul_f32 v[136:137], v[136:137], v[246:247] op_sel_hi:[1,0]
    v_pk_mul_f32 v[138:139], v[138:139], v[246:247] op_sel_hi:[1,0]
    v_pk_mul_f32 v[140:141], v[140:141], v[246:247] op_sel_hi:[1,0]
    v_pk_mul_f32 v[142:143], v[142:143], v[246:247] op_sel_hi:[1,0]
    v_fma_f32 v180, v160, s25, -v194
    v_fma_f32 v181, v161, s25, -v194
    v_exp_f32 v180, v180
    v_exp_f32 v181, v181
    v_fma_f32 v182, v162, s25, -v194
    v_fma_f32 v183, v163, s25, -v194
    v_exp_f32 v182, v182
    v_exp_f32 v183, v183
    v_cvt_pk_bf16_f32 v176, v180, v181
    v_fma_f32 v184, v164, s25, -v194
    v_fma_f32 v185, v165, s25, -v194
    v_exp_f32 v184, v184
    v_cvt_pk_bf16_f32 v177, v182, v183
    v_exp_f32 v185, v185
    v_fma_f32 v186, v166, s25, -v194
    v_fma_f32 v187, v167, s25, -v194
    v_exp_f32 v186, v186
    v_cvt_pk_bf16_f32 v178, v184, v185
    v_exp_f32 v187, v187
    s_nop 0
    v_cvt_pk_bf16_f32 v179, v186, v187
    s_nop 1
    s_branch Z_back_t162
Z_rare_s22:
    v_max3_f32 v244, v160, v161, v162
    v_max3_f32 v244, v244, v163, v164
    v_max3_f32 v244, v244, v165, v166
    v_max_f32 v244, v244, v167
    v_mov_b32 v245, v244
    s_nop 1
    v_permlane32_swap_b32 v244, v245
    v_max_f32 v244, v244, v245
    v_mov_b32 v245, v244
    s_nop 1
    v_permlane16_swap_b32 v244, v245
    v_max_f32 v244, v244, v245
    v_mul_f32 v244, s25, v244
    v_add_f32 v244, 0x41100000, v244
    v_max_f32 v244, v244, v194
    v_sub_f32 v246, v194, v244
    v_exp_f32 v246, v246
    v_mov_b32 v194, v244
    v_pk_mul_f32 v[240:241], v[240:241], v[246:247] op_sel_hi:[1,0]
    v_pk_mul_f32 v[242:243], v[242:243], v[246:247] op_sel_hi:[1,0]
    v_pk_mul_f32 v[96:97], v[96:97], v[246:247] op_sel_hi:[1,0]
    v_pk_mul_f32 v[98:99], v[98:99], v[246:247] op_sel_hi:[1,0]
    v_pk_mul_f32 v[100:101], v[100:101], v[246:247] op_sel_hi:[1,0]
    v_pk_mul_f32 v[102:103], v[102:103], v[246:247] op_sel_hi:[1,0]
    v_pk_mul_f32 v[104:105], v[104:105], v[246:247] op_sel_hi:[1,0]
    v_pk_mul_f32 v[106:107], v[106:107], v[246:247] op_sel_hi:[1,0]
    v_pk_mul_f32 v[108:109], v[108:109], v[246:247] op_sel_hi:[1,0]
    v_pk_mul_f32 v[110:111], v[110:111], v[246:247] op_sel_hi:[1,0]
    v_pk_mul_f32 v[112:113], v[112:113], v[246:247] op_sel_hi:[1,0]
    v_pk_mul_f32 v[114:115], v[114:115], v[246:247] op_sel_hi:[1,0]
    v_pk_mul_f32 v[116:117], v[116:117], v[246:247] op_sel_hi:[1,0]
    v_pk_mul_f32 v[118:119], v[118:119], v[246:247] op_sel_hi:[1,0]
    v_pk_mul_f32 v[120:121], v[120:121], v[246:247] op_sel_hi:[1,0]
    v_pk_mul_f32 v[122:123], v[122:123], v[246:247] op_sel_hi:[1,0]
    v_pk_mul_f32 v[124:125], v[124:125], v[246:247] op_sel_hi:[1,0]
    v_pk_mul_f32 v[126:127], v[126:127], v[246:247] op_sel_hi:[1,0]
    v_pk_mul_f32 v[128:129], v[128:129], v[246:247] op_sel_hi:[1,0]
    v_pk_mul_f32 v[130:131], v[130:131], v[246:247] op_sel_hi:[1,0]
    v_pk_mul_f32 v[132:133], v[132:133], v[246:247] op_sel_hi:[1,0]
    v_pk_mul_f32 v[134:135], v[134:135], v[246:247] op_sel_hi:[1,0]
    v_pk_mul_f32 v[136:137], v[136:137], v[246:247] op_sel_hi:[1,0]
    v_pk_mul_f32 v[138:139], v[138:139], v[246:247] op_sel_hi:[1,0]
    v_pk_mul_f32 v[140:141], v[140:141], v[246:247] op_sel_hi:[1,0]
    v_pk_mul_f32 v[142:143], v[142:143], v[246:247] op_sel_hi:[1,0]
    v_fma_f32 v180, v160, s25, -v194
    v_fma_f32 v181, v161, s25, -v194
    v_exp_f32 v180, v180
    v_exp_f32 v181, v181
    v_fma_f32 v182, v162, s25, -v194
    v_fma_f32 v183, v163, s25, -v194
    v_exp_f32 v182, v182
    v_exp_f32 v183, v183
    v_cvt_pk_bf16_f32 v176, v180, v181
    v_fma_f32 v184, v164, s25, -v194
    v_fma_f32 v185, v165, s25, -v194
    v_exp_f32 v184, v184
    v_cvt_pk_bf16_f32 v177, v182, v183
    v_exp_f32 v185, v185
    v_fma_f32 v186, v166, s25, -v194
    v_fma_f32 v187, v167, s25, -v194
    v_exp_f32 v186, v186
    v_cvt_pk_bf16_f32 v178, v184, v185
    v_exp_f32 v187, v187
    s_nop 0
    v_cvt_pk_bf16_f32 v179, v186, v187
    s_nop 1
    s_branch Z_back_s22
Z_rare_s20:
    v_max3_f32 v244, v144, v145, v146
    v_max3_f32 v244, v244, v147, v148
    v_max3_f32 v244, v244, v149, v150
    v_max_f32 v244, v244, v151
    v_mov_b32 v245, v244
    s_nop 1
    v_permlane32_swap_b32 v244, v245
    v_max_f32 v244, v244, v245
    v_mov_b32 v245, v244
    s_nop 1
    v_permlane16_swap_b32 v244, v245
    v_max_f32 v244, v244, v245
    v_mul_f32 v244, s25, v244
    v_add_f32 v244, 0x41100000, v244
    v_max_f32 v244, v244, v192
    v_sub_f32 v246, v192, v244
    v_exp_f32 v246, v246
    v_mov_b32 v192, v244
    v_pk_mul_f32 v[232:233], v[232:233], v[246:247] op_sel_hi:[1,0]
    v_pk_mul_f32 v[234:235], v[234:235], v[246:247] op_sel_hi:[1,0]
    v_pk_mul_f32 v[0:1], v[0:1], v[246:247] op_sel_hi:[1,0]
    v_pk_mul_f32 v[2:3], v[2:3], v[246:247] op_sel_hi:[1,0]
    v_pk_mul_f32 v[4:5], v[4:5], v[246:247] op_sel_hi:[1,0]
    v_pk_mul_f32 v[6:7], v[6:7], v[246:247] op_sel_hi:[1,0]
    v_pk_mul_f32 v[8:9], v[8:9], v[246:247] op_sel_hi:[1,0]
    v_pk_mul_f32 v[10:11], v[10:11], v[246:247] op_sel_hi:[1,0]
    v_pk_mul_f32 v[12:13], v[12:13], v[246:247] op_sel_hi:[1,0]
    v_pk_mul_f32 v[14:15], v[14:15], v[246:247] op_sel_hi:[1,0]
    v_pk_mul_f32 v[16:17], v[16:17], v[246:247] op_sel_hi:[1,0]
    v_pk_mul_f32 v[18:19], v[18:19], v[246:247] op_sel_hi:[1,0]
    v_pk_mul_f32 v[20:21], v[20:21], v[246:247] op_sel_hi:[1,0]
    v_pk_mul_f32 v[22:23], v[22:23], v[246:247] op_sel_hi:[1,0]
    v_pk_mul_f32 v[24:25], v[24:25], v[246:247] op_sel_hi:[1,0]
    v_pk_mul_f32 v[26:27], v[26:27], v[246:247] op_sel_hi:[1,0]
    v_pk_mul_f32 v[28:29], v[28:29], v[246:247] op_sel_hi:[1,0]
    v_pk_mul_f32 v[30:31], v[30:31], v[246:247] op_sel_hi:[1,0]
    v_pk_mul_f32 v[32:33], v[32:33], v[246:247] op_sel_hi:[1,0]
    v_pk_mul_f32 v[34:35], v[34:35], v[246:247] op_sel_hi:[1,0]
    v_pk_mul_f32 v[36:37], v[36:37], v[246:247] op_sel_hi:[1,0]
    v_pk_mul_f32 v[38:39], v[38:39], v[246:247] op_sel_hi:[1,0]
    v_pk_mul_f32 v[40:41], v[40:41], v[246:247] op_sel_hi:[1,0]
    v_pk_mul_f32 v[42:43], v[42:43], v[246:247] op_sel_hi:[1,0]
    v_pk_mul_f32 v[44:45], v[44:45], v[246:247] op_sel_hi:[1,0]
    v_pk_mul_f32 v[46:47], v[46:47], v[246:247] op_sel_hi:[1,0]
    v_fma_f32 v180, v144, s25, -v192
    v_fma_f32 v181, v145, s25, -v192
    v_exp_f32 v180, v180
    v_exp_f32 v181, v181
    v_fma_f32 v182, v146, s25, -v192
    v_fma_f32 v183, v147, s25, -v192
    v_exp_f32 v182, v182
    v_exp_f32 v183, v183
    v_cvt_pk_bf16_f32 v168, v180, v181
    v_fma_f32 v184, v148, s25, -v192
    v_fma_f32 v185, v149, s25, -v192
    v_exp_f32 v184, v184
    v_cvt_pk_bf16_f32 v169, v182, v183
    v_exp_f32 v185, v185
    v_fma_f32 v186, v150, s25, -v192
    v_fma_f32 v187, v151, s25, -v192
    v_exp_f32 v186, v186
    v_cvt_pk_bf16_f32 v170, v184, v185
    v_exp_f32 v187, v187
    s_nop 0
    v_cvt_pk_bf16_f32 v171, v186, v187
    s_nop 1
    s_branch Z_back_s20
Z_rare_ea:
    v_max3_f32 v244, v144, v145, v146
    v_max3_f32 v244, v244, v147, v148
    v_max3_f32 v244, v244, v149, v150
    v_max_f32 v244, v244, v151
    v_mov_b32 v245, v244
    s_nop 1
    v_permlane32_swap_b32 v244, v245
    v_max_f32 v244, v244, v245
    v_mov_b32 v245, v244
    s_nop 1
    v_permlane16_swap_b32 v244, v245
    v_max_f32 v244, v244, v245
    v_mul_f32 v244, s25, v244
    v_add_f32 v244, 0x41100000, v244
    v_max_f32 v244, v244, v192
    v_sub_f32 v246, v192, v244
    v_exp_f32 v246, v246
    v_mov_b32 v192, v244
    v_pk_mul_f32 v[232:233], v[232:233], v[246:247] op_sel_hi:[1,0]
    v_pk_mul_f32 v[234:235], v[234:235], v[246:247] op_sel_hi:[1,0]
    v_pk_mul_f32 v[0:1], v[0:1], v[246:247] op_sel_hi:[1,0]
    v_pk_mul_f32 v[2:3], v[2:3], v[246:247] op_sel_hi:[1,0]
    v_pk_mul_f32 v[4:5], v[4:5], v[246:247] op_sel_hi:[1,0]
    v_pk_mul_f32 v[6:7], v[6:7], v[246:247] op_sel_hi:[1,0]
    v_pk_mul_f32 v[8:9], v[8:9], v[246:247] op_sel_hi:[1,0]
    v_pk_mul_f32 v[10:11], v[10:11], v[246:247] op_sel_hi:[1,0]
    v_pk_mul_f32 v[12:13], v[12:13], v[246:247] op_sel_hi:[1,0]
    v_pk_mul_f32 v[14:15], v[14:15], v[246:247] op_sel_hi:[1,0]
    v_pk_mul_f32 v[16:17], v[16:17], v[246:247] op_sel_hi:[1,0]
    v_pk_mul_f32 v[18:19], v[18:19], v[246:247] op_sel_hi:[1,0]
    v_pk_mul_f32 v[20:21], v[20:21], v[246:247] op_sel_hi:[1,0]
    v_pk_mul_f32 v[22:23], v[22:23], v[246:247] op_sel_hi:[1,0]
    v_pk_mul_f32 v[24:25], v[24:25], v[246:247] op_sel_hi:[1,0]
    v_pk_mul_f32 v[26:27], v[26:27], v[246:247] op_sel_hi:[1,0]
    v_pk_mul_f32 v[28:29], v[28:29], v[246:247] op_sel_hi:[1,0]
    v_pk_mul_f32 v[30:31], v[30:31], v[246:247] op_sel_hi:[1,0]
    v_pk_mul_f32 v[32:33], v[32:33], v[246:247] op_sel_hi:[1,0]
    v_pk_mul_f32 v[34:35], v[34:35], v[246:247] op_sel_hi:[1,0]
    v_pk_mul_f32 v[36:37], v[36:37], v[246:247] op_sel_hi:[1,0]
    v_pk_mul_f32 v[38:39], v[38:39], v[246:247] op_sel_hi:[1,0]
    v_pk_mul_f32 v[40:41], v[40:41], v[246:247] op_sel_hi:[1,0]
    v_pk_mul_f32 v[42:43], v[42:43], v[246:247] op_sel_hi:[1,0]
    v_pk_mul_f32 v[44:45], v[44:45], v[246:247] op_sel_hi:[1,0]
    v_pk_mul_f32 v[46:47], v[46:47], v[246:247] op_sel_hi:[1,0]
    v_fma_f32 v180, v144, s25, -v192
    v_fma_f32 v181, v145, s25, -v192
    v_exp_f32 v180, v180
    v_exp_f32 v181, v181
    v_fma_f32 v182, v146, s25, -v192
    v_fma_f32 v183, v147, s25, -v192
    v_exp_f32 v182, v182
    v_exp_f32 v183, v183
    v_cvt_pk_bf16_f32 v168, v180, v181
    v_fma_f32 v184, v148, s25, -v192
    v_fma_f32 v185, v149, s25, -v192
    v_exp_f32 v184, v184
    v_cvt_pk_bf16_f32 v169, v182, v183
    v_exp_f32 v185, v185
    v_fma_f32 v186, v150, s25, -v192
    v_fma_f32 v187, v151, s25, -v192
    v_exp_f32 v186, v186
    v_cvt_pk_bf16_f32 v170, v184, v185
    v_exp_f32 v187, v187
    s_nop 0
    v_cvt_pk_bf16_f32 v171, v186, v187
    s_nop 1
    s_branch Z_back_ea
Z_rare_eb:
    v_max3_f32 v244, v152, v153, v154
    v_max3_f32 v244, v244, v155, v156
    v_max3_f32 v244, v244, v157, v158
    v_max_f32 v244, v244, v159
    v_mov_b32 v245, v244
    s_nop 1
    v_permlane32_swap_b32 v244, v245
    v_max_f32 v244, v244, v245
    v_mov_b32 v245, v244
    s_nop 1
    v_permlane16_swap_b32 v244, v245
    v_max_f32 v244, v244, v245
    v_mul_f32 v244, s25, v244
    v_add_f32 v244, 0x41100000, v244
    v_max_f32 v244, v244, v192
    v_sub_f32 v246, v192, v244
    v_exp_f32 v246, v246
    v_mov_b32 v192, v244
    v_pk_mul_f32 v[232:233], v[232:233], v[246:247] op_sel_hi:[1,0]
    v_pk_mul_f32 v[234:235], v[234:235], v[246:247] op_sel_hi:[1,0]
    v_pk_mul_f32 v[0:1], v[0:1], v[246:247] op_sel_hi:[1,0]
    v_pk_mul_f32 v[2:3], v[2:3], v[246:247] op_sel_hi:[1,0]
    v_pk_mul_f32 v[4:5], v[4:5], v[246:247] op_sel_hi:[1,0]
    v_pk_mul_f32 v[6:7], v[6:7], v[246:247] op_sel_hi:[1,0]
    v_pk_mul_f32 v[8:9], v[8:9], v[246:247] op_sel_hi:[1,0]
    v_pk_mul_f32 v[10:11], v[10:11], v[246:247] op_sel_hi:[1,0]
    v_pk_mul_f32 v[12:13], v[12:13], v[246:247] op_sel_hi:[1,0]
    v_pk_mul_f32 v[14:15], v[14:15], v[246:247] op_sel_hi:[1,0]
    v_pk_mul_f32 v[16:17], v[16:17], v[246:247] op_sel_hi:[1,0]
    v_pk_mul_f32 v[18:19], v[18:19], v[246:247] op_sel_hi:[1,0]
    v_pk_mul_f32 v[20:21], v[20:21], v[246:247] op_sel_hi:[1,0]
    v_pk_mul_f32 v[22:23], v[22:23], v[246:247] op_sel_hi:[1,0]
    v_pk_mul_f32 v[24:25], v[24:25], v[246:247] op_sel_hi:[1,0]
    v_pk_mul_f32 v[26:27], v[26:27], v[246:247] op_sel_hi:[1,0]
    v_pk_mul_f32 v[28:29], v[28:29], v[246:247] op_sel_hi:[1,0]
    v_pk_mul_f32 v[30:31], v[30:31], v[246:247] op_sel_hi:[1,0]
    v_pk_mul_f32 v[32:33], v[32:33], v[246:247] op_sel_hi:[1,0]
    v_pk_mul_f32 v[34:35], v[34:35], v[246:247] op_sel_hi:[1,0]
    v_pk_mul_f32 v[36:37], v[36:37], v[246:247] op_sel_hi:[1,0]
    v_pk_mul_f32 v[38:39], v[38:39], v[246:247] op_sel_hi:[1,0]
    v_pk_mul_f32 v[40:41], v[40:41], v[246:247] op_sel_hi:[1,0]
    v_pk_mul_f32 v[42:43], v[42:43], v[246:247] op_sel_hi:[1,0]
    v_pk_mul_f32 v[44:45], v[44:45], v[246:247] op_sel_hi:[1,0]
    v_pk_mul_f32 v[46:47], v[46:47], v[246:247] op_sel_hi:[1,0]
    v_fma_f32 v180, v152, s25, -v192
    v_fma_f32 v181, v153, s25, -v192
    v_exp_f32 v180, v180
    v_exp_f32 v181, v181
    v_fma_f32 v182, v154, s25, -v192
    v_fma_f32 v183, v155, s25, -v192
    v_exp_f32 v182, v182
    v_exp_f32 v183, v183
    v_cvt_pk_bf16_f32 v172, v180, v181
    v_fma_f32 v184, v156, s25, -v192
    v_fma_f32 v185, v157, s25, -v192
    v_exp_f32 v184, v184
    v_cvt_pk_bf16_f32 v173, v182, v183
    v_exp_f32 v185, v185
    v_fma_f32 v186, v158, s25, -v192
    v_fma_f32 v187, v159, s25, -v192
    v_exp_f32 v186, v186
    v_cvt_pk_bf16_f32 v174, v184, v185
    v_exp_f32 v187, v187
    s_nop 0
    v_cvt_pk_bf16_f32 v175, v186, v187
    s_nop 1
    s_branch Z_back_eb
Z_rare_ec:
    v_max3_f32 v244, v160, v161, v162
    v_max3_f32 v244, v244, v163, v164
    v_max3_f32 v244, v244, v165, v166
    v_max_f32 v244, v244, v167
    v_mov_b32 v245, v244
    s_nop 1
    v_permlane32_swap_b32 v244, v245
    v_max_f32 v244, v244, v245
    v_mov_b32 v245, v244
    s_nop 1
    v_permlane16_swap_b32 v244, v245
    v_max_f32 v244, v244, v245
    v_mul_f32 v244, s25, v244
    v_add_f32 v244, 0x41100000, v244
    v_max_f32 v244, v244, v193
    v_sub_f32 v246, v193, v244
    v_exp_f32 v246, v246
    v_mov_b32 v193, v244
    v_pk_mul_f32 v[236:237], v[236:237], v[246:247] op_sel_hi:[1,0]
    v_pk_mul_f32 v[238:239], v[238:239], v[246:247] op_sel_hi:[1,0]
    v_pk_mul_f32 v[48:49], v[48:49], v[246:247] op_sel_hi:[1,0]
    v_pk_mul_f32 v[50:51], v[50:51], v[246:247] op_sel_hi:[1,0]
    v_pk_mul_f32 v[52:53], v[52:53], v[246:247] op_sel_hi:[1,0]
    v_pk_mul_f32 v[54:55], v[54:55], v[246:247] op_sel_hi:[1,0]
    v_pk_mul_f32 v[56:57], v[56:57], v[246:247] op_sel_hi:[1,0]
    v_pk_mul_f32 v[58:59], v[58:59], v[246:247] op_sel_hi:[1,0]
    v_pk_mul_f32 v[60:61], v[60:61], v[246:247] op_sel_hi:[1,0]
    v_pk_mul_f32 v[62:63], v[62:63], v[246:247] op_sel_hi:[1,0]
    v_pk_mul_f32 v[64:65], v[64:65], v[246:247] op_sel_hi:[1,0]
    v_pk_mul_f32 v[66:67], v[66:67], v[246:247] op_sel_hi:[1,0]
    v_pk_mul_f32 v[68:69], v[68:69], v[246:247] op_sel_hi:[1,0]
    v_pk_mul_f32 v[70:71], v[70:71], v[246:247] op_sel_hi:[1,0]
    v_pk_mul_f32 v[72:73], v[72:73], v[246:247] op_sel_hi:[1,0]
    v_pk_mul_f32 v[74:75], v[74:75], v[246:247] op_sel_hi:[1,0]
    v_pk_mul_f32 v[76:77], v[76:77], v[246:247] op_sel_hi:[1,0]
    v_pk_mul_f32 v[78:79], v[78:79], v[246:247] op_sel_hi:[1,0]
    v_pk_mul_f32 v[80:81], v[80:81], v[246:247] op_sel_hi:[1,0]
    v_pk_mul_f32 v[82:83], v[82:83], v[246:247] op_sel_hi:[1,0]
    v_pk_mul_f32 v[84:85], v[84:85], v[246:247] op_sel_hi:[1,0]
    v_pk_mul_f32 v[86:87], v[86:87], v[246:247] op_sel_hi:[1,0]
    v_pk_mul_f32 v[88:89], v[88:89], v[246:247] op_sel_hi:[1,0]
    v_pk_mul_f32 v[90:91], v[90:91], v[246:247] op_sel_hi:[1,0]
    v_pk_mul_f32 v[92:93], v[92:93], v[246:247] op_sel_hi:[1,0]
    v_pk_mul_f32 v[94:95], v[94:95], v[246:247] op_sel_hi:[1,0]
    v_fma_f32 v180, v160, s25, -v193
    v_fma_f32 v181, v161, s25, -v193
    v_exp_f32 v180, v180
    v_exp_f32 v181, v181
    v_fma_f32 v182, v162, s25, -v193
    v_fma_f32 v183, v163, s25, -v193
    v_exp_f32 v182, v182
    v_exp_f32 v183, v183
    v_cvt_pk_bf16_f32 v176, v180, v181
    v_fma_f32 v184, v164, s25, -v193
    v_fma_f32 v185, v165, s25, -v193
    v_exp_f32 v184, v184
    v_cvt_pk_bf16_f32 v177, v182, v183
    v_exp_f32 v185, v185
    v_fma_f32 v186, v166, s25, -v193
    v_fma_f32 v187, v167, s25, -v193
    v_exp_f32 v186, v186
    v_cvt_pk_bf16_f32 v178, v184, v185
    v_exp_f32 v187, v187
    s_nop 0
    v_cvt_pk_bf16_f32 v179, v186, v187
    s_nop 1
    s_branch Z_back_ec
Z_rare_ed:
    v_max3_f32 v244, v144, v145, v146
    v_max3_f32 v244, v244, v147, v148
    v_max3_f32 v244, v244, v149, v150
    v_max_f32 v244, v244, v151
    v_mov_b32 v245, v244
    s_nop 1
    v_permlane32_swap_b32 v244, v245
    v_max_f32 v244, v244, v245
    v_mov_b32 v245, v244
    s_nop 1
    v_permlane16_swap_b32 v244, v245
    v_max_f32 v244, v244, v245
    v_mul_f32 v244, s25, v244
    v_add_f32 v244, 0x41100000, v244
    v_max_f32 v244, v244, v193
    v_sub_f32 v246, v193, v244
    v_exp_f32 v246, v246
    v_mov_b32 v193, v244
    v_pk_mul_f32 v[236:237], v[236:237], v[246:247] op_sel_hi:[1,0]
    v_pk_mul_f32 v[238:239], v[238:239], v[246:247] op_sel_hi:[1,0]
    v_pk_mul_f32 v[48:49], v[48:49], v[246:247] op_sel_hi:[1,0]
    v_pk_mul_f32 v[50:51], v[50:51], v[246:247] op_sel_hi:[1,0]
    v_pk_mul_f32 v[52:53], v[52:53], v[246:247] op_sel_hi:[1,0]
    v_pk_mul_f32 v[54:55], v[54:55], v[246:247] op_sel_hi:[1,0]
    v_pk_mul_f32 v[56:57], v[56:57], v[246:247] op_sel_hi:[1,0]
    v_pk_mul_f32 v[58:59], v[58:59], v[246:247] op_sel_hi:[1,0]
    v_pk_mul_f32 v[60:61], v[60:61], v[246:247] op_sel_hi:[1,0]
    v_pk_mul_f32 v[62:63], v[62:63], v[246:247] op_sel_hi:[1,0]
    v_pk_mul_f32 v[64:65], v[64:65], v[246:247] op_sel_hi:[1,0]
    v_pk_mul_f32 v[66:67], v[66:67], v[246:247] op_sel_hi:[1,0]
    v_pk_mul_f32 v[68:69], v[68:69], v[246:247] op_sel_hi:[1,0]
    v_pk_mul_f32 v[70:71], v[70:71], v[246:247] op_sel_hi:[1,0]
    v_pk_mul_f32 v[72:73], v[72:73], v[246:247] op_sel_hi:[1,0]
    v_pk_mul_f32 v[74:75], v[74:75], v[246:247] op_sel_hi:[1,0]
    v_pk_mul_f32 v[76:77], v[76:77], v[246:247] op_sel_hi:[1,0]
    v_pk_mul_f32 v[78:79], v[78:79], v[246:247] op_sel_hi:[1,0]
    v_pk_mul_f32 v[80:81], v[80:81], v[246:247] op_sel_hi:[1,0]
    v_pk_mul_f32 v[82:83], v[82:83], v[246:247] op_sel_hi:[1,0]
    v_pk_mul_f32 v[84:85], v[84:85], v[246:247] op_sel_hi:[1,0]
    v_pk_mul_f32 v[86:87], v[86:87], v[246:247] op_sel_hi:[1,0]
    v_pk_mul_f32 v[88:89], v[88:89], v[246:247] op_sel_hi:[1,0]
    v_pk_mul_f32 v[90:91], v[90:91], v[246:247] op_sel_hi:[1,0]
    v_pk_mul_f32 v[92:93], v[92:93], v[246:247] op_sel_hi:[1,0]
    v_pk_mul_f32 v[94:95], v[94:95], v[246:247] op_sel_hi:[1,0]
    v_fma_f32 v180, v144, s25, -v193
    v_fma_f32 v181, v145, s25, -v193
    v_exp_f32 v180, v180
    v_exp_f32 v181, v181
    v_fma_f32 v182, v146, s25, -v193
    v_fma_f32 v183, v147, s25, -v193
    v_exp_f32 v182, v182
    v_exp_f32 v183, v183
    v_cvt_pk_bf16_f32 v168, v180, v181
    v_fma_f32 v184, v148, s25, -v193
    v_fma_f32 v185, v149, s25, -v193
    v_exp_f32 v184, v184
    v_cvt_pk_bf16_f32 v169, v182, v183
    v_exp_f32 v185, v185
    v_fma_f32 v186, v150, s25, -v193
    v_fma_f32 v187, v151, s25, -v193
    v_exp_f32 v186, v186
    v_cvt_pk_bf16_f32 v170, v184, v185
    v_exp_f32 v187, v187
    s_nop 0
    v_cvt_pk_bf16_f32 v171, v186, v187
    s_nop 1
    s_branch Z_back_ed
Z_rare_ee:
    v_max3_f32 v244, v152, v153, v154
    v_max3_f32 v244, v244, v155, v156
    v_max3_f32 v244, v244, v157, v158
    v_max_f32 v244, v244, v159
    v_mov_b32 v245, v244
    s_nop 1
    v_permlane32_swap_b32 v244, v245
    v_max_f32 v244, v244, v245
    v_mov_b32 v245, v244
    s_nop 1
    v_permlane16_swap_b32 v244, v245
    v_max_f32 v244, v244, v245
    v_mul_f32 v244, s25, v244
    v_add_f32 v244, 0x41100000, v244
    v_max_f32 v244, v244, v194
    v_sub_f32 v246, v194, v244
    v_exp_f32 v246, v246
    v_mov_b32 v194, v244
    v_pk_mul_f32 v[240:241], v[240:241], v[246:247] op_sel_hi:[1,0]
    v_pk_mul_f32 v[242:243], v[242:243], v[246:247] op_sel_hi:[1,0]
    v_pk_mul_f32 v[96:97], v[96:97], v[246:247] op_sel_hi:[1,0]
    v_pk_mul_f32 v[98:99], v[98:99], v[246:247] op_sel_hi:[1,0]
    v_pk_mul_f32 v[100:101], v[100:101], v[246:247] op_sel_hi:[1,0]
    v_pk_mul_f32 v[102:103], v[102:103], v[246:247] op_sel_hi:[1,0]
    v_pk_mul_f32 v[104:105], v[104:105], v[246:247] op_sel_hi:[1,0]
    v_pk_mul_f32 v[106:107], v[106:107], v[246:247] op_sel_hi:[1,0]
    v_pk_mul_f32 v[108:109], v[108:109], v[246:247] op_sel_hi:[1,0]
    v_pk_mul_f32 v[110:111], v[110:111], v[246:247] op_sel_hi:[1,0]
    v_pk_mul_f32 v[112:113], v[112:113], v[246:247] op_sel_hi:[1,0]
    v_pk_mul_f32 v[114:115], v[114:115], v[246:247] op_sel_hi:[1,0]
    v_pk_mul_f32 v[116:117], v[116:117], v[246:247] op_sel_hi:[1,0]
    v_pk_mul_f32 v[118:119], v[118:119], v[246:247] op_sel_hi:[1,0]
    v_pk_mul_f32 v[120:121], v[120:121], v[246:247] op_sel_hi:[1,0]
    v_pk_mul_f32 v[122:123], v[122:123], v[246:247] op_sel_hi:[1,0]
    v_pk_mul_f32 v[124:125], v[124:125], v[246:247] op_sel_hi:[1,0]
    v_pk_mul_f32 v[126:127], v[126:127], v[246:247] op_sel_hi:[1,0]
    v_pk_mul_f32 v[128:129], v[128:129], v[246:247] op_sel_hi:[1,0]
    v_pk_mul_f32 v[130:131], v[130:131], v[246:247] op_sel_hi:[1,0]
    v_pk_mul_f32 v[132:133], v[132:133], v[246:247] op_sel_hi:[1,0]
    v_pk_mul_f32 v[134:135], v[134:135], v[246:247] op_sel_hi:[1,0]
    v_pk_mul_f32 v[136:137], v[136:137], v[246:247] op_sel_hi:[1,0]
    v_pk_mul_f32 v[138:139], v[138:139], v[246:247] op_sel_hi:[1,0]
    v_pk_mul_f32 v[140:141], v[140:141], v[246:247] op_sel_hi:[1,0]
    v_pk_mul_f32 v[142:143], v[142:143], v[246:247] op_sel_hi:[1,0]
    v_fma_f32 v180, v152, s25, -v194
    v_fma_f32 v181, v153, s25, -v194
    v_exp_f32 v180, v180
    v_exp_f32 v181, v181
    v_fma_f32 v182, v154, s25, -v194
    v_fma_f32 v183, v155, s25, -v194
    v_exp_f32 v182, v182
    v_exp_f32 v183, v183
    v_cvt_pk_bf16_f32 v172, v180, v181
    v_fma_f32 v184, v156, s25, -v194
    v_fma_f32 v185, v157, s25, -v194
    v_exp_f32 v184, v184
    v_cvt_pk_bf16_f32 v173, v182, v183
    v_exp_f32 v185, v185
    v_fma_f32 v186, v158, s25, -v194
    v_fma_f32 v187, v159, s25, -v194
    v_exp_f32 v186, v186
    v_cvt_pk_bf16_f32 v174, v184, v185
    v_exp_f32 v187, v187
    s_nop 0
    v_cvt_pk_bf16_f32 v175, v186, v187
    s_nop 1
    s_branch Z_back_ee
Z_rare_ef:
    v_max3_f32 v244, v160, v161, v162
    v_max3_f32 v244, v244, v163, v164
    v_max3_f32 v244, v244, v165, v166
    v_max_f32 v244, v244, v167
    v_mov_b32 v245, v244
    s_nop 1
    v_permlane32_swap_b32 v244, v245
    v_max_f32 v244, v244, v245
    v_mov_b32 v245, v244
    s_nop 1
    v_permlane16_swap_b32 v244, v245
    v_max_f32 v244, v244, v245
    v_mul_f32 v244, s25, v244
    v_add_f32 v244, 0x41100000, v244
    v_max_f32 v244, v244, v194
    v_sub_f32 v246, v194, v244
    v_exp_f32 v246, v246
    v_mov_b32 v194, v244
    v_pk_mul_f32 v[240:241], v[240:241], v[246:247] op_sel_hi:[1,0]
    v_pk_mul_f32 v[242:243], v[242:243], v[246:247] op_sel_hi:[1,0]
    v_pk_mul_f32 v[96:97], v[96:97], v[246:247] op_sel_hi:[1,0]
    v_pk_mul_f32 v[98:99], v[98:99], v[246:247] op_sel_hi:[1,0]
    v_pk_mul_f32 v[100:101], v[100:101], v[246:247] op_sel_hi:[1,0]
    v_pk_mul_f32 v[102:103], v[102:103], v[246:247] op_sel_hi:[1,0]
    v_pk_mul_f32 v[104:105], v[104:105], v[246:247] op_sel_hi:[1,0]
    v_pk_mul_f32 v[106:107], v[106:107], v[246:247] op_sel_hi:[1,0]
    v_pk_mul_f32 v[108:109], v[108:109], v[246:247] op_sel_hi:[1,0]
    v_pk_mul_f32 v[110:111], v[110:111], v[246:247] op_sel_hi:[1,0]
    v_pk_mul_f32 v[112:113], v[112:113], v[246:247] op_sel_hi:[1,0]
    v_pk_mul_f32 v[114:115], v[114:115], v[246:247] op_sel_hi:[1,0]
    v_pk_mul_f32 v[116:117], v[116:117], v[246:247] op_sel_hi:[1,0]
    v_pk_mul_f32 v[118:119], v[118:119], v[246:247] op_sel_hi:[1,0]
    v_pk_mul_f32 v[120:121], v[120:121], v[246:247] op_sel_hi:[1,0]
    v_pk_mul_f32 v[122:123], v[122:123], v[246:247] op_sel_hi:[1,0]
    v_pk_mul_f32 v[124:125], v[124:125], v[246:247] op_sel_hi:[1,0]
    v_pk_mul_f32 v[126:127], v[126:127], v[246:247] op_sel_hi:[1,0]
    v_pk_mul_f32 v[128:129], v[128:129], v[246:247] op_sel_hi:[1,0]
    v_pk_mul_f32 v[130:131], v[130:131], v[246:247] op_sel_hi:[1,0]
    v_pk_mul_f32 v[132:133], v[132:133], v[246:247] op_sel_hi:[1,0]
    v_pk_mul_f32 v[134:135], v[134:135], v[246:247] op_sel_hi:[1,0]
    v_pk_mul_f32 v[136:137], v[136:137], v[246:247] op_sel_hi:[1,0]
    v_pk_mul_f32 v[138:139], v[138:139], v[246:247] op_sel_hi:[1,0]
    v_pk_mul_f32 v[140:141], v[140:141], v[246:247] op_sel_hi:[1,0]
    v_pk_mul_f32 v[142:143], v[142:143], v[246:247] op_sel_hi:[1,0]
    v_fma_f32 v180, v160, s25, -v194
    v_fma_f32 v181, v161, s25, -v194
    v_exp_f32 v180, v180
    v_exp_f32 v181, v181
    v_fma_f32 v182, v162, s25, -v194
    v_fma_f32 v183, v163, s25, -v194
    v_exp_f32 v182, v182
    v_exp_f32 v183, v183
    v_cvt_pk_bf16_f32 v176, v180, v181
    v_fma_f32 v184, v164, s25, -v194
    v_fma_f32 v185, v165, s25, -v194
    v_exp_f32 v184, v184
    v_cvt_pk_bf16_f32 v177, v182, v183
    v_exp_f32 v185, v185
    v_fma_f32 v186, v166, s25, -v194
    v_fma_f32 v187, v167, s25, -v194
    v_exp_f32 v186, v186
    v_cvt_pk_bf16_f32 v178, v184, v185
    v_exp_f32 v187, v187
    s_nop 0
    v_cvt_pk_bf16_f32 v179, v186, v187
    s_nop 1
    s_branch Z_back_ef
.section .rodata,"a"
.p2align 6
.amdhsa_kernel standalone__gqa_softmax__near_ridge_kernel
  .amdhsa_next_free_vgpr 512
  .amdhsa_next_free_sgpr 96
  .amdhsa_accum_offset 256
  .amdhsa_group_segment_fixed_size 0
  .amdhsa_kernarg_size 48
  .amdhsa_user_sgpr_count 2
  .amdhsa_user_sgpr_kernarg_segment_ptr 1
  .amdhsa_system_sgpr_workgroup_id_x 1
.end_amdhsa_kernel
```
